```python
import torch

def _softmax(x, axis=-1):
    return torch.softmax(x, dim=axis)
def _gelu(x):
    return torch.nn.functional.gelu(x, approximate="tanh")
def _silu(x):
    return torch.nn.functional.silu(x)
def _sigmoid(x):
    return torch.sigmoid(x)
def _layernorm(x, axis=-1, eps=1e-5):
    m = x.mean(dim=axis, keepdim=True)
    v = x.var(dim=axis, keepdim=True, unbiased=False)
    return (x - m) / torch.sqrt(v + eps)
def _scatter_add(tgt, idx, src, axis=0):
    return tgt.clone().index_add_(axis, idx, src)
def _segment_sum(src, seg, n):
    out = torch.zeros((n,) + src.shape[1:], dtype=src.dtype)
    return out.index_add_(0, seg, src)
def _pad(x, pw):
    flat = tuple(v for pair in reversed(pw) for v in pair)
    return torch.nn.functional.pad(x, flat)

kernel_name = 'interleave_layers__linear_kernel_hedgehog__mixer_s_mlp__prompt'

def setup_inputs():

    _w = (lambda a: (lambda t: t.to(torch.bfloat16) if t.is_floating_point() else t)(torch.as_tensor(a)))
    def _A_setup():
        B, S, D, H = 1, 2048, 512, 32
        Dh = D // H
        return {
            "x": _w((lambda *s: torch.randn(*s, dtype=torch.bfloat16) * 0.05)(B, S, D)),
            "wqkv": _w((lambda *s: torch.randn(*s, dtype=torch.bfloat16) * 0.4)(D, 3 * D)),
            "w_phi": _w((lambda *s: torch.randn(*s, dtype=torch.bfloat16) * 0.4)(H, Dh, Dh) * (Dh ** -0.5)),
            "wo": _w((lambda *s: torch.randn(*s, dtype=torch.bfloat16) * 0.05)(D, D)),
        }
    _A_in = _A_setup()

    def _B_setup():
        B, S, D, F = 1, 2048, 512, 1792
        return {
            "x":  _w((lambda *s: torch.randn(*s, dtype=torch.bfloat16) * 0.05)(B, S, D)),
            "w1": _w((lambda *s: torch.randn(*s, dtype=torch.bfloat16) * 3.2)(D, D) * (D ** -0.5)),
            "w2": _w((lambda *s: torch.randn(*s, dtype=torch.bfloat16) * 3.2)(D, D) * (D ** -0.5)),
            "w3": _w((lambda *s: torch.randn(*s, dtype=torch.bfloat16) * 3.2)(D, F) * (D ** -0.5)),
            "w4": _w((lambda *s: torch.randn(*s, dtype=torch.bfloat16) * 3.2)(F, D) * (F ** -0.5)),
        }
    _B_in = _B_setup()

    return {
        "A_x": _A_in["x"],
        "A_wqkv": _A_in["wqkv"],
        "A_w_phi": _A_in["w_phi"],
        "A_wo": _A_in["wo"],
        "B_x": _B_in["x"],
        "B_w1": _B_in["w1"],
        "B_w2": _B_in["w2"],
        "B_w3": _B_in["w3"],
        "B_w4": _B_in["w4"],
    }

def reference(A_x, A_wqkv, A_w_phi, A_wo, B_x, B_w1, B_w2, B_w3, B_w4):
    def _A_ref(x, wqkv, w_phi, wo):
        B, S, D = x.shape
        H = 32; Dh = D // H
        qkv = (lambda x, *d: x.permute(*d))((x @ wqkv).reshape(B, S, 3, H, Dh), 2, 0, 3, 1, 4)
        q, k, v = qkv[0], qkv[1], qkv[2]
        pq = torch.einsum("bhsd,hdf->bhsf", q, w_phi)
        pk = torch.einsum("bhsd,hdf->bhsf", k, w_phi)
        phi_q = torch.concatenate([_softmax(pq, axis=-1), _softmax(-pq, axis=-1)], axis=-1)
        phi_k = torch.concatenate([_softmax(pk, axis=-1), _softmax(-pk, axis=-1)], axis=-1)
        kv = torch.einsum("bhsf,bhsd->bhfd", phi_k, v)
        z  = torch.einsum("bhsf->bhf", phi_k)
        num = torch.einsum("bhqf,bhfd->bhqd", phi_q, kv)
        den = torch.einsum("bhqf,bhf->bhq", phi_q, z)[..., None] + 1e-6
        o = num / den
        return (lambda x, *d: x.permute(*d))(o, 0, 2, 1, 3).reshape(B, S, D) @ wo

    def _B_ref(x, w1, w2, w3, w4):
        B, S, D = x.shape
        h = _gelu(_layernorm(x, axis=-1) @ w1)
        c = D // 4
        g0 = _pad(h[:, :, 0*c:1*c], ((0, 0), (1, 0), (0, 0)))[:, :S, :]
        g1 = _pad(h[:, :, 1*c:2*c], ((0, 0), (0, 1), (0, 0)))[:, 1:, :]
        g2 = _pad(h[:, :, 2*c:3*c], ((0, 0), (2, 0), (0, 0)))[:, :S, :]
        g3 = _pad(h[:, :, 3*c:   ], ((0, 0), (0, 2), (0, 0)))[:, 2:, :]
        hs = torch.concatenate([g0, g1, g2, g3], axis=-1) @ w2
        x1 = x + hs
        h2 = _gelu(_layernorm(x1, axis=-1) @ w3) @ w4
        return x1 + h2

    x = A_x
    x = x + _A_ref(_layernorm(x, axis=-1), A_wqkv, A_w_phi, A_wo)
    x = x + _B_ref(_layernorm(x, axis=-1), B_w1, B_w2, B_w3, B_w4)
    x = x + _A_ref(_layernorm(x, axis=-1), A_wqkv, A_w_phi, A_wo)
    x = x + _B_ref(_layernorm(x, axis=-1), B_w1, B_w2, B_w3, B_w4)
    return x
```

```asm
; @launch grid=(256,1,1) block=(512,1,1) lds=163840
.amdgcn_target "amdgcn-amd-amdhsa--gfx950"
.text
.globl interleave_layers__linear_kernel_hedgehog__mixer_s_mlp__prompt_kernel
.p2align 8
.type interleave_layers__linear_kernel_hedgehog__mixer_s_mlp__prompt_kernel,@function
interleave_layers__linear_kernel_hedgehog__mixer_s_mlp__prompt_kernel:
    s_cmp_ge_u32 s2, 256
    s_cbranch_scc1 DONE
    s_load_dwordx16 s[16:31], s[0:1], 0
    s_load_dwordx8 s[32:39], s[0:1], 64
    v_lshrrev_b32 v1, 6, v0
    v_and_b32 v8, 63, v0
    v_readfirstlane_b32 s42, v1
    s_getpc_b64 s[58:59]
PCREF:
    s_lshr_b32 s52, s2, 3
    v_and_b32 v9, 1, v8
    v_lshl_or_b32 v9, v1, 1, v9
    v_lshlrev_b32 v9, 7, v9
    s_lshl_b32 s51, s52, 11
    v_add_u32 v9, s51, v9
    v_min_u32 v9, CODE_END-PCREF-4, v9
    s_mov_b64 exec, 3
    global_load_dword v6, v9, s[58:59]
    s_mov_b64 exec, -1
    v_lshlrev_b32 v0, 4, v8
    s_and_b32 s51, s2, 7
    s_and_b32 s41, s52, 15
    s_lshr_b32 s52, s52, 4
    s_lshl_b32 s40, s51, 1
    s_add_u32 s40, s40, s52
    v_lshrrev_b32 v16, 3, v8
    v_and_b32 v17, 7, v8
    v_mov_b32 v28, 0
    v_lshlrev_b32 v18, 2, v8
    v_add_u32 v18, 160384, v18
    ds_write_b32 v18, v28
    v_mov_b32 v29, 0
    v_lshlrev_b32 v18, 3, v8
    v_add_u32 v18, 156672, v18
    ds_write_b64 v18, v[28:29]
    s_cmp_ge_u32 s42, 4
    s_cbranch_scc1 HELPERS
    v_lshlrev_b32 v18, 10, v16
    v_lshl_or_b32 v18, v17, 4, v18
    s_lshl_b32 s54, s42, 12
    s_add_u32 s54, s54, 131072
    s_lshl_b32 s71, s40, 2
    s_add_u32 s71, s71, s42
    s_lshl_b32 s71, s71, 15
    s_add_u32 s72, s71, 8192
    s_add_u32 s73, s71, 16384
    s_add_u32 s74, s71, 24576
    s_mov_b32 s10, 2097152
    s_mov_b32 s11, 0x20000
    s_waitcnt lgkmcnt(0)
    s_barrier
    s_mov_b32 s8, s16
    s_and_b32 s9, s17, 0xffff
    s_lshl_b32 s51, s40, 4
    s_add_u32 s51, s51, s41
    s_lshl_b32 s51, s51, 2
    s_add_u32 s51, s51, s42
    s_lshl_b32 s51, s51, 11
    v_lshlrev_b32 v19, 7, v8
    s_mov_b64 exec, 0xffff
    buffer_load_dword v6, v19, s[8:11], s51 offen
    s_mov_b64 exec, -1
    buffer_load_dwordx4 v[128:131], v18, s[8:11], s71 offen offset:0
    buffer_load_dwordx4 v[132:135], v18, s[8:11], s72 offen offset:0
    buffer_load_dwordx4 v[136:139], v18, s[8:11], s73 offen offset:0
    buffer_load_dwordx4 v[140:143], v18, s[8:11], s74 offen offset:0
    buffer_load_dwordx4 v[144:147], v18, s[8:11], s71 offen offset:128
    buffer_load_dwordx4 v[148:151], v18, s[8:11], s72 offen offset:128
    buffer_load_dwordx4 v[152:155], v18, s[8:11], s73 offen offset:128
    buffer_load_dwordx4 v[156:159], v18, s[8:11], s74 offen offset:128
    buffer_load_dwordx4 v[160:163], v18, s[8:11], s71 offen offset:256
    buffer_load_dwordx4 v[164:167], v18, s[8:11], s72 offen offset:256
    buffer_load_dwordx4 v[168:171], v18, s[8:11], s73 offen offset:256
    buffer_load_dwordx4 v[172:175], v18, s[8:11], s74 offen offset:256
    buffer_load_dwordx4 v[176:179], v18, s[8:11], s71 offen offset:384
    buffer_load_dwordx4 v[180:183], v18, s[8:11], s72 offen offset:384
    buffer_load_dwordx4 v[184:187], v18, s[8:11], s73 offen offset:384
    buffer_load_dwordx4 v[188:191], v18, s[8:11], s74 offen offset:384
    buffer_load_dwordx4 v[192:195], v18, s[8:11], s71 offen offset:512
    buffer_load_dwordx4 v[196:199], v18, s[8:11], s72 offen offset:512
    buffer_load_dwordx4 v[200:203], v18, s[8:11], s73 offen offset:512
    buffer_load_dwordx4 v[204:207], v18, s[8:11], s74 offen offset:512
    buffer_load_dwordx4 v[208:211], v18, s[8:11], s71 offen offset:640
    buffer_load_dwordx4 v[212:215], v18, s[8:11], s72 offen offset:640
    buffer_load_dwordx4 v[216:219], v18, s[8:11], s73 offen offset:640
    buffer_load_dwordx4 v[220:223], v18, s[8:11], s74 offen offset:640
    s_lshr_b32 s43, s41, 3
    s_and_b32 s44, s41, 7
    s_mov_b32 s46, 0
    s_mov_b32 s75, 0x3f803f80
    v_mov_b32 v4, 160512
    v_lshrrev_b32 v9, 4, v8
    v_bfe_u32 v10, v8, 2, 2
    v_and_b32 v11, 3, v8
    v_lshl_add_u32 v12, v9, 3, v10
    v_lshlrev_b32 v12, 7, v12
    v_and_b32 v13, 2, v10
    v_and_b32 v14, 1, v9
    v_or_b32 v15, v13, v14
    v_lshl_or_b32 v12, v15, 5, v12
    v_lshl_or_b32 v1, v11, 3, v12
    v_lshrrev_b32 v28, 5, v8
    v_lshl_add_u32 v12, v28, 3, v10
    v_lshlrev_b32 v12, 7, v12
    v_or_b32 v15, v13, v28
    v_lshrrev_b32 v29, 1, v11
    v_and_b32 v30, 1, v11
    v_lshl_or_b32 v12, v29, 3, v12
    v_xor_b32 v31, v14, v15
    v_lshl_or_b32 v2, v31, 5, v12
    v_lshl_or_b32 v2, v30, 4, v2
    v_xor_b32 v31, v30, v15
    v_lshl_or_b32 v3, v31, 5, v12
    v_lshl_or_b32 v3, v14, 4, v3
    s_mov_b32 s4, s38
    s_and_b32 s5, s39, 0xffff
    s_mov_b32 s6, 25165824
    s_mov_b32 s7, 0x20000
    s_setprio 2
    v_lshrrev_b32 v20, 5, v8
    v_xor_b32 v112, v17, v9
    v_lshlrev_b32 v112, 4, v112
    v_lshl_or_b32 v112, v16, 7, v112
    v_add_u32 v112, s54, v112
    v_xor_b32 v113, 64, v112
    v_and_b32 v114, 31, v8
    v_bfe_u32 v115, v8, 1, 3
    v_xor_b32 v115, v115, v20
    v_lshlrev_b32 v115, 4, v115
    v_lshl_or_b32 v114, v114, 7, v115
    v_add_u32 v114, s54, v114
    v_xor_b32 v115, 32, v114
    v_xor_b32 v116, 64, v114
    v_xor_b32 v117, 96, v114
    v_mov_b32 v96, 0
    v_mov_b32 v97, 0
    s_and_b32 s76, s42, 1
    s_lshr_b32 s77, s42, 1
    s_lshl_b32 s45, s43, 1
    s_add_u32 s45, s45, s76
    s_mov_b32 s48, 0
    s_mov_b32 s49, 0
    s_mov_b32 s50, 0
    s_mov_b32 s70, 0
    s_mov_b32 s84, 0
    s_mul_i32 s65, s40, 917504
    s_add_u32 s63, s65, 32768
    s_add_u32 s64, s65, 229376
    s_add_u32 s66, s65, 393216
    s_add_u32 s67, s65, 851968
    s_lshl_b32 s69, s40, 8
    s_add_u32 s69, s69, 20185088
    s_lshl_b32 s51, s41, 2
    s_add_u32 s51, s51, s42
    s_lshl_b32 s68, s51, 2
    s_add_u32 s68, s68, s69
    s_lshl_b32 s82, s51, 13
    s_add_u32 s82, s82, 18874368
    s_lshl_b32 s83, s51, 10
    s_add_u32 s83, s83, 19922944
    s_lshl_b32 s89, s51, 7
    s_add_u32 s89, s89, 20250624
    s_lshl_b32 s86, s45, 15
    s_lshl_b32 s51, s44, 12
    s_lshl_b32 s52, s77, 11
    s_add_u32 s51, s51, s52
    s_add_u32 s85, s86, s51
    s_lshl_b32 s52, s77, 14
    s_add_u32 s86, s86, s52
    s_lshl_b32 s88, s40, 2
    s_add_u32 s88, s88, s45
    s_lshl_b32 s88, s88, 15
    s_lshr_b32 s51, s51, 5
    s_add_u32 s88, s88, s51
    v_and_b32 v19, 31, v8
    v_lshlrev_b32 v19, 10, v19
    v_lshrrev_b32 v20, 5, v8
    v_lshl_or_b32 v19, v20, 4, v19
    buffer_load_dwordx4 v[120:123], v19, s[8:11], s88 offen offset:0
    buffer_load_dwordx4 v[124:127], v19, s[8:11], s88 offen offset:32
    s_lshl_b32 s51, s43, 7
    s_lshl_b32 s52, s76, 2
    s_add_u32 s51, s51, s52
    s_add_u32 s87, s51, s69
    s_sub_u32 s78, s87, 4
    s_add_u32 s79, s87, 4
    s_add_u32 s52, s69, 4
    s_cmp_eq_u32 s45, 2
    s_cselect_b32 s78, s52, s78
    s_add_u32 s52, s69, 128
    s_cmp_eq_u32 s45, 1
    s_cselect_b32 s79, s52, s79
    s_cmp_eq_u32 s45, 0
    s_cselect_b32 s78, s87, s78
    s_cmp_eq_u32 s45, 3
    s_cselect_b32 s79, s87, s79
    s_mov_b32 s61, 786432
    s_mov_b32 s58, 0xff000000
    s_mov_b32 s59, 0xff000000
    s_bitcmp1_b32 s44, 1
    s_cbranch_scc1 HW_UP
    s_cmp_eq_u32 s45, 3
    s_cselect_b32 s60, 1, 0
    s_cmp_eq_u32 s40, 15
    s_cselect_b32 s60, 0, s60
    s_branch HW_E
HW_UP:
    s_mov_b32 s61, 4294180864
    s_mov_b32 s58, 0xff
    s_mov_b32 s59, 0xff
    s_cmp_eq_u32 s45, 0
    s_cselect_b32 s60, 1, 0
    s_cmp_eq_u32 s40, 0
    s_cselect_b32 s60, 0, s60
HW_E:
    s_lshl_b32 s51, s42, 2
    s_add_u32 s51, s51, 160528
    v_mov_b32 v5, s51
    v_xor_b32 v10, 64, v3
    buffer_load_dwordx4 v[224:227], v18, s[8:11], s71 offen offset:768
    buffer_load_dwordx4 v[228:231], v18, s[8:11], s72 offen offset:768
    buffer_load_dwordx4 v[232:235], v18, s[8:11], s73 offen offset:768
    buffer_load_dwordx4 v[236:239], v18, s[8:11], s74 offen offset:768
    s_waitcnt vmcnt(26)
    ds_write_b128 v112, v[128:131] offset:0
    ds_write_b128 v113, v[132:135] offset:1024
    ds_write_b128 v112, v[136:139] offset:2048
    ds_write_b128 v113, v[140:143] offset:3072
    ds_read_b128 v[128:131], v114
    ds_read_b128 v[132:135], v115
    ds_read_b128 v[136:139], v116
    ds_read_b128 v[140:143], v117
    buffer_load_dwordx4 v[240:243], v18, s[8:11], s71 offen offset:896
    buffer_load_dwordx4 v[244:247], v18, s[8:11], s72 offen offset:896
    buffer_load_dwordx4 v[248:251], v18, s[8:11], s73 offen offset:896
    buffer_load_dwordx4 v[252:255], v18, s[8:11], s74 offen offset:896
    s_waitcnt vmcnt(26)
    ds_write_b128 v112, v[144:147] offset:0
    ds_write_b128 v113, v[148:151] offset:1024
    ds_write_b128 v112, v[152:155] offset:2048
    ds_write_b128 v113, v[156:159] offset:3072
    ds_read_b128 v[144:147], v114
    ds_read_b128 v[148:151], v115
    ds_read_b128 v[152:155], v116
    ds_read_b128 v[156:159], v117
    s_waitcnt lgkmcnt(8)
    v_dot2c_f32_bf16 v96, s75, v128
    v_dot2c_f32_bf16 v97, v128, v128
    v_dot2c_f32_bf16 v96, s75, v129
    v_dot2c_f32_bf16 v97, v129, v129
    v_dot2c_f32_bf16 v96, s75, v130
    v_dot2c_f32_bf16 v97, v130, v130
    v_dot2c_f32_bf16 v96, s75, v131
    v_dot2c_f32_bf16 v97, v131, v131
    v_dot2c_f32_bf16 v96, s75, v132
    v_dot2c_f32_bf16 v97, v132, v132
    v_dot2c_f32_bf16 v96, s75, v133
    v_dot2c_f32_bf16 v97, v133, v133
    v_dot2c_f32_bf16 v96, s75, v134
    v_dot2c_f32_bf16 v97, v134, v134
    v_dot2c_f32_bf16 v96, s75, v135
    v_dot2c_f32_bf16 v97, v135, v135
    v_dot2c_f32_bf16 v96, s75, v136
    v_dot2c_f32_bf16 v97, v136, v136
    v_dot2c_f32_bf16 v96, s75, v137
    v_dot2c_f32_bf16 v97, v137, v137
    v_dot2c_f32_bf16 v96, s75, v138
    v_dot2c_f32_bf16 v97, v138, v138
    v_dot2c_f32_bf16 v96, s75, v139
    v_dot2c_f32_bf16 v97, v139, v139
    v_dot2c_f32_bf16 v96, s75, v140
    v_dot2c_f32_bf16 v97, v140, v140
    v_dot2c_f32_bf16 v96, s75, v141
    v_dot2c_f32_bf16 v97, v141, v141
    v_dot2c_f32_bf16 v96, s75, v142
    v_dot2c_f32_bf16 v97, v142, v142
    v_dot2c_f32_bf16 v96, s75, v143
    v_dot2c_f32_bf16 v97, v143, v143
    s_waitcnt vmcnt(22)
    ds_write_b128 v112, v[160:163] offset:0
    ds_write_b128 v113, v[164:167] offset:1024
    ds_write_b128 v112, v[168:171] offset:2048
    ds_write_b128 v113, v[172:175] offset:3072
    ds_read_b128 v[160:163], v114
    ds_read_b128 v[164:167], v115
    ds_read_b128 v[168:171], v116
    ds_read_b128 v[172:175], v117
    s_waitcnt lgkmcnt(8)
    v_dot2c_f32_bf16 v96, s75, v144
    v_dot2c_f32_bf16 v97, v144, v144
    v_dot2c_f32_bf16 v96, s75, v145
    v_dot2c_f32_bf16 v97, v145, v145
    v_dot2c_f32_bf16 v96, s75, v146
    v_dot2c_f32_bf16 v97, v146, v146
    v_dot2c_f32_bf16 v96, s75, v147
    v_dot2c_f32_bf16 v97, v147, v147
    v_dot2c_f32_bf16 v96, s75, v148
    v_dot2c_f32_bf16 v97, v148, v148
    v_dot2c_f32_bf16 v96, s75, v149
    v_dot2c_f32_bf16 v97, v149, v149
    v_dot2c_f32_bf16 v96, s75, v150
    v_dot2c_f32_bf16 v97, v150, v150
    v_dot2c_f32_bf16 v96, s75, v151
    v_dot2c_f32_bf16 v97, v151, v151
    v_dot2c_f32_bf16 v96, s75, v152
    v_dot2c_f32_bf16 v97, v152, v152
    v_dot2c_f32_bf16 v96, s75, v153
    v_dot2c_f32_bf16 v97, v153, v153
    v_dot2c_f32_bf16 v96, s75, v154
    v_dot2c_f32_bf16 v97, v154, v154
    v_dot2c_f32_bf16 v96, s75, v155
    v_dot2c_f32_bf16 v97, v155, v155
    v_dot2c_f32_bf16 v96, s75, v156
    v_dot2c_f32_bf16 v97, v156, v156
    v_dot2c_f32_bf16 v96, s75, v157
    v_dot2c_f32_bf16 v97, v157, v157
    v_dot2c_f32_bf16 v96, s75, v158
    v_dot2c_f32_bf16 v97, v158, v158
    v_dot2c_f32_bf16 v96, s75, v159
    v_dot2c_f32_bf16 v97, v159, v159
    s_waitcnt vmcnt(18)
    ds_write_b128 v112, v[176:179] offset:0
    ds_write_b128 v113, v[180:183] offset:1024
    ds_write_b128 v112, v[184:187] offset:2048
    ds_write_b128 v113, v[188:191] offset:3072
    ds_read_b128 v[176:179], v114
    ds_read_b128 v[180:183], v115
    ds_read_b128 v[184:187], v116
    ds_read_b128 v[188:191], v117
    s_waitcnt lgkmcnt(8)
    v_dot2c_f32_bf16 v96, s75, v160
    v_dot2c_f32_bf16 v97, v160, v160
    v_dot2c_f32_bf16 v96, s75, v161
    v_dot2c_f32_bf16 v97, v161, v161
    v_dot2c_f32_bf16 v96, s75, v162
    v_dot2c_f32_bf16 v97, v162, v162
    v_dot2c_f32_bf16 v96, s75, v163
    v_dot2c_f32_bf16 v97, v163, v163
    v_dot2c_f32_bf16 v96, s75, v164
    v_dot2c_f32_bf16 v97, v164, v164
    v_dot2c_f32_bf16 v96, s75, v165
    v_dot2c_f32_bf16 v97, v165, v165
    v_dot2c_f32_bf16 v96, s75, v166
    v_dot2c_f32_bf16 v97, v166, v166
    v_dot2c_f32_bf16 v96, s75, v167
    v_dot2c_f32_bf16 v97, v167, v167
    v_dot2c_f32_bf16 v96, s75, v168
    v_dot2c_f32_bf16 v97, v168, v168
    v_dot2c_f32_bf16 v96, s75, v169
    v_dot2c_f32_bf16 v97, v169, v169
    v_dot2c_f32_bf16 v96, s75, v170
    v_dot2c_f32_bf16 v97, v170, v170
    v_dot2c_f32_bf16 v96, s75, v171
    v_dot2c_f32_bf16 v97, v171, v171
    v_dot2c_f32_bf16 v96, s75, v172
    v_dot2c_f32_bf16 v97, v172, v172
    v_dot2c_f32_bf16 v96, s75, v173
    v_dot2c_f32_bf16 v97, v173, v173
    v_dot2c_f32_bf16 v96, s75, v174
    v_dot2c_f32_bf16 v97, v174, v174
    v_dot2c_f32_bf16 v96, s75, v175
    v_dot2c_f32_bf16 v97, v175, v175
    s_waitcnt vmcnt(14)
    ds_write_b128 v112, v[192:195] offset:0
    ds_write_b128 v113, v[196:199] offset:1024
    ds_write_b128 v112, v[200:203] offset:2048
    ds_write_b128 v113, v[204:207] offset:3072
    ds_read_b128 v[192:195], v114
    ds_read_b128 v[196:199], v115
    ds_read_b128 v[200:203], v116
    ds_read_b128 v[204:207], v117
    s_waitcnt lgkmcnt(8)
    v_dot2c_f32_bf16 v96, s75, v176
    v_dot2c_f32_bf16 v97, v176, v176
    v_dot2c_f32_bf16 v96, s75, v177
    v_dot2c_f32_bf16 v97, v177, v177
    v_dot2c_f32_bf16 v96, s75, v178
    v_dot2c_f32_bf16 v97, v178, v178
    v_dot2c_f32_bf16 v96, s75, v179
    v_dot2c_f32_bf16 v97, v179, v179
    v_dot2c_f32_bf16 v96, s75, v180
    v_dot2c_f32_bf16 v97, v180, v180
    v_dot2c_f32_bf16 v96, s75, v181
    v_dot2c_f32_bf16 v97, v181, v181
    v_dot2c_f32_bf16 v96, s75, v182
    v_dot2c_f32_bf16 v97, v182, v182
    v_dot2c_f32_bf16 v96, s75, v183
    v_dot2c_f32_bf16 v97, v183, v183
    v_dot2c_f32_bf16 v96, s75, v184
    v_dot2c_f32_bf16 v97, v184, v184
    v_dot2c_f32_bf16 v96, s75, v185
    v_dot2c_f32_bf16 v97, v185, v185
    v_dot2c_f32_bf16 v96, s75, v186
    v_dot2c_f32_bf16 v97, v186, v186
    v_dot2c_f32_bf16 v96, s75, v187
    v_dot2c_f32_bf16 v97, v187, v187
    v_dot2c_f32_bf16 v96, s75, v188
    v_dot2c_f32_bf16 v97, v188, v188
    v_dot2c_f32_bf16 v96, s75, v189
    v_dot2c_f32_bf16 v97, v189, v189
    v_dot2c_f32_bf16 v96, s75, v190
    v_dot2c_f32_bf16 v97, v190, v190
    v_dot2c_f32_bf16 v96, s75, v191
    v_dot2c_f32_bf16 v97, v191, v191
    s_waitcnt vmcnt(10)
    ds_write_b128 v112, v[208:211] offset:0
    ds_write_b128 v113, v[212:215] offset:1024
    ds_write_b128 v112, v[216:219] offset:2048
    ds_write_b128 v113, v[220:223] offset:3072
    ds_read_b128 v[208:211], v114
    ds_read_b128 v[212:215], v115
    ds_read_b128 v[216:219], v116
    ds_read_b128 v[220:223], v117
    s_waitcnt lgkmcnt(8)
    v_dot2c_f32_bf16 v96, s75, v192
    v_dot2c_f32_bf16 v97, v192, v192
    v_dot2c_f32_bf16 v96, s75, v193
    v_dot2c_f32_bf16 v97, v193, v193
    v_dot2c_f32_bf16 v96, s75, v194
    v_dot2c_f32_bf16 v97, v194, v194
    v_dot2c_f32_bf16 v96, s75, v195
    v_dot2c_f32_bf16 v97, v195, v195
    v_dot2c_f32_bf16 v96, s75, v196
    v_dot2c_f32_bf16 v97, v196, v196
    v_dot2c_f32_bf16 v96, s75, v197
    v_dot2c_f32_bf16 v97, v197, v197
    v_dot2c_f32_bf16 v96, s75, v198
    v_dot2c_f32_bf16 v97, v198, v198
    v_dot2c_f32_bf16 v96, s75, v199
    v_dot2c_f32_bf16 v97, v199, v199
    v_dot2c_f32_bf16 v96, s75, v200
    v_dot2c_f32_bf16 v97, v200, v200
    v_dot2c_f32_bf16 v96, s75, v201
    v_dot2c_f32_bf16 v97, v201, v201
    v_dot2c_f32_bf16 v96, s75, v202
    v_dot2c_f32_bf16 v97, v202, v202
    v_dot2c_f32_bf16 v96, s75, v203
    v_dot2c_f32_bf16 v97, v203, v203
    v_dot2c_f32_bf16 v96, s75, v204
    v_dot2c_f32_bf16 v97, v204, v204
    v_dot2c_f32_bf16 v96, s75, v205
    v_dot2c_f32_bf16 v97, v205, v205
    v_dot2c_f32_bf16 v96, s75, v206
    v_dot2c_f32_bf16 v97, v206, v206
    v_dot2c_f32_bf16 v96, s75, v207
    v_dot2c_f32_bf16 v97, v207, v207
    s_waitcnt vmcnt(4)
    ds_write_b128 v112, v[224:227] offset:0
    ds_write_b128 v113, v[228:231] offset:1024
    ds_write_b128 v112, v[232:235] offset:2048
    ds_write_b128 v113, v[236:239] offset:3072
    ds_read_b128 v[224:227], v114
    ds_read_b128 v[228:231], v115
    ds_read_b128 v[232:235], v116
    ds_read_b128 v[236:239], v117
    s_waitcnt lgkmcnt(8)
    v_dot2c_f32_bf16 v96, s75, v208
    v_dot2c_f32_bf16 v97, v208, v208
    v_dot2c_f32_bf16 v96, s75, v209
    v_dot2c_f32_bf16 v97, v209, v209
    v_dot2c_f32_bf16 v96, s75, v210
    v_dot2c_f32_bf16 v97, v210, v210
    v_dot2c_f32_bf16 v96, s75, v211
    v_dot2c_f32_bf16 v97, v211, v211
    v_dot2c_f32_bf16 v96, s75, v212
    v_dot2c_f32_bf16 v97, v212, v212
    v_dot2c_f32_bf16 v96, s75, v213
    v_dot2c_f32_bf16 v97, v213, v213
    v_dot2c_f32_bf16 v96, s75, v214
    v_dot2c_f32_bf16 v97, v214, v214
    v_dot2c_f32_bf16 v96, s75, v215
    v_dot2c_f32_bf16 v97, v215, v215
    v_dot2c_f32_bf16 v96, s75, v216
    v_dot2c_f32_bf16 v97, v216, v216
    v_dot2c_f32_bf16 v96, s75, v217
    v_dot2c_f32_bf16 v97, v217, v217
    v_dot2c_f32_bf16 v96, s75, v218
    v_dot2c_f32_bf16 v97, v218, v218
    v_dot2c_f32_bf16 v96, s75, v219
    v_dot2c_f32_bf16 v97, v219, v219
    v_dot2c_f32_bf16 v96, s75, v220
    v_dot2c_f32_bf16 v97, v220, v220
    v_dot2c_f32_bf16 v96, s75, v221
    v_dot2c_f32_bf16 v97, v221, v221
    v_dot2c_f32_bf16 v96, s75, v222
    v_dot2c_f32_bf16 v97, v222, v222
    v_dot2c_f32_bf16 v96, s75, v223
    v_dot2c_f32_bf16 v97, v223, v223
    s_waitcnt vmcnt(0)
    ds_write_b128 v112, v[240:243] offset:0
    ds_write_b128 v113, v[244:247] offset:1024
    ds_write_b128 v112, v[248:251] offset:2048
    ds_write_b128 v113, v[252:255] offset:3072
    ds_read_b128 v[240:243], v114
    ds_read_b128 v[244:247], v115
    ds_read_b128 v[248:251], v116
    ds_read_b128 v[252:255], v117
    s_waitcnt lgkmcnt(8)
    v_dot2c_f32_bf16 v96, s75, v224
    v_dot2c_f32_bf16 v97, v224, v224
    v_dot2c_f32_bf16 v96, s75, v225
    v_dot2c_f32_bf16 v97, v225, v225
    v_dot2c_f32_bf16 v96, s75, v226
    v_dot2c_f32_bf16 v97, v226, v226
    v_dot2c_f32_bf16 v96, s75, v227
    v_dot2c_f32_bf16 v97, v227, v227
    v_dot2c_f32_bf16 v96, s75, v228
    v_dot2c_f32_bf16 v97, v228, v228
    v_dot2c_f32_bf16 v96, s75, v229
    v_dot2c_f32_bf16 v97, v229, v229
    v_dot2c_f32_bf16 v96, s75, v230
    v_dot2c_f32_bf16 v97, v230, v230
    v_dot2c_f32_bf16 v96, s75, v231
    v_dot2c_f32_bf16 v97, v231, v231
    v_dot2c_f32_bf16 v96, s75, v232
    v_dot2c_f32_bf16 v97, v232, v232
    v_dot2c_f32_bf16 v96, s75, v233
    v_dot2c_f32_bf16 v97, v233, v233
    v_dot2c_f32_bf16 v96, s75, v234
    v_dot2c_f32_bf16 v97, v234, v234
    v_dot2c_f32_bf16 v96, s75, v235
    v_dot2c_f32_bf16 v97, v235, v235
    v_dot2c_f32_bf16 v96, s75, v236
    v_dot2c_f32_bf16 v97, v236, v236
    v_dot2c_f32_bf16 v96, s75, v237
    v_dot2c_f32_bf16 v97, v237, v237
    v_dot2c_f32_bf16 v96, s75, v238
    v_dot2c_f32_bf16 v97, v238, v238
    v_dot2c_f32_bf16 v96, s75, v239
    v_dot2c_f32_bf16 v97, v239, v239
    s_waitcnt lgkmcnt(0)
    v_dot2c_f32_bf16 v96, s75, v240
    v_dot2c_f32_bf16 v97, v240, v240
    v_dot2c_f32_bf16 v96, s75, v241
    v_dot2c_f32_bf16 v97, v241, v241
    v_dot2c_f32_bf16 v96, s75, v242
    v_dot2c_f32_bf16 v97, v242, v242
    v_dot2c_f32_bf16 v96, s75, v243
    v_dot2c_f32_bf16 v97, v243, v243
    v_dot2c_f32_bf16 v96, s75, v244
    v_dot2c_f32_bf16 v97, v244, v244
    v_dot2c_f32_bf16 v96, s75, v245
    v_dot2c_f32_bf16 v97, v245, v245
    v_dot2c_f32_bf16 v96, s75, v246
    v_dot2c_f32_bf16 v97, v246, v246
    v_dot2c_f32_bf16 v96, s75, v247
    v_dot2c_f32_bf16 v97, v247, v247
    v_dot2c_f32_bf16 v96, s75, v248
    v_dot2c_f32_bf16 v97, v248, v248
    v_dot2c_f32_bf16 v96, s75, v249
    v_dot2c_f32_bf16 v97, v249, v249
    v_dot2c_f32_bf16 v96, s75, v250
    v_dot2c_f32_bf16 v97, v250, v250
    v_dot2c_f32_bf16 v96, s75, v251
    v_dot2c_f32_bf16 v97, v251, v251
    v_dot2c_f32_bf16 v96, s75, v252
    v_dot2c_f32_bf16 v97, v252, v252
    v_dot2c_f32_bf16 v96, s75, v253
    v_dot2c_f32_bf16 v97, v253, v253
    v_dot2c_f32_bf16 v96, s75, v254
    v_dot2c_f32_bf16 v97, v254, v254
    v_dot2c_f32_bf16 v96, s75, v255
    v_dot2c_f32_bf16 v97, v255, v255
    v_mov_b32 v6, 4
    v_mov_b32 v16, v120
    v_mov_b32 v17, v121
    v_mov_b32 v18, v122
    v_mov_b32 v19, v123
    v_mov_b32 v20, v124
    v_mov_b32 v21, v125
    v_mov_b32 v22, v126
    v_mov_b32 v23, v127
    s_cmp_gt_i32 s48, 0
    s_cbranch_scc0 NW_1
NWB_2:
    ds_read_b64_tr_b16 v[32:33], v3 offset:0
    ds_read_b64_tr_b16 v[34:35], v3 offset:512
    ds_read_b64_tr_b16 v[36:37], v10 offset:0
    ds_read_b64_tr_b16 v[38:39], v10 offset:512
    ds_read_b64_tr_b16 v[40:41], v3 offset:2048
    ds_read_b64_tr_b16 v[42:43], v3 offset:2560
    ds_read_b64_tr_b16 v[44:45], v10 offset:2048
    ds_read_b64_tr_b16 v[46:47], v10 offset:2560
    ds_read_b64_tr_b16 v[48:49], v3 offset:4096
    ds_read_b64_tr_b16 v[50:51], v3 offset:4608
    ds_read_b64_tr_b16 v[52:53], v10 offset:4096
    ds_read_b64_tr_b16 v[54:55], v10 offset:4608
    s_waitcnt lgkmcnt(10)
    v_mfma_f32_32x32x16_bf16 v[64:79], v[32:35], v[128:131], 0
    ds_read_b64_tr_b16 v[32:33], v3 offset:6144
    ds_read_b64_tr_b16 v[34:35], v3 offset:6656
    v_mov_b32 v56, 0
    v_mov_b32 v60, -1
    v_mov_b32 v57, 0
    v_mov_b32 v61, -1
    v_mov_b32 v58, 0
    v_mov_b32 v62, -1
    v_mov_b32 v59, 0
    v_mov_b32 v63, -1
    v_mov_b32 v100, s68
    s_mov_b64 exec, 1
    buffer_store_dword v56, v100, s[4:7], 0 offen sc1
    s_mov_b64 exec, -1
    v_and_b32 v101, 0x1f0, v0
    v_lshrrev_b32 v103, 9, v0
    v_lshl_or_b32 v101, v103, 19, v101
    s_lshl_b32 s51, s40, 9
    s_add_u32 s51, s51, s82
    buffer_store_dwordx4 v[60:63], v101, s[4:7], s51 offen sc1
    v_and_b32 v102, 0x30, v0
    v_bfe_u32 v103, v0, 6, 1
    v_lshl_or_b32 v102, v103, 16, v102
    s_lshl_b32 s51, s40, 6
    s_add_u32 s51, s51, s83
    s_mov_b64 exec, 0xff
    buffer_store_dwordx4 v[60:63], v102, s[4:7], s51 offen sc1
    s_mov_b64 exec, -1
    s_lshl_b32 s52, s40, 2
    s_add_u32 s52, s52, s45
    s_add_u32 s51, s65, s85
    s_add_u32 s53, s51, 65536
    s_cmp_eq_u32 s52, 63
    s_cselect_b32 s53, s53, 0x70000000
    s_cmp_eq_u32 s52, 0
    s_cselect_b32 s53, s51, s53
    s_add_u32 s51, s51, 32768
    s_add_u32 s51, s51, s61
    s_cmp_eq_u32 s60, 0
    s_cselect_b32 s51, s53, s51
    s_cselect_b32 s52, 0, -1
    v_mov_b32 v56, s52
    v_mov_b32 v57, s52
    v_mov_b32 v58, s52
    v_mov_b32 v59, s52
    s_mov_b32 exec_lo, 0xff0000ff
    s_mov_b32 exec_hi, 0xff0000ff
    buffer_store_dwordx4 v[56:59], v0, s[4:7], s51 offen offset:0 sc1
    buffer_store_dwordx4 v[56:59], v0, s[4:7], s51 offen offset:1024 sc1
    s_add_u32 s51, s51, 196608
    buffer_store_dwordx4 v[56:59], v0, s[4:7], s51 offen offset:0 sc1
    buffer_store_dwordx4 v[56:59], v0, s[4:7], s51 offen offset:1024 sc1
    s_add_u32 s51, s51, 196608
    s_mov_b64 exec, -1
    s_waitcnt lgkmcnt(10)
    v_mfma_f32_32x32x16_bf16 v[80:95], v[36:39], v[128:131], 0
    ds_read_b64_tr_b16 v[36:37], v10 offset:6144
    ds_read_b64_tr_b16 v[38:39], v10 offset:6656
    s_waitcnt lgkmcnt(10)
    v_mfma_f32_32x32x16_bf16 v[64:79], v[40:43], v[132:135], v[64:79]
    ds_read_b64_tr_b16 v[40:41], v3 offset:8192
    ds_read_b64_tr_b16 v[42:43], v3 offset:8704
    s_waitcnt lgkmcnt(10)
    v_mfma_f32_32x32x16_bf16 v[80:95], v[44:47], v[132:135], v[80:95]
    ds_read_b64_tr_b16 v[44:45], v10 offset:8192
    ds_read_b64_tr_b16 v[46:47], v10 offset:8704
    s_waitcnt lgkmcnt(10)
    v_mfma_f32_32x32x16_bf16 v[64:79], v[48:51], v[136:139], v[64:79]
    ds_read_b64_tr_b16 v[48:49], v3 offset:10240
    ds_read_b64_tr_b16 v[50:51], v3 offset:10752
    s_waitcnt lgkmcnt(10)
    v_mfma_f32_32x32x16_bf16 v[80:95], v[52:55], v[136:139], v[80:95]
    ds_read_b64_tr_b16 v[52:53], v10 offset:10240
    ds_read_b64_tr_b16 v[54:55], v10 offset:10752
    s_waitcnt lgkmcnt(10)
    v_mfma_f32_32x32x16_bf16 v[64:79], v[32:35], v[140:143], v[64:79]
    ds_read_b64 v[8:9], v4 offset:32
    ds_read_b64_tr_b16 v[32:33], v3 offset:12288
    ds_read_b64_tr_b16 v[34:35], v3 offset:12800
    s_waitcnt lgkmcnt(11)
    v_mfma_f32_32x32x16_bf16 v[80:95], v[36:39], v[140:143], v[80:95]
    ds_read_b64_tr_b16 v[36:37], v10 offset:12288
    ds_read_b64_tr_b16 v[38:39], v10 offset:12800
    s_waitcnt lgkmcnt(11)
    v_mfma_f32_32x32x16_bf16 v[64:79], v[40:43], v[144:147], v[64:79]
    ds_read_b64_tr_b16 v[40:41], v3 offset:14336
    ds_read_b64_tr_b16 v[42:43], v3 offset:14848
    s_waitcnt lgkmcnt(11)
    v_mfma_f32_32x32x16_bf16 v[80:95], v[44:47], v[144:147], v[80:95]
    ds_read_b64_tr_b16 v[44:45], v10 offset:14336
    ds_read_b64_tr_b16 v[46:47], v10 offset:14848
    s_waitcnt lgkmcnt(11)
    v_mfma_f32_32x32x16_bf16 v[64:79], v[48:51], v[148:151], v[64:79]
    s_waitcnt lgkmcnt(8)
    v_min_u32 v8, v8, v9
    s_nop 0
    v_readfirstlane_b32 s48, v8
    s_nop 1
    s_sub_i32 s48, s48, s49
    s_cmp_gt_i32 s48, 1
    s_cbranch_scc0 NW_3
NWB_4:
    ds_read_b64_tr_b16 v[48:49], v3 offset:16384
    ds_read_b64_tr_b16 v[50:51], v3 offset:16896
    v_mov_b32 v98, v96
    v_mov_b32 v99, v97
    v_mfma_f32_32x32x16_bf16 v[80:95], v[52:55], v[148:151], v[80:95]
    ds_read_b64_tr_b16 v[52:53], v10 offset:16384
    ds_read_b64_tr_b16 v[54:55], v10 offset:16896
    v_permlane32_swap_b32 v96, v98
    v_permlane32_swap_b32 v97, v99
    s_waitcnt lgkmcnt(10)
    v_mfma_f32_32x32x16_bf16 v[64:79], v[32:35], v[152:155], v[64:79]
    ds_read_b64_tr_b16 v[32:33], v3 offset:18432
    ds_read_b64_tr_b16 v[34:35], v3 offset:18944
    v_pk_add_f32 v[96:97], v[96:97], v[98:99]
    v_mul_f32 v26, 0xbb000000, v96
    s_waitcnt lgkmcnt(10)
    v_mfma_f32_32x32x16_bf16 v[80:95], v[36:39], v[152:155], v[80:95]
    ds_read_b64_tr_b16 v[36:37], v10 offset:18432
    ds_read_b64_tr_b16 v[38:39], v10 offset:18944
    v_cvt_pk_bf16_f32 v25, v26, 0
    v_lshlrev_b32 v27, 16, v25
    s_waitcnt lgkmcnt(10)
    v_mfma_f32_32x32x16_bf16 v[64:79], v[40:43], v[156:159], v[64:79]
    ds_read_b64_tr_b16 v[40:41], v3 offset:20480
    ds_read_b64_tr_b16 v[42:43], v3 offset:20992
    v_sub_f32 v27, v26, v27
    v_cvt_pk_bf16_f32 v24, v26, v27
    s_waitcnt lgkmcnt(10)
    v_mfma_f32_32x32x16_bf16 v[80:95], v[44:47], v[156:159], v[80:95]
    ds_read_b64_tr_b16 v[44:45], v10 offset:20480
    ds_read_b64_tr_b16 v[46:47], v10 offset:20992
    v_mov_b32 v26, 0
    v_mov_b32 v27, 0
    s_waitcnt lgkmcnt(10)
    v_mfma_f32_32x32x16_bf16 v[64:79], v[48:51], v[160:163], v[64:79]
    ds_read_b64_tr_b16 v[48:49], v3 offset:22528
    ds_read_b64_tr_b16 v[50:51], v3 offset:23040
    v_lshrrev_b32 v13, 2, v0
    v_add_u32 v13, 160640, v13
    s_waitcnt lgkmcnt(10)
    v_mfma_f32_32x32x16_bf16 v[80:95], v[52:55], v[160:163], v[80:95]
    ds_read_b64_tr_b16 v[52:53], v10 offset:22528
    ds_read_b64_tr_b16 v[54:55], v10 offset:23040
    v_mul_f32 v14, 0x3b000000, v96
    v_mul_f32 v97, 0x3b000000, v97
    s_waitcnt lgkmcnt(10)
    v_mfma_f32_32x32x16_bf16 v[64:79], v[32:35], v[164:167], v[64:79]
    ds_read_b64_tr_b16 v[32:33], v3 offset:24576
    ds_read_b64_tr_b16 v[34:35], v3 offset:25088
    v_fma_f32 v97, -v14, v14, v97
    v_max_f32 v97, 0, v97
    s_waitcnt lgkmcnt(10)
    v_mfma_f32_32x32x16_bf16 v[80:95], v[36:39], v[164:167], v[80:95]
    ds_read_b64_tr_b16 v[36:37], v10 offset:24576
    ds_read_b64_tr_b16 v[38:39], v10 offset:25088
    v_add_f32 v15, 0x3727c5ac, v97
    v_rsq_f32 v15, v15
    s_waitcnt lgkmcnt(10)
    v_mfma_f32_32x32x16_bf16 v[64:79], v[40:43], v[168:171], v[64:79]
    ds_read_b64_tr_b16 v[40:41], v3 offset:26624
    ds_read_b64_tr_b16 v[42:43], v3 offset:27136
    v_mul_f32 v28, 0x3fb8aa3b, v15
    v_bfe_u32 v12, v0, 4, 1
    s_waitcnt lgkmcnt(10)
    v_mfma_f32_32x32x16_bf16 v[80:95], v[44:47], v[168:171], v[80:95]
    ds_read_b64_tr_b16 v[44:45], v10 offset:26624
    ds_read_b64_tr_b16 v[46:47], v10 offset:27136
    v_lshrrev_b32 v98, 9, v0
    v_xor_b32 v98, v98, v12
    s_waitcnt lgkmcnt(10)
    v_mfma_f32_32x32x16_bf16 v[64:79], v[48:51], v[172:175], v[64:79]
    ds_read_b64 v[8:9], v4 offset:32
    ds_read_b64_tr_b16 v[48:49], v3 offset:28672
    ds_read_b64_tr_b16 v[50:51], v3 offset:29184
    v_lshlrev_b32 v12, 9, v12
    v_bfe_u32 v99, v0, 6, 2
    s_waitcnt lgkmcnt(11)
    v_mfma_f32_32x32x16_bf16 v[80:95], v[52:55], v[172:175], v[80:95]
    ds_read_b64_tr_b16 v[52:53], v10 offset:28672
    ds_read_b64_tr_b16 v[54:55], v10 offset:29184
    v_lshl_or_b32 v12, v99, 5, v12
    v_bfe_u32 v99, v0, 8, 1
    s_waitcnt lgkmcnt(11)
    v_mfma_f32_32x32x16_bf16 v[64:79], v[32:35], v[176:179], v[64:79]
    ds_read_b64_tr_b16 v[32:33], v3 offset:30720
    ds_read_b64_tr_b16 v[34:35], v3 offset:31232
    v_lshl_or_b32 v12, v99, 4, v12
    v_bfe_u32 v99, v0, 5, 1
    s_waitcnt lgkmcnt(11)
    v_mfma_f32_32x32x16_bf16 v[80:95], v[36:39], v[176:179], v[80:95]
    ds_read_b64_tr_b16 v[36:37], v10 offset:30720
    ds_read_b64_tr_b16 v[38:39], v10 offset:31232
    v_lshl_or_b32 v12, v99, 3, v12
    v_cmp_eq_u32 vcc, 1, v98
    s_waitcnt lgkmcnt(11)
    v_mfma_f32_32x32x16_bf16 v[64:79], v[40:43], v[180:183], v[64:79]
    s_waitcnt lgkmcnt(8)
    v_min_u32 v8, v8, v9
    s_nop 0
    v_readfirstlane_b32 s48, v8
    s_nop 1
    s_sub_i32 s48, s48, s49
    s_cmp_gt_i32 s48, 2
    s_cbranch_scc0 NW_5
NWB_6:
    ds_read_b64_tr_b16 v[40:41], v3 offset:32768
    ds_read_b64_tr_b16 v[42:43], v3 offset:33280
    v_mov_b32 v99, 1024
    v_cndmask_b32 v12, v12, v99, vcc
    v_mfma_f32_32x32x16_bf16 v[80:95], v[44:47], v[180:183], v[80:95]
    ds_read_b64_tr_b16 v[44:45], v10 offset:32768
    ds_read_b64_tr_b16 v[46:47], v10 offset:33280
    v_add_u32 v12, 155648, v12
    v_bfe_u32 v29, v0, 4, 5
    s_waitcnt lgkmcnt(10)
    v_mfma_f32_32x32x16_bf16 v[64:79], v[48:51], v[184:187], v[64:79]
    ds_read_b64_tr_b16 v[48:49], v3 offset:34816
    ds_read_b64_tr_b16 v[50:51], v3 offset:35328
    v_and_b32 v30, 2, v29
    v_bfe_u32 v98, v29, 3, 1
    s_waitcnt lgkmcnt(10)
    v_mfma_f32_32x32x16_bf16 v[80:95], v[52:55], v[184:187], v[80:95]
    ds_read_b64_tr_b16 v[52:53], v10 offset:34816
    ds_read_b64_tr_b16 v[54:55], v10 offset:35328
    v_or_b32 v30, v30, v98
    v_lshlrev_b32 v29, 7, v29
    s_waitcnt lgkmcnt(10)
    v_mfma_f32_32x32x16_bf16 v[64:79], v[32:35], v[188:191], v[64:79]
    ds_read_b64_tr_b16 v[32:33], v3 offset:36864
    ds_read_b64_tr_b16 v[34:35], v3 offset:37376
    v_lshl_or_b32 v29, v30, 5, v29
    v_lshrrev_b32 v98, 9, v0
    s_waitcnt lgkmcnt(10)
    v_mfma_f32_32x32x16_bf16 v[80:95], v[36:39], v[188:191], v[80:95]
    ds_read_b64_tr_b16 v[36:37], v10 offset:36864
    ds_read_b64_tr_b16 v[38:39], v10 offset:37376
    v_lshlrev_b32 v99, 6, v98
    v_xor_b32 v30, v99, v29
    s_waitcnt lgkmcnt(10)
    v_mfma_f32_32x32x16_bf16 v[64:79], v[40:43], v[192:195], v[64:79]
    ds_read_b64_tr_b16 v[40:41], v3 offset:38912
    ds_read_b64_tr_b16 v[42:43], v3 offset:39424
    v_lshlrev_b32 v99, 5, v98
    v_xor_b32 v29, v99, v29
    s_waitcnt lgkmcnt(10)
    v_mfma_f32_32x32x16_bf16 v[80:95], v[44:47], v[192:195], v[80:95]
    ds_read_b64_tr_b16 v[44:45], v10 offset:38912
    ds_read_b64_tr_b16 v[46:47], v10 offset:39424
    s_lshl_b32 s51, s42, 12
    s_add_u32 s51, s51, 131072
    s_waitcnt lgkmcnt(10)
    v_mfma_f32_32x32x16_bf16 v[64:79], v[48:51], v[196:199], v[64:79]
    ds_read_b64_tr_b16 v[48:49], v3 offset:40960
    ds_read_b64_tr_b16 v[50:51], v3 offset:41472
    v_add_u32 v30, s51, v30
    s_lshl_b32 s51, s77, 6
    s_waitcnt lgkmcnt(10)
    v_mfma_f32_32x32x16_bf16 v[80:95], v[52:55], v[196:199], v[80:95]
    ds_read_b64_tr_b16 v[52:53], v10 offset:40960
    ds_read_b64_tr_b16 v[54:55], v10 offset:41472
    v_xor_b32 v29, s51, v29
    s_lshl_b32 s51, s76, 12
    s_waitcnt lgkmcnt(10)
    v_mfma_f32_32x32x16_bf16 v[64:79], v[32:35], v[200:203], v[64:79]
    ds_read_b64_tr_b16 v[32:33], v3 offset:43008
    ds_read_b64_tr_b16 v[34:35], v3 offset:43520
    s_add_u32 s51, s51, 147456
    v_add_u32 v29, s51, v29
    s_waitcnt lgkmcnt(10)
    v_mfma_f32_32x32x16_bf16 v[80:95], v[36:39], v[200:203], v[80:95]
    ds_read_b64_tr_b16 v[36:37], v10 offset:43008
    ds_read_b64_tr_b16 v[38:39], v10 offset:43520
    v_xor_b32 v31, 32, v30
    s_lshl_b32 s51, s42, 5
    s_waitcnt lgkmcnt(10)
    v_mfma_f32_32x32x16_bf16 v[64:79], v[40:43], v[204:207], v[64:79]
    ds_read_b64 v[8:9], v4 offset:32
    ds_read_b64_tr_b16 v[40:41], v3 offset:45056
    ds_read_b64_tr_b16 v[42:43], v3 offset:45568
    v_xor_b32 v106, s51, v1
    v_add_u32 v106, 131072, v106
    s_waitcnt lgkmcnt(11)
    v_mfma_f32_32x32x16_bf16 v[80:95], v[44:47], v[204:207], v[80:95]
    ds_read_b64_tr_b16 v[44:45], v10 offset:45056
    ds_read_b64_tr_b16 v[46:47], v10 offset:45568
    s_lshl_b32 s51, s77, 5
    v_xor_b32 v107, s51, v1
    s_waitcnt vmcnt(0)
    v_mov_b32 v111, 1
    s_mov_b64 exec, 1
    ds_add_u32 v4, v111 offset:44
    s_mov_b64 exec, -1
    s_waitcnt lgkmcnt(12)
    v_mfma_f32_32x32x16_bf16 v[64:79], v[48:51], v[208:211], v[64:79]
    ds_read_b64_tr_b16 v[48:49], v3 offset:47104
    ds_read_b64_tr_b16 v[50:51], v3 offset:47616
    v_add_u32 v107, 147456, v107
    v_xor_b32 v108, 64, v107
    s_waitcnt lgkmcnt(12)
    v_mfma_f32_32x32x16_bf16 v[80:95], v[52:55], v[208:211], v[80:95]
    ds_read_b64_tr_b16 v[52:53], v10 offset:47104
    ds_read_b64_tr_b16 v[54:55], v10 offset:47616
    v_lshrrev_b32 v109, 1, v0
    v_bfe_u32 v110, v0, 4, 4
    s_waitcnt lgkmcnt(12)
    v_mfma_f32_32x32x16_bf16 v[64:79], v[32:35], v[212:215], v[64:79]
    s_waitcnt lgkmcnt(9)
    v_min_u32 v8, v8, v9
    s_nop 0
    v_readfirstlane_b32 s48, v8
    s_nop 1
    s_sub_i32 s48, s48, s49
    s_cmp_gt_i32 s48, 3
    s_cbranch_scc0 NW_7
NWB_8:
    ds_read_b64_tr_b16 v[32:33], v3 offset:49152
    ds_read_b64_tr_b16 v[34:35], v3 offset:49664
    v_lshlrev_b32 v110, 2, v110
    s_lshl_b32 s72, s40, 9
    v_mfma_f32_32x32x16_bf16 v[80:95], v[36:39], v[212:215], v[80:95]
    ds_read_b64_tr_b16 v[36:37], v10 offset:49152
    ds_read_b64_tr_b16 v[38:39], v10 offset:49664
    s_add_u32 s72, s72, s82
    s_lshl_b32 s73, s40, 6
    s_waitcnt lgkmcnt(11)
    v_mfma_f32_32x32x16_bf16 v[64:79], v[40:43], v[216:219], v[64:79]
    ds_read_b64_tr_b16 v[40:41], v3 offset:51200
    ds_read_b64_tr_b16 v[42:43], v3 offset:51712
    s_add_u32 s73, s73, s83
    s_waitcnt lgkmcnt(11)
    v_mfma_f32_32x32x16_bf16 v[80:95], v[44:47], v[216:219], v[80:95]
    ds_read_b64_tr_b16 v[44:45], v10 offset:51200
    ds_read_b64_tr_b16 v[46:47], v10 offset:51712
    s_waitcnt lgkmcnt(10)
    v_mfma_f32_32x32x16_bf16 v[64:79], v[48:51], v[220:223], v[64:79]
    ds_read_b64_tr_b16 v[48:49], v3 offset:53248
    ds_read_b64_tr_b16 v[50:51], v3 offset:53760
    s_waitcnt lgkmcnt(10)
    v_mfma_f32_32x32x16_bf16 v[80:95], v[52:55], v[220:223], v[80:95]
    ds_read_b64_tr_b16 v[52:53], v10 offset:53248
    ds_read_b64_tr_b16 v[54:55], v10 offset:53760
    s_waitcnt lgkmcnt(10)
    v_mfma_f32_32x32x16_bf16 v[64:79], v[32:35], v[224:227], v[64:79]
    ds_read_b64_tr_b16 v[32:33], v3 offset:55296
    ds_read_b64_tr_b16 v[34:35], v3 offset:55808
    s_waitcnt lgkmcnt(10)
    v_mfma_f32_32x32x16_bf16 v[80:95], v[36:39], v[224:227], v[80:95]
    ds_read_b64_tr_b16 v[36:37], v10 offset:55296
    ds_read_b64_tr_b16 v[38:39], v10 offset:55808
    s_waitcnt lgkmcnt(10)
    v_mfma_f32_32x32x16_bf16 v[64:79], v[40:43], v[228:231], v[64:79]
    ds_read_b64_tr_b16 v[40:41], v3 offset:57344
    ds_read_b64_tr_b16 v[42:43], v3 offset:57856
    s_waitcnt lgkmcnt(10)
    v_mfma_f32_32x32x16_bf16 v[80:95], v[44:47], v[228:231], v[80:95]
    ds_read_b64_tr_b16 v[44:45], v10 offset:57344
    ds_read_b64_tr_b16 v[46:47], v10 offset:57856
    s_waitcnt lgkmcnt(10)
    v_mfma_f32_32x32x16_bf16 v[64:79], v[48:51], v[232:235], v[64:79]
    ds_read_b64_tr_b16 v[48:49], v3 offset:59392
    ds_read_b64_tr_b16 v[50:51], v3 offset:59904
    s_waitcnt lgkmcnt(10)
    v_mfma_f32_32x32x16_bf16 v[80:95], v[52:55], v[232:235], v[80:95]
    ds_read_b64_tr_b16 v[52:53], v10 offset:59392
    ds_read_b64_tr_b16 v[54:55], v10 offset:59904
    s_waitcnt lgkmcnt(10)
    v_mfma_f32_32x32x16_bf16 v[64:79], v[32:35], v[236:239], v[64:79]
    ds_read_b64_tr_b16 v[32:33], v3 offset:61440
    ds_read_b64_tr_b16 v[34:35], v3 offset:61952
    s_waitcnt lgkmcnt(10)
    v_mfma_f32_32x32x16_bf16 v[80:95], v[36:39], v[236:239], v[80:95]
    ds_read_b64_tr_b16 v[36:37], v10 offset:61440
    ds_read_b64_tr_b16 v[38:39], v10 offset:61952
    s_waitcnt lgkmcnt(10)
    v_mfma_f32_32x32x16_bf16 v[64:79], v[40:43], v[240:243], v[64:79]
    ds_read_b64_tr_b16 v[40:41], v3 offset:63488
    ds_read_b64_tr_b16 v[42:43], v3 offset:64000
    s_mov_b32 s55, 0
LW_9:
    ds_read_b32 v100, v4 offset:120
    s_waitcnt lgkmcnt(0)
    v_readfirstlane_b32 s52, v100
    s_nop 1
    s_cmp_ge_u32 s52, 1
    s_cbranch_scc1 LWD_10
    s_add_u32 s55, s55, 1
    s_cmp_lt_u32 s55, 4000000
    s_cbranch_scc1 LW_9
    s_branch ABORT
LWD_10:
    ds_read_b64_tr_b16 v[56:57], v12 offset:0
    ds_read_b64_tr_b16 v[58:59], v12 offset:128
    ds_read_b64_tr_b16 v[60:61], v12 offset:256
    ds_read_b64_tr_b16 v[62:63], v12 offset:384
    s_cmp_eq_u32 s46, 0
    s_cbranch_scc0 CSK_11
    s_mov_b32 s55, 0
LW_12:
    ds_read_b32 v100, v4 offset:68
    s_waitcnt lgkmcnt(0)
    v_readfirstlane_b32 s52, v100
    s_nop 1
    s_cmp_ge_u32 s52, 4
    s_cbranch_scc1 LWD_13
    s_add_u32 s55, s55, 1
    s_cmp_lt_u32 s55, 4000000
    s_cbranch_scc1 LW_12
    s_branch ABORT
LWD_13:
CSK_11:
    ds_read2st64_b32 v[100:101], v13 offset0:0 offset1:1
    ds_read2st64_b32 v[102:103], v13 offset0:2 offset1:3
    v_mfma_f32_32x32x16_bf16 v[80:95], v[44:47], v[240:243], v[80:95]
    ds_read_b64_tr_b16 v[44:45], v10 offset:63488
    ds_read_b64_tr_b16 v[46:47], v10 offset:64000
    v_mfma_f32_32x32x16_bf16 v[64:79], v[48:51], v[244:247], v[64:79]
    v_mfma_f32_32x32x16_bf16 v[80:95], v[52:55], v[244:247], v[80:95]
    v_mfma_f32_32x32x16_bf16 v[64:79], v[32:35], v[248:251], v[64:79]
    s_waitcnt lgkmcnt(2)
    v_mov_b32 v105, 0
    v_add_f32 v101, v100, v101
    v_cvt_pk_bf16_f32 v100, v101, v101
    v_and_b32 v104, 0xffff0000, v100
    v_sub_f32 v101, v101, v104
    v_cvt_pk_bf16_f32 v101, v101, 0
    v_add_f32 v103, v102, v103
    v_cvt_pk_bf16_f32 v102, v103, v103
    v_and_b32 v104, 0xffff0000, v102
    v_sub_f32 v103, v103, v104
    v_cvt_pk_bf16_f32 v103, v103, 0
    v_mfma_f32_32x32x16_bf16 v[80:95], v[36:39], v[248:251], v[80:95]
    s_nop 0
    v_mfma_f32_32x32x16_bf16 v[64:79], v[100:103], v[24:27], v[64:79]
    v_mfma_f32_32x32x16_bf16 v[64:79], v[40:43], v[252:255], v[64:79]
    v_mfma_f32_32x32x16_bf16 v[80:95], v[102:105], v[24:27], v[80:95]
    s_waitcnt lgkmcnt(0)
    v_mfma_f32_32x32x16_bf16 v[80:95], v[44:47], v[252:255], v[80:95]
    ds_write_b32 v5, v6
    s_lshl_b32 s74, s45, 12
    s_lshl_b32 s51, s44, 9
    s_add_u32 s74, s74, s51
    s_lshl_b32 s51, s77, 3
    s_add_u32 s74, s74, s51
    s_add_u32 s74, s74, s67
    s_mov_b32 s8, s34
    s_and_b32 s9, s35, 0xffff
    s_mov_b32 s10, 2097152
    s_mov_b32 s11, 0x20000
    s_branch P1_JOIN
P1_L1:
    buffer_load_dword v113, v112, s[4:7], 0 offen sc1
    s_cmp_gt_i32 s48, 0
    s_cbranch_scc0 NW_17
NWB_18:
    ds_read_b64_tr_b16 v[32:33], v3 offset:0
    ds_read_b64_tr_b16 v[34:35], v3 offset:512
    ds_read_b64_tr_b16 v[36:37], v10 offset:0
    ds_read_b64_tr_b16 v[38:39], v10 offset:512
    ds_read_b64_tr_b16 v[40:41], v3 offset:2048
    ds_read_b64_tr_b16 v[42:43], v3 offset:2560
    ds_read_b64_tr_b16 v[44:45], v10 offset:2048
    ds_read_b64_tr_b16 v[46:47], v10 offset:2560
    ds_read_b64_tr_b16 v[48:49], v3 offset:4096
    ds_read_b64_tr_b16 v[50:51], v3 offset:4608
    ds_read_b64_tr_b16 v[52:53], v10 offset:4096
    ds_read_b64_tr_b16 v[54:55], v10 offset:4608
    s_mov_b32 s55, 0
    s_branch POLLC_15
POLLC_15:
POLL_14:
    buffer_load_dword v114, v112, s[4:7], 0 offen sc1
    s_waitcnt vmcnt(1)
    v_cmp_le_u32 vcc, s54, v113
    s_nop 1
    s_cmp_eq_u64 vcc, -1
    s_cbranch_scc1 POLLD_16
    buffer_load_dword v113, v112, s[4:7], 0 offen sc1
    s_waitcnt vmcnt(1)
    v_cmp_le_u32 vcc, s54, v114
    s_nop 1
    s_cmp_eq_u64 vcc, -1
    s_cbranch_scc1 POLLD_16
    s_add_u32 s55, s55, 1
    s_cmp_lt_u32 s55, 400000
    s_cbranch_scc1 POLL_14
    s_branch ABORT
POLLD_16:
    s_lshl_b32 s51, s42, 12
    s_add_u32 s51, s51, s67
    s_add_u32 s51, s51, 32768
    buffer_load_dwordx4 v[112:115], v0, s[4:7], s51 offen offset:0 sc1
    buffer_load_dwordx4 v[116:119], v0, s[4:7], s51 offen offset:1024 sc1
    buffer_load_dwordx4 v[120:123], v0, s[4:7], s51 offen offset:2048 sc1
    buffer_load_dwordx4 v[124:127], v0, s[4:7], s51 offen offset:3072 sc1
    buffer_load_dwordx4 v[128:131], v0, s[4:7], s71 offen offset:0 sc1
    buffer_load_dwordx4 v[132:135], v0, s[4:7], s71 offen offset:1024 sc1
    buffer_load_dwordx4 v[136:139], v0, s[4:7], s71 offen offset:2048 sc1
    buffer_load_dwordx4 v[140:143], v0, s[4:7], s71 offen offset:3072 sc1
    s_add_u32 s71, s71, 4096
    buffer_load_dwordx4 v[144:147], v0, s[4:7], s71 offen offset:0 sc1
    buffer_load_dwordx4 v[148:151], v0, s[4:7], s71 offen offset:1024 sc1
    buffer_load_dwordx4 v[152:155], v0, s[4:7], s71 offen offset:2048 sc1
    buffer_load_dwordx4 v[156:159], v0, s[4:7], s71 offen offset:3072 sc1
    s_waitcnt vmcnt(7) lgkmcnt(10)
    v_mfma_f32_32x32x16_bf16 v[64:79], v[32:35], v[128:131], 0
    ds_read_b64_tr_b16 v[32:33], v3 offset:6144
    ds_read_b64_tr_b16 v[34:35], v3 offset:6656
    s_add_u32 s71, s71, 4096
    buffer_load_dwordx4 v[160:163], v0, s[4:7], s71 offen offset:0 sc1
    s_waitcnt lgkmcnt(10)
    v_mfma_f32_32x32x16_bf16 v[80:95], v[36:39], v[128:131], 0
    ds_read_b64_tr_b16 v[36:37], v10 offset:6144
    ds_read_b64_tr_b16 v[38:39], v10 offset:6656
    v_pk_add_f32 v[112:113], v[112:113], v[120:121]
    v_pk_add_f32 v[114:115], v[114:115], v[122:123]
    v_pk_add_f32 v[116:117], v[116:117], v[124:125]
    v_pk_add_f32 v[118:119], v[118:119], v[126:127]
    v_pk_add_f32 v[112:113], v[112:113], v[116:117]
    v_pk_add_f32 v[114:115], v[114:115], v[118:119]
    v_pk_add_f32 v[96:97], v[112:113], v[114:115]
    s_waitcnt vmcnt(7) lgkmcnt(10)
    v_mfma_f32_32x32x16_bf16 v[64:79], v[40:43], v[132:135], v[64:79]
    ds_read_b64_tr_b16 v[40:41], v3 offset:8192
    ds_read_b64_tr_b16 v[42:43], v3 offset:8704
    buffer_load_dwordx4 v[164:167], v0, s[4:7], s71 offen offset:1024 sc1
    v_mov_b32 v98, v96
    v_mov_b32 v99, v97
    s_waitcnt lgkmcnt(10)
    v_mfma_f32_32x32x16_bf16 v[80:95], v[44:47], v[132:135], v[80:95]
    ds_read_b64_tr_b16 v[44:45], v10 offset:8192
    ds_read_b64_tr_b16 v[46:47], v10 offset:8704
    v_permlane32_swap_b32 v96, v98
    v_permlane32_swap_b32 v97, v99
    s_waitcnt vmcnt(7) lgkmcnt(10)
    v_mfma_f32_32x32x16_bf16 v[64:79], v[48:51], v[136:139], v[64:79]
    ds_read_b64_tr_b16 v[48:49], v3 offset:10240
    ds_read_b64_tr_b16 v[50:51], v3 offset:10752
    buffer_load_dwordx4 v[168:171], v0, s[4:7], s71 offen offset:2048 sc1
    v_pk_add_f32 v[96:97], v[96:97], v[98:99]
    v_mul_f32 v26, 0xbb000000, v96
    s_waitcnt lgkmcnt(10)
    v_mfma_f32_32x32x16_bf16 v[80:95], v[52:55], v[136:139], v[80:95]
    ds_read_b64_tr_b16 v[52:53], v10 offset:10240
    ds_read_b64_tr_b16 v[54:55], v10 offset:10752
    v_cvt_pk_bf16_f32 v25, v26, 0
    v_lshlrev_b32 v27, 16, v25
    s_waitcnt vmcnt(7) lgkmcnt(10)
    v_mfma_f32_32x32x16_bf16 v[64:79], v[32:35], v[140:143], v[64:79]
    ds_read_b64 v[8:9], v4 offset:32
    ds_read_b64_tr_b16 v[32:33], v3 offset:12288
    ds_read_b64_tr_b16 v[34:35], v3 offset:12800
    buffer_load_dwordx4 v[172:175], v0, s[4:7], s71 offen offset:3072 sc1
    v_sub_f32 v27, v26, v27
    v_cvt_pk_bf16_f32 v24, v26, v27
    s_waitcnt lgkmcnt(11)
    v_mfma_f32_32x32x16_bf16 v[80:95], v[36:39], v[140:143], v[80:95]
    ds_read_b64_tr_b16 v[36:37], v10 offset:12288
    ds_read_b64_tr_b16 v[38:39], v10 offset:12800
    v_mov_b32 v26, 0
    v_mov_b32 v27, 0
    s_waitcnt vmcnt(7) lgkmcnt(11)
    v_mfma_f32_32x32x16_bf16 v[64:79], v[40:43], v[144:147], v[64:79]
    ds_read_b64_tr_b16 v[40:41], v3 offset:14336
    ds_read_b64_tr_b16 v[42:43], v3 offset:14848
    s_add_u32 s71, s71, 4096
    buffer_load_dwordx4 v[176:179], v0, s[4:7], s71 offen offset:0 sc1
    v_lshrrev_b32 v13, 2, v0
    v_add_u32 v13, 160640, v13
    s_waitcnt lgkmcnt(11)
    v_mfma_f32_32x32x16_bf16 v[80:95], v[44:47], v[144:147], v[80:95]
    ds_read_b64_tr_b16 v[44:45], v10 offset:14336
    ds_read_b64_tr_b16 v[46:47], v10 offset:14848
    v_mul_f32 v14, 0x3b000000, v96
    v_mul_f32 v97, 0x3b000000, v97
    s_waitcnt vmcnt(7) lgkmcnt(11)
    v_mfma_f32_32x32x16_bf16 v[64:79], v[48:51], v[148:151], v[64:79]
    s_waitcnt lgkmcnt(8)
    v_min_u32 v8, v8, v9
    s_nop 0
    v_readfirstlane_b32 s48, v8
    s_nop 1
    s_sub_i32 s48, s48, s49
    s_cmp_gt_i32 s48, 1
    s_cbranch_scc0 NW_19
NWB_20:
    ds_read_b64_tr_b16 v[48:49], v3 offset:16384
    ds_read_b64_tr_b16 v[50:51], v3 offset:16896
    buffer_load_dwordx4 v[180:183], v0, s[4:7], s71 offen offset:1024 sc1
    v_fma_f32 v97, -v14, v14, v97
    v_max_f32 v97, 0, v97
    v_mfma_f32_32x32x16_bf16 v[80:95], v[52:55], v[148:151], v[80:95]
    ds_read_b64_tr_b16 v[52:53], v10 offset:16384
    ds_read_b64_tr_b16 v[54:55], v10 offset:16896
    v_add_f32 v15, 0x3727c5ac, v97
    v_rsq_f32 v15, v15
    s_waitcnt vmcnt(7) lgkmcnt(10)
    v_mfma_f32_32x32x16_bf16 v[64:79], v[32:35], v[152:155], v[64:79]
    ds_read_b64_tr_b16 v[32:33], v3 offset:18432
    ds_read_b64_tr_b16 v[34:35], v3 offset:18944
    buffer_load_dwordx4 v[184:187], v0, s[4:7], s71 offen offset:2048 sc1
    v_mul_f32 v28, 0x3fb8aa3b, v15
    v_bfe_u32 v12, v0, 4, 1
    s_waitcnt lgkmcnt(10)
    v_mfma_f32_32x32x16_bf16 v[80:95], v[36:39], v[152:155], v[80:95]
    ds_read_b64_tr_b16 v[36:37], v10 offset:18432
    ds_read_b64_tr_b16 v[38:39], v10 offset:18944
    v_lshrrev_b32 v98, 9, v0
    v_xor_b32 v98, v98, v12
    s_waitcnt vmcnt(7) lgkmcnt(10)
    v_mfma_f32_32x32x16_bf16 v[64:79], v[40:43], v[156:159], v[64:79]
    ds_read_b64_tr_b16 v[40:41], v3 offset:20480
    ds_read_b64_tr_b16 v[42:43], v3 offset:20992
    buffer_load_dwordx4 v[188:191], v0, s[4:7], s71 offen offset:3072 sc1
    v_lshlrev_b32 v12, 9, v12
    v_bfe_u32 v99, v0, 6, 2
    s_waitcnt lgkmcnt(10)
    v_mfma_f32_32x32x16_bf16 v[80:95], v[44:47], v[156:159], v[80:95]
    ds_read_b64_tr_b16 v[44:45], v10 offset:20480
    ds_read_b64_tr_b16 v[46:47], v10 offset:20992
    v_lshl_or_b32 v12, v99, 5, v12
    v_bfe_u32 v99, v0, 8, 1
    s_waitcnt vmcnt(7) lgkmcnt(10)
    v_mfma_f32_32x32x16_bf16 v[64:79], v[48:51], v[160:163], v[64:79]
    ds_read_b64_tr_b16 v[48:49], v3 offset:22528
    ds_read_b64_tr_b16 v[50:51], v3 offset:23040
    s_add_u32 s71, s71, 4096
    buffer_load_dwordx4 v[192:195], v0, s[4:7], s71 offen offset:0 sc1
    v_lshl_or_b32 v12, v99, 4, v12
    v_bfe_u32 v99, v0, 5, 1
    s_waitcnt lgkmcnt(10)
    v_mfma_f32_32x32x16_bf16 v[80:95], v[52:55], v[160:163], v[80:95]
    ds_read_b64_tr_b16 v[52:53], v10 offset:22528
    ds_read_b64_tr_b16 v[54:55], v10 offset:23040
    v_lshl_or_b32 v12, v99, 3, v12
    v_cmp_eq_u32 vcc, 1, v98
    s_waitcnt vmcnt(7) lgkmcnt(10)
    v_mfma_f32_32x32x16_bf16 v[64:79], v[32:35], v[164:167], v[64:79]
    ds_read_b64_tr_b16 v[32:33], v3 offset:24576
    ds_read_b64_tr_b16 v[34:35], v3 offset:25088
    buffer_load_dwordx4 v[196:199], v0, s[4:7], s71 offen offset:1024 sc1
    v_mov_b32 v99, 1024
    v_cndmask_b32 v12, v12, v99, vcc
    s_waitcnt lgkmcnt(10)
    v_mfma_f32_32x32x16_bf16 v[80:95], v[36:39], v[164:167], v[80:95]
    ds_read_b64_tr_b16 v[36:37], v10 offset:24576
    ds_read_b64_tr_b16 v[38:39], v10 offset:25088
    v_add_u32 v12, 155648, v12
    v_bfe_u32 v29, v0, 4, 5
    s_waitcnt vmcnt(7) lgkmcnt(10)
    v_mfma_f32_32x32x16_bf16 v[64:79], v[40:43], v[168:171], v[64:79]
    ds_read_b64_tr_b16 v[40:41], v3 offset:26624
    ds_read_b64_tr_b16 v[42:43], v3 offset:27136
    buffer_load_dwordx4 v[200:203], v0, s[4:7], s71 offen offset:2048 sc1
    v_and_b32 v30, 2, v29
    v_bfe_u32 v98, v29, 3, 1
    s_waitcnt lgkmcnt(10)
    v_mfma_f32_32x32x16_bf16 v[80:95], v[44:47], v[168:171], v[80:95]
    ds_read_b64_tr_b16 v[44:45], v10 offset:26624
    ds_read_b64_tr_b16 v[46:47], v10 offset:27136
    v_or_b32 v30, v30, v98
    v_lshlrev_b32 v29, 7, v29
    s_waitcnt vmcnt(7) lgkmcnt(10)
    v_mfma_f32_32x32x16_bf16 v[64:79], v[48:51], v[172:175], v[64:79]
    ds_read_b64 v[8:9], v4 offset:32
    ds_read_b64_tr_b16 v[48:49], v3 offset:28672
    ds_read_b64_tr_b16 v[50:51], v3 offset:29184
    buffer_load_dwordx4 v[204:207], v0, s[4:7], s71 offen offset:3072 sc1
    v_lshl_or_b32 v29, v30, 5, v29
    v_lshrrev_b32 v98, 9, v0
    s_waitcnt lgkmcnt(11)
    v_mfma_f32_32x32x16_bf16 v[80:95], v[52:55], v[172:175], v[80:95]
    ds_read_b64_tr_b16 v[52:53], v10 offset:28672
    ds_read_b64_tr_b16 v[54:55], v10 offset:29184
    v_lshlrev_b32 v99, 6, v98
    v_xor_b32 v30, v99, v29
    s_waitcnt vmcnt(7) lgkmcnt(11)
    v_mfma_f32_32x32x16_bf16 v[64:79], v[32:35], v[176:179], v[64:79]
    ds_read_b64_tr_b16 v[32:33], v3 offset:30720
    ds_read_b64_tr_b16 v[34:35], v3 offset:31232
    s_add_u32 s71, s71, 4096
    buffer_load_dwordx4 v[208:211], v0, s[4:7], s71 offen offset:0 sc1
    v_lshlrev_b32 v99, 5, v98
    v_xor_b32 v29, v99, v29
    s_waitcnt lgkmcnt(11)
    v_mfma_f32_32x32x16_bf16 v[80:95], v[36:39], v[176:179], v[80:95]
    ds_read_b64_tr_b16 v[36:37], v10 offset:30720
    ds_read_b64_tr_b16 v[38:39], v10 offset:31232
    s_lshl_b32 s51, s42, 12
    s_add_u32 s51, s51, 131072
    s_waitcnt vmcnt(7) lgkmcnt(11)
    v_mfma_f32_32x32x16_bf16 v[64:79], v[40:43], v[180:183], v[64:79]
    s_waitcnt lgkmcnt(8)
    v_min_u32 v8, v8, v9
    s_nop 0
    v_readfirstlane_b32 s48, v8
    s_nop 1
    s_sub_i32 s48, s48, s49
    s_cmp_gt_i32 s48, 2
    s_cbranch_scc0 NW_21
NWB_22:
    ds_read_b64_tr_b16 v[40:41], v3 offset:32768
    ds_read_b64_tr_b16 v[42:43], v3 offset:33280
    buffer_load_dwordx4 v[212:215], v0, s[4:7], s71 offen offset:1024 sc1
    v_add_u32 v30, s51, v30
    s_lshl_b32 s51, s77, 6
    v_mfma_f32_32x32x16_bf16 v[80:95], v[44:47], v[180:183], v[80:95]
    ds_read_b64_tr_b16 v[44:45], v10 offset:32768
    ds_read_b64_tr_b16 v[46:47], v10 offset:33280
    v_xor_b32 v29, s51, v29
    s_lshl_b32 s51, s76, 12
    s_waitcnt vmcnt(7) lgkmcnt(10)
    v_mfma_f32_32x32x16_bf16 v[64:79], v[48:51], v[184:187], v[64:79]
    ds_read_b64_tr_b16 v[48:49], v3 offset:34816
    ds_read_b64_tr_b16 v[50:51], v3 offset:35328
    buffer_load_dwordx4 v[216:219], v0, s[4:7], s71 offen offset:2048 sc1
    s_add_u32 s51, s51, 147456
    v_add_u32 v29, s51, v29
    s_waitcnt lgkmcnt(10)
    v_mfma_f32_32x32x16_bf16 v[80:95], v[52:55], v[184:187], v[80:95]
    ds_read_b64_tr_b16 v[52:53], v10 offset:34816
    ds_read_b64_tr_b16 v[54:55], v10 offset:35328
    v_xor_b32 v31, 32, v30
    s_lshl_b32 s51, s42, 5
    s_waitcnt vmcnt(7) lgkmcnt(10)
    v_mfma_f32_32x32x16_bf16 v[64:79], v[32:35], v[188:191], v[64:79]
    ds_read_b64_tr_b16 v[32:33], v3 offset:36864
    ds_read_b64_tr_b16 v[34:35], v3 offset:37376
    buffer_load_dwordx4 v[220:223], v0, s[4:7], s71 offen offset:3072 sc1
    v_xor_b32 v106, s51, v1
    v_add_u32 v106, 131072, v106
    s_waitcnt lgkmcnt(10)
    v_mfma_f32_32x32x16_bf16 v[80:95], v[36:39], v[188:191], v[80:95]
    ds_read_b64_tr_b16 v[36:37], v10 offset:36864
    ds_read_b64_tr_b16 v[38:39], v10 offset:37376
    s_lshl_b32 s51, s77, 5
    v_xor_b32 v107, s51, v1
    s_waitcnt vmcnt(7) lgkmcnt(10)
    v_mfma_f32_32x32x16_bf16 v[64:79], v[40:43], v[192:195], v[64:79]
    ds_read_b64_tr_b16 v[40:41], v3 offset:38912
    ds_read_b64_tr_b16 v[42:43], v3 offset:39424
    s_add_u32 s71, s71, 4096
    buffer_load_dwordx4 v[224:227], v0, s[4:7], s71 offen offset:0 sc1
    v_add_u32 v107, 147456, v107
    v_xor_b32 v108, 64, v107
    s_waitcnt lgkmcnt(10)
    v_mfma_f32_32x32x16_bf16 v[80:95], v[44:47], v[192:195], v[80:95]
    ds_read_b64_tr_b16 v[44:45], v10 offset:38912
    ds_read_b64_tr_b16 v[46:47], v10 offset:39424
    v_lshrrev_b32 v109, 1, v0
    v_bfe_u32 v110, v0, 4, 4
    s_waitcnt vmcnt(7) lgkmcnt(10)
    v_mfma_f32_32x32x16_bf16 v[64:79], v[48:51], v[196:199], v[64:79]
    ds_read_b64_tr_b16 v[48:49], v3 offset:40960
    ds_read_b64_tr_b16 v[50:51], v3 offset:41472
    buffer_load_dwordx4 v[228:231], v0, s[4:7], s71 offen offset:1024 sc1
    v_lshlrev_b32 v110, 2, v110
    s_lshl_b32 s72, s40, 9
    s_waitcnt lgkmcnt(10)
    v_mfma_f32_32x32x16_bf16 v[80:95], v[52:55], v[196:199], v[80:95]
    ds_read_b64_tr_b16 v[52:53], v10 offset:40960
    ds_read_b64_tr_b16 v[54:55], v10 offset:41472
    s_add_u32 s72, s72, s82
    s_lshl_b32 s73, s40, 6
    s_waitcnt vmcnt(7) lgkmcnt(10)
    v_mfma_f32_32x32x16_bf16 v[64:79], v[32:35], v[200:203], v[64:79]
    ds_read_b64_tr_b16 v[32:33], v3 offset:43008
    ds_read_b64_tr_b16 v[34:35], v3 offset:43520
    buffer_load_dwordx4 v[232:235], v0, s[4:7], s71 offen offset:2048 sc1
    s_add_u32 s73, s73, s83
    s_waitcnt lgkmcnt(10)
    v_mfma_f32_32x32x16_bf16 v[80:95], v[36:39], v[200:203], v[80:95]
    ds_read_b64_tr_b16 v[36:37], v10 offset:43008
    ds_read_b64_tr_b16 v[38:39], v10 offset:43520
    s_waitcnt vmcnt(7) lgkmcnt(10)
    v_mfma_f32_32x32x16_bf16 v[64:79], v[40:43], v[204:207], v[64:79]
    ds_read_b64 v[8:9], v4 offset:32
    ds_read_b64_tr_b16 v[40:41], v3 offset:45056
    ds_read_b64_tr_b16 v[42:43], v3 offset:45568
    buffer_load_dwordx4 v[236:239], v0, s[4:7], s71 offen offset:3072 sc1
    s_waitcnt lgkmcnt(11)
    v_mfma_f32_32x32x16_bf16 v[80:95], v[44:47], v[204:207], v[80:95]
    ds_read_b64_tr_b16 v[44:45], v10 offset:45056
    ds_read_b64_tr_b16 v[46:47], v10 offset:45568
    s_waitcnt vmcnt(7) lgkmcnt(11)
    v_mfma_f32_32x32x16_bf16 v[64:79], v[48:51], v[208:211], v[64:79]
    ds_read_b64_tr_b16 v[48:49], v3 offset:47104
    ds_read_b64_tr_b16 v[50:51], v3 offset:47616
    s_add_u32 s71, s71, 4096
    buffer_load_dwordx4 v[240:243], v0, s[4:7], s71 offen offset:0 sc1
    ds_read_b64_tr_b16 v[56:57], v12 offset:0
    ds_read_b64_tr_b16 v[58:59], v12 offset:128
    ds_read_b64_tr_b16 v[60:61], v12 offset:256
    ds_read_b64_tr_b16 v[62:63], v12 offset:384
    s_waitcnt lgkmcnt(15)
    v_mfma_f32_32x32x16_bf16 v[80:95], v[52:55], v[208:211], v[80:95]
    ds_read_b64_tr_b16 v[52:53], v10 offset:47104
    ds_read_b64_tr_b16 v[54:55], v10 offset:47616
    ds_read2st64_b32 v[100:101], v13 offset0:0 offset1:1
    ds_read2st64_b32 v[102:103], v13 offset0:2 offset1:3
    s_waitcnt vmcnt(7) lgkmcnt(15)
    v_mfma_f32_32x32x16_bf16 v[64:79], v[32:35], v[212:215], v[64:79]
    s_waitcnt lgkmcnt(14)
    v_min_u32 v8, v8, v9
    s_nop 0
    v_readfirstlane_b32 s48, v8
    s_nop 1
    s_sub_i32 s48, s48, s49
    s_cmp_gt_i32 s48, 3
    s_cbranch_scc0 NW_23
NWB_24:
    ds_read_b64_tr_b16 v[32:33], v3 offset:49152
    ds_read_b64_tr_b16 v[34:35], v3 offset:49664
    buffer_load_dwordx4 v[244:247], v0, s[4:7], s71 offen offset:1024 sc1
    v_xor_b32 v113, 8, v5
    ds_read_b32 v112, v113 offset:64
    v_mfma_f32_32x32x16_bf16 v[80:95], v[36:39], v[212:215], v[80:95]
    ds_read_b64_tr_b16 v[36:37], v10 offset:49152
    ds_read_b64_tr_b16 v[38:39], v10 offset:49664
    s_waitcnt vmcnt(7) lgkmcnt(15)
    v_mfma_f32_32x32x16_bf16 v[64:79], v[40:43], v[216:219], v[64:79]
    v_add_u32 v6, 4, v6
    ds_write_b32 v5, v6
    ds_read_b64_tr_b16 v[40:41], v3 offset:51200
    ds_read_b64_tr_b16 v[42:43], v3 offset:51712
    buffer_load_dwordx4 v[248:251], v0, s[4:7], s71 offen offset:2048 sc1
    v_mfma_f32_32x32x16_bf16 v[80:95], v[44:47], v[216:219], v[80:95]
    ds_read_b64_tr_b16 v[44:45], v10 offset:51200
    ds_read_b64_tr_b16 v[46:47], v10 offset:51712
    s_waitcnt vmcnt(7) lgkmcnt(15)
    v_mfma_f32_32x32x16_bf16 v[64:79], v[48:51], v[220:223], v[64:79]
    ds_read_b64_tr_b16 v[48:49], v3 offset:53248
    ds_read_b64_tr_b16 v[50:51], v3 offset:53760
    buffer_load_dwordx4 v[252:255], v0, s[4:7], s71 offen offset:3072 sc1
    s_waitcnt lgkmcnt(14)
    v_mfma_f32_32x32x16_bf16 v[80:95], v[52:55], v[220:223], v[80:95]
    ds_read_b64_tr_b16 v[52:53], v10 offset:53248
    ds_read_b64_tr_b16 v[54:55], v10 offset:53760
    s_waitcnt vmcnt(7) lgkmcnt(12)
    v_mfma_f32_32x32x16_bf16 v[64:79], v[32:35], v[224:227], v[64:79]
    ds_read_b64_tr_b16 v[32:33], v3 offset:55296
    ds_read_b64_tr_b16 v[34:35], v3 offset:55808
    v_mov_b32 v105, 0
    v_add_f32 v101, v100, v101
    v_cvt_pk_bf16_f32 v100, v101, v101
    v_and_b32 v104, 0xffff0000, v100
    v_sub_f32 v101, v101, v104
    v_cvt_pk_bf16_f32 v101, v101, 0
    v_add_f32 v103, v102, v103
    v_cvt_pk_bf16_f32 v102, v103, v103
    v_and_b32 v104, 0xffff0000, v102
    v_sub_f32 v103, v103, v104
    v_cvt_pk_bf16_f32 v103, v103, 0
    s_waitcnt lgkmcnt(11)
    v_mfma_f32_32x32x16_bf16 v[80:95], v[36:39], v[224:227], v[80:95]
    ds_read_b64_tr_b16 v[36:37], v10 offset:55296
    ds_read_b64_tr_b16 v[38:39], v10 offset:55808
    s_waitcnt vmcnt(6) lgkmcnt(10)
    v_mfma_f32_32x32x16_bf16 v[64:79], v[40:43], v[228:231], v[64:79]
    ds_read_b64_tr_b16 v[40:41], v3 offset:57344
    ds_read_b64_tr_b16 v[42:43], v3 offset:57856
    v_readfirstlane_b32 s52, v112
    s_nop 1
    s_cmp_ge_u32 s52, s84
    s_cbranch_scc1 CK_25
    s_mov_b32 s55, 0
LW_26:
    ds_read_b32 v112, v113 offset:64
    s_waitcnt lgkmcnt(0)
    v_readfirstlane_b32 s52, v112
    s_nop 1
    s_cmp_ge_u32 s52, s84
    s_cbranch_scc1 LWD_27
    s_add_u32 s55, s55, 1
    s_cmp_lt_u32 s55, 4000000
    s_cbranch_scc1 LW_26
    s_branch ABORT
LWD_27:
CK_25:
    s_waitcnt lgkmcnt(10)
    v_mfma_f32_32x32x16_bf16 v[80:95], v[44:47], v[228:231], v[80:95]
    ds_read_b64_tr_b16 v[44:45], v10 offset:57344
    ds_read_b64_tr_b16 v[46:47], v10 offset:57856
    s_waitcnt vmcnt(5) lgkmcnt(10)
    v_mfma_f32_32x32x16_bf16 v[64:79], v[48:51], v[232:235], v[64:79]
    ds_read_b64_tr_b16 v[48:49], v3 offset:59392
    ds_read_b64_tr_b16 v[50:51], v3 offset:59904
    s_waitcnt lgkmcnt(10)
    v_mfma_f32_32x32x16_bf16 v[80:95], v[52:55], v[232:235], v[80:95]
    ds_read_b64_tr_b16 v[52:53], v10 offset:59392
    ds_read_b64_tr_b16 v[54:55], v10 offset:59904
    v_mfma_f32_32x32x16_bf16 v[64:79], v[100:103], v[24:27], v[64:79]
    s_waitcnt vmcnt(4) lgkmcnt(10)
    v_mfma_f32_32x32x16_bf16 v[64:79], v[32:35], v[236:239], v[64:79]
    ds_read_b64_tr_b16 v[32:33], v3 offset:61440
    ds_read_b64_tr_b16 v[34:35], v3 offset:61952
    v_mfma_f32_32x32x16_bf16 v[80:95], v[102:105], v[24:27], v[80:95]
    s_waitcnt lgkmcnt(10)
    v_mfma_f32_32x32x16_bf16 v[80:95], v[36:39], v[236:239], v[80:95]
    ds_read_b64_tr_b16 v[36:37], v10 offset:61440
    ds_read_b64_tr_b16 v[38:39], v10 offset:61952
    s_waitcnt vmcnt(3) lgkmcnt(10)
    v_mfma_f32_32x32x16_bf16 v[64:79], v[40:43], v[240:243], v[64:79]
    ds_read_b64_tr_b16 v[40:41], v3 offset:63488
    ds_read_b64_tr_b16 v[42:43], v3 offset:64000
    s_waitcnt lgkmcnt(10)
    v_mfma_f32_32x32x16_bf16 v[80:95], v[44:47], v[240:243], v[80:95]
    ds_read_b64_tr_b16 v[44:45], v10 offset:63488
    ds_read_b64_tr_b16 v[46:47], v10 offset:64000
    s_waitcnt vmcnt(2) lgkmcnt(10)
    v_mfma_f32_32x32x16_bf16 v[64:79], v[48:51], v[244:247], v[64:79]
    s_waitcnt lgkmcnt(8)
    v_mfma_f32_32x32x16_bf16 v[80:95], v[52:55], v[244:247], v[80:95]
    s_waitcnt vmcnt(1) lgkmcnt(6)
    v_mfma_f32_32x32x16_bf16 v[64:79], v[32:35], v[248:251], v[64:79]
    s_waitcnt lgkmcnt(4)
    v_mfma_f32_32x32x16_bf16 v[80:95], v[36:39], v[248:251], v[80:95]
    s_waitcnt vmcnt(0) lgkmcnt(2)
    v_mfma_f32_32x32x16_bf16 v[64:79], v[40:43], v[252:255], v[64:79]
    s_waitcnt lgkmcnt(0)
    v_mfma_f32_32x32x16_bf16 v[80:95], v[44:47], v[252:255], v[80:95]
P1_JOIN:
    s_nop 9
    v_cvt_pk_bf16_f32 v32, v64, v65
    v_cvt_pk_bf16_f32 v33, v66, v67
    v_cvt_pk_bf16_f32 v34, v68, v69
    v_cvt_pk_bf16_f32 v35, v70, v71
    v_cvt_pk_bf16_f32 v36, v72, v73
    v_cvt_pk_bf16_f32 v37, v74, v75
    v_cvt_pk_bf16_f32 v38, v76, v77
    v_cvt_pk_bf16_f32 v39, v78, v79
    v_mfma_f32_32x32x16_bf16 v[112:127], v[56:59], v[32:35], 0
    s_nop 0
    v_mfma_f32_32x32x16_bf16 v[112:127], v[60:63], v[36:39], v[112:127]
    v_pk_mul_f32 v[80:81], v[14:15], v[80:81] op_sel:[1,0] op_sel_hi:[1,1]
    v_pk_mul_f32 v[82:83], v[14:15], v[82:83] op_sel:[1,0] op_sel_hi:[1,1]
    v_pk_mul_f32 v[84:85], v[14:15], v[84:85] op_sel:[1,0] op_sel_hi:[1,1]
    v_pk_mul_f32 v[86:87], v[14:15], v[86:87] op_sel:[1,0] op_sel_hi:[1,1]
    v_pk_mul_f32 v[88:89], v[14:15], v[88:89] op_sel:[1,0] op_sel_hi:[1,1]
    v_pk_mul_f32 v[90:91], v[14:15], v[90:91] op_sel:[1,0] op_sel_hi:[1,1]
    v_pk_mul_f32 v[92:93], v[14:15], v[92:93] op_sel:[1,0] op_sel_hi:[1,1]
    v_pk_mul_f32 v[94:95], v[14:15], v[94:95] op_sel:[1,0] op_sel_hi:[1,1]
    v_cvt_pk_bf16_f32 v40, v80, v81
    v_cvt_pk_bf16_f32 v41, v82, v83
    v_cvt_pk_bf16_f32 v42, v84, v85
    v_cvt_pk_bf16_f32 v43, v86, v87
    v_cvt_pk_bf16_f32 v44, v88, v89
    v_cvt_pk_bf16_f32 v45, v90, v91
    v_cvt_pk_bf16_f32 v46, v92, v93
    v_cvt_pk_bf16_f32 v47, v94, v95
    ds_write_b128 v29, v[40:43]
    ds_write_b128 v29, v[44:47] offset:16
    v_max3_f32 v96, v112, v113, v114
    v_max3_f32 v97, v115, v116, v117
    v_max3_f32 v98, v118, v119, v120
    v_max3_f32 v99, v121, v122, v123
    v_max3_f32 v100, v124, v125, v126
    v_min3_f32 v101, v112, v113, v114
    v_min3_f32 v102, v115, v116, v117
    v_min3_f32 v103, v118, v119, v120
    v_min3_f32 v104, v121, v122, v123
    v_min3_f32 v105, v124, v125, v126
    v_max3_f32 v96, v96, v97, v127
    v_max3_f32 v98, v98, v99, v100
    v_min3_f32 v101, v101, v102, v127
    v_min3_f32 v103, v103, v104, v105
    v_max_f32 v96, v96, v98
    v_min_f32 v98, v101, v103
    v_mul_f32 v96, -v96, v28
    v_mul_f32 v98, v98, v28
    v_pk_fma_f32 v[64:65], v[112:113], v[28:29], v[98:99] op_sel_hi:[1,0,0] neg_lo:[1,0,0] neg_hi:[1,0,0]
    v_pk_fma_f32 v[112:113], v[112:113], v[28:29], v[96:97] op_sel:[0,0,0] op_sel_hi:[1,0,0]
    v_pk_fma_f32 v[66:67], v[114:115], v[28:29], v[98:99] op_sel_hi:[1,0,0] neg_lo:[1,0,0] neg_hi:[1,0,0]
    v_exp_f32 v64, v64
    v_pk_fma_f32 v[114:115], v[114:115], v[28:29], v[96:97] op_sel:[0,0,0] op_sel_hi:[1,0,0]
    v_exp_f32 v65, v65
    v_pk_fma_f32 v[68:69], v[116:117], v[28:29], v[98:99] op_sel_hi:[1,0,0] neg_lo:[1,0,0] neg_hi:[1,0,0]
    v_exp_f32 v112, v112
    v_pk_fma_f32 v[116:117], v[116:117], v[28:29], v[96:97] op_sel:[0,0,0] op_sel_hi:[1,0,0]
    v_exp_f32 v113, v113
    v_pk_fma_f32 v[70:71], v[118:119], v[28:29], v[98:99] op_sel_hi:[1,0,0] neg_lo:[1,0,0] neg_hi:[1,0,0]
    v_exp_f32 v66, v66
    v_pk_fma_f32 v[118:119], v[118:119], v[28:29], v[96:97] op_sel:[0,0,0] op_sel_hi:[1,0,0]
    v_exp_f32 v67, v67
    v_pk_fma_f32 v[72:73], v[120:121], v[28:29], v[98:99] op_sel_hi:[1,0,0] neg_lo:[1,0,0] neg_hi:[1,0,0]
    v_exp_f32 v114, v114
    v_pk_fma_f32 v[120:121], v[120:121], v[28:29], v[96:97] op_sel:[0,0,0] op_sel_hi:[1,0,0]
    v_exp_f32 v115, v115
    v_pk_fma_f32 v[74:75], v[122:123], v[28:29], v[98:99] op_sel_hi:[1,0,0] neg_lo:[1,0,0] neg_hi:[1,0,0]
    v_exp_f32 v68, v68
    v_pk_fma_f32 v[122:123], v[122:123], v[28:29], v[96:97] op_sel:[0,0,0] op_sel_hi:[1,0,0]
    v_exp_f32 v69, v69
    v_pk_fma_f32 v[76:77], v[124:125], v[28:29], v[98:99] op_sel_hi:[1,0,0] neg_lo:[1,0,0] neg_hi:[1,0,0]
    v_exp_f32 v116, v116
    v_pk_fma_f32 v[124:125], v[124:125], v[28:29], v[96:97] op_sel:[0,0,0] op_sel_hi:[1,0,0]
    v_exp_f32 v117, v117
    v_pk_fma_f32 v[78:79], v[126:127], v[28:29], v[98:99] op_sel_hi:[1,0,0] neg_lo:[1,0,0] neg_hi:[1,0,0]
    v_exp_f32 v70, v70
    v_pk_fma_f32 v[126:127], v[126:127], v[28:29], v[96:97] op_sel:[0,0,0] op_sel_hi:[1,0,0]
    v_exp_f32 v71, v71
    v_pk_add_f32 v[102:103], v[64:65], v[66:67]
    v_exp_f32 v118, v118
    v_pk_add_f32 v[98:99], v[112:113], v[114:115]
    v_exp_f32 v119, v119
    v_exp_f32 v72, v72
    v_pk_add_f32 v[104:105], v[68:69], v[70:71]
    v_exp_f32 v73, v73
    v_pk_add_f32 v[100:101], v[116:117], v[118:119]
    v_exp_f32 v120, v120
    v_exp_f32 v121, v121
    v_exp_f32 v74, v74
    v_pk_add_f32 v[102:103], v[102:103], v[72:73]
    v_exp_f32 v75, v75
    v_pk_add_f32 v[98:99], v[98:99], v[120:121]
    v_exp_f32 v122, v122
    v_exp_f32 v123, v123
    v_exp_f32 v76, v76
    v_pk_add_f32 v[104:105], v[104:105], v[74:75]
    v_exp_f32 v77, v77
    v_pk_add_f32 v[100:101], v[100:101], v[122:123]
    v_exp_f32 v124, v124
    v_exp_f32 v125, v125
    v_exp_f32 v78, v78
    v_pk_add_f32 v[102:103], v[102:103], v[76:77]
    v_exp_f32 v79, v79
    v_pk_add_f32 v[98:99], v[98:99], v[124:125]
    v_exp_f32 v126, v126
    v_exp_f32 v127, v127
    v_pk_add_f32 v[104:105], v[104:105], v[78:79]
    v_pk_add_f32 v[100:101], v[100:101], v[126:127]
    v_pk_add_f32 v[98:99], v[98:99], v[100:101]
    v_pk_add_f32 v[102:103], v[102:103], v[104:105]
    v_add_f32 v96, v98, v99
    v_add_f32 v97, v102, v103
    v_rcp_f32 v96, v96
    v_rcp_f32 v97, v97
    s_nop 0
    v_pk_mul_f32 v[112:113], v[112:113], v[96:97] op_sel_hi:[1,0]
    v_pk_mul_f32 v[114:115], v[114:115], v[96:97] op_sel_hi:[1,0]
    v_pk_mul_f32 v[116:117], v[116:117], v[96:97] op_sel_hi:[1,0]
    v_pk_mul_f32 v[118:119], v[118:119], v[96:97] op_sel_hi:[1,0]
    v_pk_mul_f32 v[120:121], v[120:121], v[96:97] op_sel_hi:[1,0]
    v_pk_mul_f32 v[122:123], v[122:123], v[96:97] op_sel_hi:[1,0]
    v_pk_mul_f32 v[124:125], v[124:125], v[96:97] op_sel_hi:[1,0]
    v_pk_mul_f32 v[126:127], v[126:127], v[96:97] op_sel_hi:[1,0]
    v_cvt_pk_bf16_f32 v80, v112, v113
    v_cvt_pk_bf16_f32 v81, v114, v115
    v_cvt_pk_bf16_f32 v82, v116, v117
    v_cvt_pk_bf16_f32 v83, v118, v119
    v_cvt_pk_bf16_f32 v84, v120, v121
    v_cvt_pk_bf16_f32 v85, v122, v123
    v_cvt_pk_bf16_f32 v86, v124, v125
    v_cvt_pk_bf16_f32 v87, v126, v127
    ds_write_b128 v30, v[80:83]
    ds_write_b128 v30, v[84:87] offset:16
    v_pk_mul_f32 v[64:65], v[96:97], v[64:65] op_sel:[1,0] op_sel_hi:[1,1]
    v_pk_mul_f32 v[66:67], v[96:97], v[66:67] op_sel:[1,0] op_sel_hi:[1,1]
    v_pk_mul_f32 v[68:69], v[96:97], v[68:69] op_sel:[1,0] op_sel_hi:[1,1]
    v_pk_mul_f32 v[70:71], v[96:97], v[70:71] op_sel:[1,0] op_sel_hi:[1,1]
    v_pk_mul_f32 v[72:73], v[96:97], v[72:73] op_sel:[1,0] op_sel_hi:[1,1]
    v_pk_mul_f32 v[74:75], v[96:97], v[74:75] op_sel:[1,0] op_sel_hi:[1,1]
    v_pk_mul_f32 v[76:77], v[96:97], v[76:77] op_sel:[1,0] op_sel_hi:[1,1]
    v_pk_mul_f32 v[78:79], v[96:97], v[78:79] op_sel:[1,0] op_sel_hi:[1,1]
    v_cvt_pk_bf16_f32 v88, v64, v65
    v_cvt_pk_bf16_f32 v89, v66, v67
    v_cvt_pk_bf16_f32 v90, v68, v69
    v_cvt_pk_bf16_f32 v91, v70, v71
    v_cvt_pk_bf16_f32 v92, v72, v73
    v_cvt_pk_bf16_f32 v93, v74, v75
    v_cvt_pk_bf16_f32 v94, v76, v77
    v_cvt_pk_bf16_f32 v95, v78, v79
    ds_write_b128 v31, v[88:91]
    ds_write_b128 v31, v[92:95] offset:16
    s_add_u32 s70, s70, 1
    v_mov_b32 v8, s70
    ds_write_b32 v5, v8 offset:32
    v_mov_b32 v96, s75
    v_mov_b32 v97, s75
    v_mov_b32 v98, s75
    v_mov_b32 v99, s75
    s_mov_b32 s55, 0
SY_28:
    ds_read_b128 v[100:103], v4 offset:48
    s_waitcnt lgkmcnt(0)
    v_min3_u32 v100, v100, v101, v102
    v_min_u32 v100, v100, v103
    s_nop 0
    v_readfirstlane_b32 s52, v100
    s_nop 1
    s_cmp_ge_u32 s52, s70
    s_cbranch_scc1 SYD_29
    s_add_u32 s55, s55, 1
    s_cmp_lt_u32 s55, 4000000
    s_cbranch_scc1 SY_28
    s_branch ABORT
SYD_29:
    ds_read_b64_tr_b16 v[64:65], v106 offset:0
    ds_read_b64_tr_b16 v[66:67], v106 offset:512
    ds_read_b64_tr_b16 v[112:113], v107 offset:0
    ds_read_b64_tr_b16 v[114:115], v107 offset:512
    ds_read_b64_tr_b16 v[68:69], v106 offset:4096
    ds_read_b64_tr_b16 v[70:71], v106 offset:4608
    ds_read_b64_tr_b16 v[116:117], v107 offset:4096
    ds_read_b64_tr_b16 v[118:119], v107 offset:4608
    ds_read_b64_tr_b16 v[72:73], v106 offset:8192
    ds_read_b64_tr_b16 v[74:75], v106 offset:8704
    ds_read_b64_tr_b16 v[120:121], v108 offset:0
    ds_read_b64_tr_b16 v[122:123], v108 offset:512
    ds_read_b64_tr_b16 v[76:77], v106 offset:12288
    ds_read_b64_tr_b16 v[78:79], v106 offset:12800
    ds_read_b64_tr_b16 v[124:125], v108 offset:4096
    ds_read_b64_tr_b16 v[126:127], v108 offset:4608
    s_waitcnt lgkmcnt(12)
    v_mfma_f32_16x16x32_bf16 v[80:83], v[64:67], v[112:115], 0
    v_mfma_f32_16x16x32_bf16 v[84:87], v[96:99], v[64:67], 0
    s_waitcnt lgkmcnt(8)
    v_mfma_f32_16x16x32_bf16 v[80:83], v[68:71], v[116:119], v[80:83]
    v_mfma_f32_16x16x32_bf16 v[84:87], v[96:99], v[68:71], v[84:87]
    s_waitcnt lgkmcnt(4)
    v_mfma_f32_16x16x32_bf16 v[80:83], v[72:75], v[120:123], v[80:83]
    v_mfma_f32_16x16x32_bf16 v[84:87], v[96:99], v[72:75], v[84:87]
    s_waitcnt lgkmcnt(0)
    v_mfma_f32_16x16x32_bf16 v[80:83], v[76:79], v[124:127], v[80:83]
    v_mfma_f32_16x16x32_bf16 v[84:87], v[96:99], v[76:79], v[84:87]
    s_nop 6
    v_cvt_pk_bf16_f32 v80, v80, v81
    v_cvt_pk_bf16_f32 v81, v82, v83
    v_min_u32 v80, -2, v80
    v_min_u32 v81, -2, v81
    v_min_u32 v84, -2, v84
    buffer_store_dwordx2 v[80:81], v109, s[4:7], s72 offen sc1
    buffer_store_dword v84, v110, s[4:7], s73 offen sc1
    s_mov_b64 exec, 1
    s_lshl_b32 s97, s50, 1
    s_add_u32 s97, s97, 1
    v_mov_b32 v85, s97
    ds_max_u32 v4, v85 offset:72
    s_mov_b64 exec, -1
    v_add_u32 v6, 2, v6
    ds_write_b32 v5, v6
    v_xor_b32 v10, 0x10000, v3
    v_xor_b32 v11, 0x10040, v3
    s_cmp_gt_i32 s48, 4
    s_cbranch_scc0 NW_30
NWB_31:
    ds_read_b64_tr_b16 v[32:33], v10 offset:0
    ds_read_b64_tr_b16 v[34:35], v10 offset:512
    ds_read_b64_tr_b16 v[36:37], v10 offset:2048
    ds_read_b64_tr_b16 v[38:39], v10 offset:2560
    ds_read_b64_tr_b16 v[40:41], v10 offset:4096
    ds_read_b64_tr_b16 v[42:43], v10 offset:4608
    ds_read_b64_tr_b16 v[44:45], v10 offset:6144
    ds_read_b64_tr_b16 v[46:47], v10 offset:6656
    ds_read_b64_tr_b16 v[48:49], v10 offset:8192
    ds_read_b64_tr_b16 v[50:51], v10 offset:8704
    ds_read_b64_tr_b16 v[52:53], v10 offset:10240
    ds_read_b64_tr_b16 v[54:55], v10 offset:10752
    s_waitcnt lgkmcnt(10)
    v_mfma_f32_32x32x16_bf16 v[64:79], v[32:35], v[128:131], 0
    ds_read_b64_tr_b16 v[32:33], v10 offset:12288
    ds_read_b64_tr_b16 v[34:35], v10 offset:12800
    s_waitcnt lgkmcnt(10)
    v_mfma_f32_32x32x16_bf16 v[64:79], v[36:39], v[132:135], v[64:79]
    ds_read_b64_tr_b16 v[36:37], v10 offset:14336
    ds_read_b64_tr_b16 v[38:39], v10 offset:14848
    v_lshrrev_b32 v125, 9, v0
    s_lshl_b32 s51, s42, 5
    s_waitcnt lgkmcnt(10)
    v_mfma_f32_32x32x16_bf16 v[64:79], v[40:43], v[136:139], v[64:79]
    ds_read_b64_tr_b16 v[40:41], v11 offset:0
    ds_read_b64_tr_b16 v[42:43], v11 offset:512
    s_add_u32 s51, s51, 160256
    v_lshrrev_b32 v117, 1, v110
    s_waitcnt lgkmcnt(10)
    v_mfma_f32_32x32x16_bf16 v[64:79], v[44:47], v[140:143], v[64:79]
    ds_read_b64_tr_b16 v[44:45], v11 offset:2048
    ds_read_b64_tr_b16 v[46:47], v11 offset:2560
    v_add_u32 v117, s51, v117
    v_bfe_u32 v118, v0, 4, 3
    s_waitcnt lgkmcnt(10)
    v_mfma_f32_32x32x16_bf16 v[64:79], v[48:51], v[144:147], v[64:79]
    ds_read_b64_tr_b16 v[48:49], v11 offset:4096
    ds_read_b64_tr_b16 v[50:51], v11 offset:4608
    v_lshl_or_b32 v118, v118, 1, v125
    v_bfe_u32 v126, v0, 7, 2
    s_waitcnt lgkmcnt(10)
    v_mfma_f32_32x32x16_bf16 v[64:79], v[52:55], v[148:151], v[64:79]
    ds_read_b64_tr_b16 v[52:53], v11 offset:6144
    ds_read_b64_tr_b16 v[54:55], v11 offset:6656
    v_mul_u32_u24 v118, 80, v118
    v_lshl_add_u32 v118, v126, 3, v118
    s_waitcnt lgkmcnt(10)
    v_mfma_f32_32x32x16_bf16 v[64:79], v[32:35], v[152:155], v[64:79]
    ds_read_b64 v[8:9], v4 offset:32
    ds_read_b64_tr_b16 v[32:33], v11 offset:8192
    ds_read_b64_tr_b16 v[34:35], v11 offset:8704
    s_mul_i32 s51, s77, 1280
    s_lshl_b32 s53, s76, 5
    s_waitcnt lgkmcnt(11)
    v_mfma_f32_32x32x16_bf16 v[64:79], v[36:39], v[156:159], v[64:79]
    ds_read_b64_tr_b16 v[36:37], v11 offset:10240
    ds_read_b64_tr_b16 v[38:39], v11 offset:10752
    s_add_u32 s51, s51, s53
    s_add_u32 s51, s51, 157696
    s_waitcnt lgkmcnt(11)
    v_mfma_f32_32x32x16_bf16 v[64:79], v[40:43], v[160:163], v[64:79]
    ds_read_b64_tr_b16 v[40:41], v11 offset:12288
    ds_read_b64_tr_b16 v[42:43], v11 offset:12800
    v_add_u32 v118, s51, v118
    v_bfe_u32 v122, v0, 8, 1
    s_waitcnt lgkmcnt(11)
    v_mfma_f32_32x32x16_bf16 v[64:79], v[44:47], v[164:167], v[64:79]
    ds_read_b64_tr_b16 v[44:45], v11 offset:14336
    ds_read_b64_tr_b16 v[46:47], v11 offset:14848
    v_bfe_u32 v123, v0, 6, 1
    v_bfe_u32 v124, v0, 7, 1
    s_waitcnt lgkmcnt(11)
    v_mfma_f32_32x32x16_bf16 v[64:79], v[48:51], v[168:171], v[64:79]
    s_waitcnt lgkmcnt(8)
    v_min_u32 v8, v8, v9
    s_nop 0
    v_readfirstlane_b32 s48, v8
    s_nop 1
    s_sub_i32 s48, s48, s49
    s_cmp_gt_i32 s48, 5
    s_cbranch_scc0 NW_32
NWB_33:
    ds_read_b64_tr_b16 v[48:49], v10 offset:16384
    ds_read_b64_tr_b16 v[50:51], v10 offset:16896
    v_bfe_u32 v119, v0, 4, 2
    v_lshl_or_b32 v119, v123, 3, v119
    v_mfma_f32_32x32x16_bf16 v[64:79], v[52:55], v[172:175], v[64:79]
    ds_read_b64_tr_b16 v[52:53], v10 offset:18432
    ds_read_b64_tr_b16 v[54:55], v10 offset:18944
    v_lshl_or_b32 v119, v124, 2, v119
    v_lshl_or_b32 v119, v122, 4, v119
    s_waitcnt lgkmcnt(10)
    v_mfma_f32_32x32x16_bf16 v[64:79], v[32:35], v[176:179], v[64:79]
    ds_read_b64_tr_b16 v[32:33], v10 offset:20480
    ds_read_b64_tr_b16 v[34:35], v10 offset:20992
    v_mul_u32_u24 v119, 80, v119
    v_add_u32 v119, 157696, v119
    s_waitcnt lgkmcnt(10)
    v_mfma_f32_32x32x16_bf16 v[64:79], v[36:39], v[180:183], v[64:79]
    ds_read_b64_tr_b16 v[36:37], v10 offset:22528
    ds_read_b64_tr_b16 v[38:39], v10 offset:23040
    v_cmp_eq_u32 vcc, v122, v125
    v_mov_b32 v123, 160384
    s_waitcnt lgkmcnt(10)
    v_mfma_f32_32x32x16_bf16 v[64:79], v[40:43], v[184:187], v[64:79]
    ds_read_b64_tr_b16 v[40:41], v10 offset:24576
    ds_read_b64_tr_b16 v[42:43], v10 offset:25088
    v_lshlrev_b32 v120, 6, v125
    v_add_u32 v120, 160256, v120
    s_waitcnt lgkmcnt(10)
    v_mfma_f32_32x32x16_bf16 v[64:79], v[44:47], v[188:191], v[64:79]
    ds_read_b64_tr_b16 v[44:45], v10 offset:26624
    ds_read_b64_tr_b16 v[46:47], v10 offset:27136
    v_cndmask_b32 v119, v123, v119, vcc
    v_lshrrev_b32 v121, 2, v0
    s_waitcnt lgkmcnt(10)
    v_mfma_f32_32x32x16_bf16 v[64:79], v[48:51], v[192:195], v[64:79]
    ds_read_b64_tr_b16 v[48:49], v10 offset:28672
    ds_read_b64_tr_b16 v[50:51], v10 offset:29184
    v_add_u32 v13, 1024, v13
    s_waitcnt lgkmcnt(10)
    v_mfma_f32_32x32x16_bf16 v[64:79], v[52:55], v[196:199], v[64:79]
    ds_read_b64_tr_b16 v[52:53], v10 offset:30720
    ds_read_b64_tr_b16 v[54:55], v10 offset:31232
    s_waitcnt lgkmcnt(10)
    v_mfma_f32_32x32x16_bf16 v[64:79], v[32:35], v[200:203], v[64:79]
    ds_read_b64_tr_b16 v[32:33], v11 offset:16384
    ds_read_b64_tr_b16 v[34:35], v11 offset:16896
    s_waitcnt lgkmcnt(10)
    v_mfma_f32_32x32x16_bf16 v[64:79], v[36:39], v[204:207], v[64:79]
    ds_read_b64_tr_b16 v[36:37], v11 offset:18432
    ds_read_b64_tr_b16 v[38:39], v11 offset:18944
    s_waitcnt lgkmcnt(10)
    v_mfma_f32_32x32x16_bf16 v[64:79], v[40:43], v[208:211], v[64:79]
    ds_read_b64_tr_b16 v[40:41], v11 offset:20480
    ds_read_b64_tr_b16 v[42:43], v11 offset:20992
    s_waitcnt lgkmcnt(10)
    v_mfma_f32_32x32x16_bf16 v[64:79], v[44:47], v[212:215], v[64:79]
    ds_read_b64_tr_b16 v[44:45], v11 offset:22528
    ds_read_b64_tr_b16 v[46:47], v11 offset:23040
    s_waitcnt lgkmcnt(10)
    v_mfma_f32_32x32x16_bf16 v[64:79], v[48:51], v[216:219], v[64:79]
    ds_read_b64_tr_b16 v[48:49], v11 offset:24576
    ds_read_b64_tr_b16 v[50:51], v11 offset:25088
    s_waitcnt lgkmcnt(10)
    v_mfma_f32_32x32x16_bf16 v[64:79], v[52:55], v[220:223], v[64:79]
    ds_read_b64_tr_b16 v[52:53], v11 offset:26624
    ds_read_b64_tr_b16 v[54:55], v11 offset:27136
    s_waitcnt lgkmcnt(10)
    v_mfma_f32_32x32x16_bf16 v[64:79], v[32:35], v[224:227], v[64:79]
    ds_read_b64_tr_b16 v[32:33], v11 offset:28672
    ds_read_b64_tr_b16 v[34:35], v11 offset:29184
    s_cmp_eq_u32 s46, 0
    s_cbranch_scc0 CSK_34
    s_mov_b32 s55, 0
LW_35:
    ds_read_b32 v100, v4 offset:40
    s_waitcnt lgkmcnt(0)
    v_readfirstlane_b32 s52, v100
    s_nop 1
    s_cmp_ge_u32 s52, 4
    s_cbranch_scc1 LWD_36
    s_add_u32 s55, s55, 1
    s_cmp_lt_u32 s55, 4000000
    s_cbranch_scc1 LW_35
    s_branch ABORT
LWD_36:
CSK_34:
    ds_read2st64_b32 v[100:101], v13 offset0:0 offset1:1
    s_waitcnt lgkmcnt(11)
    v_mfma_f32_32x32x16_bf16 v[64:79], v[36:39], v[228:231], v[64:79]
    ds_read_b64_tr_b16 v[36:37], v11 offset:30720
    ds_read_b64_tr_b16 v[38:39], v11 offset:31232
    s_waitcnt lgkmcnt(11)
    v_mfma_f32_32x32x16_bf16 v[64:79], v[40:43], v[232:235], v[64:79]
    s_waitcnt lgkmcnt(9)
    v_mfma_f32_32x32x16_bf16 v[64:79], v[44:47], v[236:239], v[64:79]
    s_waitcnt lgkmcnt(7)
    v_mfma_f32_32x32x16_bf16 v[64:79], v[48:51], v[240:243], v[64:79]
    s_waitcnt lgkmcnt(2)
    v_mov_b32 v103, 0
    v_add_f32 v101, v100, v101
    v_cvt_pk_bf16_f32 v100, v101, v101
    v_and_b32 v102, 0xffff0000, v100
    v_sub_f32 v101, v101, v102
    v_cvt_pk_bf16_f32 v101, v101, 0
    v_mfma_f32_32x32x16_bf16 v[64:79], v[52:55], v[244:247], v[64:79]
    v_mfma_f32_32x32x16_bf16 v[64:79], v[32:35], v[248:251], v[64:79]
    v_mfma_f32_32x32x16_bf16 v[64:79], v[100:103], v[24:27], v[64:79]
    s_waitcnt lgkmcnt(0)
    v_mfma_f32_32x32x16_bf16 v[64:79], v[36:39], v[252:255], v[64:79]
    v_add_u32 v6, 2, v6
    ds_write_b32 v5, v6
    s_nop 9
    v_cvt_pk_bf16_f32 v48, v64, v65
    v_cvt_pk_bf16_f32 v49, v66, v67
    v_cvt_pk_bf16_f32 v50, v68, v69
    v_cvt_pk_bf16_f32 v51, v70, v71
    v_cvt_pk_bf16_f32 v52, v72, v73
    v_cvt_pk_bf16_f32 v53, v74, v75
    v_cvt_pk_bf16_f32 v54, v76, v77
    v_cvt_pk_bf16_f32 v55, v78, v79
    v_mfma_f32_32x32x16_bf16 v[144:159], v[56:59], v[48:51], 0
    s_nop 0
    v_mfma_f32_32x32x16_bf16 v[144:159], v[60:63], v[52:55], v[144:159]
    s_mul_i32 s51, s77, 8256
    s_add_u32 s51, s51, 65536
    v_xor_b32 v10, s51, v2
    v_xor_b32 v11, 64, v10
    s_mov_b32 s62, 0
    s_mov_b32 s54, 0
    s_cmp_eq_u32 s46, 0
    s_cbranch_scc0 GATHER
    ds_read_b32 v8, v4 offset:64
    s_waitcnt lgkmcnt(0)
    v_readfirstlane_b32 s47, v8
    s_nop 1
    s_cmp_ge_u32 s47, 2
    s_cbranch_scc1 GATHER
    s_mov_b32 s62, 2
    s_branch GWORK
GATHER:
    s_add_u32 s71, s82, 4096
    buffer_load_dword v44, v121, s[4:7], s83 offen offset:0 sc1
    buffer_load_dword v45, v121, s[4:7], s83 offen offset:256 sc1
    buffer_load_dword v46, v121, s[4:7], s83 offen offset:512 sc1
    buffer_load_dword v47, v121, s[4:7], s83 offen offset:768 sc1
    buffer_load_dwordx4 v[64:67], v0, s[4:7], s82 offen offset:0 sc1
    buffer_load_dwordx4 v[68:71], v0, s[4:7], s82 offen offset:1024 sc1
    buffer_load_dwordx4 v[72:75], v0, s[4:7], s82 offen offset:2048 sc1
    buffer_load_dwordx4 v[76:79], v0, s[4:7], s82 offen offset:3072 sc1
    buffer_load_dwordx4 v[80:83], v0, s[4:7], s71 offen offset:0 sc1
    buffer_load_dwordx4 v[84:87], v0, s[4:7], s71 offen offset:1024 sc1
    buffer_load_dwordx4 v[88:91], v0, s[4:7], s71 offen offset:2048 sc1
    buffer_load_dwordx4 v[92:95], v0, s[4:7], s71 offen offset:3072 sc1
    s_bitcmp1_b32 s62, 0
    s_cbranch_scc1 GATHER2
GWORK:
    ds_read_b64 v[8:9], v4 offset:32
    v_max3_f32 v192, v144, v145, v146
    v_max3_f32 v193, v147, v148, v149
    v_max3_f32 v194, v150, v151, v152
    v_max3_f32 v195, v153, v154, v155
    v_max3_f32 v196, v156, v157, v158
    v_min3_f32 v197, v144, v145, v146
    v_min3_f32 v198, v147, v148, v149
    v_min3_f32 v199, v150, v151, v152
    v_min3_f32 v200, v153, v154, v155
    v_min3_f32 v201, v156, v157, v158
    v_max3_f32 v192, v192, v193, v159
    v_max3_f32 v194, v194, v195, v196
    v_min3_f32 v197, v197, v198, v159
    v_min3_f32 v199, v199, v200, v201
    v_max_f32 v192, v192, v194
    v_min_f32 v194, v197, v199
    v_mul_f32 v192, -v192, v28
    v_mul_f32 v194, v194, v28
    v_pk_fma_f32 v[160:161], v[144:145], v[28:29], v[194:195] op_sel_hi:[1,0,0] neg_lo:[1,0,0] neg_hi:[1,0,0]
    v_pk_fma_f32 v[144:145], v[144:145], v[28:29], v[192:193] op_sel:[0,0,0] op_sel_hi:[1,0,0]
    v_pk_fma_f32 v[162:163], v[146:147], v[28:29], v[194:195] op_sel_hi:[1,0,0] neg_lo:[1,0,0] neg_hi:[1,0,0]
    v_exp_f32 v160, v160
    v_pk_fma_f32 v[146:147], v[146:147], v[28:29], v[192:193] op_sel:[0,0,0] op_sel_hi:[1,0,0]
    v_exp_f32 v161, v161
    v_pk_fma_f32 v[164:165], v[148:149], v[28:29], v[194:195] op_sel_hi:[1,0,0] neg_lo:[1,0,0] neg_hi:[1,0,0]
    v_exp_f32 v144, v144
    v_pk_fma_f32 v[148:149], v[148:149], v[28:29], v[192:193] op_sel:[0,0,0] op_sel_hi:[1,0,0]
    v_exp_f32 v145, v145
    v_pk_fma_f32 v[166:167], v[150:151], v[28:29], v[194:195] op_sel_hi:[1,0,0] neg_lo:[1,0,0] neg_hi:[1,0,0]
    v_exp_f32 v162, v162
    v_pk_fma_f32 v[150:151], v[150:151], v[28:29], v[192:193] op_sel:[0,0,0] op_sel_hi:[1,0,0]
    v_exp_f32 v163, v163
    v_pk_fma_f32 v[168:169], v[152:153], v[28:29], v[194:195] op_sel_hi:[1,0,0] neg_lo:[1,0,0] neg_hi:[1,0,0]
    v_exp_f32 v146, v146
    v_pk_fma_f32 v[152:153], v[152:153], v[28:29], v[192:193] op_sel:[0,0,0] op_sel_hi:[1,0,0]
    v_exp_f32 v147, v147
    v_pk_fma_f32 v[170:171], v[154:155], v[28:29], v[194:195] op_sel_hi:[1,0,0] neg_lo:[1,0,0] neg_hi:[1,0,0]
    v_exp_f32 v164, v164
    v_pk_fma_f32 v[154:155], v[154:155], v[28:29], v[192:193] op_sel:[0,0,0] op_sel_hi:[1,0,0]
    v_exp_f32 v165, v165
    v_pk_fma_f32 v[172:173], v[156:157], v[28:29], v[194:195] op_sel_hi:[1,0,0] neg_lo:[1,0,0] neg_hi:[1,0,0]
    v_exp_f32 v148, v148
    v_pk_fma_f32 v[156:157], v[156:157], v[28:29], v[192:193] op_sel:[0,0,0] op_sel_hi:[1,0,0]
    v_exp_f32 v149, v149
    v_pk_fma_f32 v[174:175], v[158:159], v[28:29], v[194:195] op_sel_hi:[1,0,0] neg_lo:[1,0,0] neg_hi:[1,0,0]
    v_exp_f32 v166, v166
    v_pk_fma_f32 v[158:159], v[158:159], v[28:29], v[192:193] op_sel:[0,0,0] op_sel_hi:[1,0,0]
    v_exp_f32 v167, v167
    v_pk_add_f32 v[198:199], v[160:161], v[162:163]
    v_exp_f32 v150, v150
    v_pk_add_f32 v[194:195], v[144:145], v[146:147]
    v_exp_f32 v151, v151
    v_exp_f32 v168, v168
    v_pk_add_f32 v[200:201], v[164:165], v[166:167]
    v_exp_f32 v169, v169
    v_pk_add_f32 v[196:197], v[148:149], v[150:151]
    v_exp_f32 v152, v152
    v_exp_f32 v153, v153
    v_exp_f32 v170, v170
    v_pk_add_f32 v[198:199], v[198:199], v[168:169]
    v_exp_f32 v171, v171
    v_pk_add_f32 v[194:195], v[194:195], v[152:153]
    v_exp_f32 v154, v154
    v_exp_f32 v155, v155
    v_exp_f32 v172, v172
    v_pk_add_f32 v[200:201], v[200:201], v[170:171]
    v_exp_f32 v173, v173
    v_pk_add_f32 v[196:197], v[196:197], v[154:155]
    v_exp_f32 v156, v156
    v_exp_f32 v157, v157
    v_exp_f32 v174, v174
    v_pk_add_f32 v[198:199], v[198:199], v[172:173]
    v_exp_f32 v175, v175
    v_pk_add_f32 v[194:195], v[194:195], v[156:157]
    v_exp_f32 v158, v158
    v_exp_f32 v159, v159
    v_pk_add_f32 v[200:201], v[200:201], v[174:175]
    v_pk_add_f32 v[196:197], v[196:197], v[158:159]
    v_pk_add_f32 v[194:195], v[194:195], v[196:197]
    v_pk_add_f32 v[198:199], v[198:199], v[200:201]
    v_add_f32 v192, v194, v195
    v_add_f32 v193, v198, v199
    v_rcp_f32 v192, v192
    v_rcp_f32 v193, v193
    s_nop 0
    v_pk_mul_f32 v[144:145], v[144:145], v[192:193] op_sel_hi:[1,0]
    v_pk_mul_f32 v[146:147], v[146:147], v[192:193] op_sel_hi:[1,0]
    v_pk_mul_f32 v[148:149], v[148:149], v[192:193] op_sel_hi:[1,0]
    v_pk_mul_f32 v[150:151], v[150:151], v[192:193] op_sel_hi:[1,0]
    v_pk_mul_f32 v[152:153], v[152:153], v[192:193] op_sel_hi:[1,0]
    v_pk_mul_f32 v[154:155], v[154:155], v[192:193] op_sel_hi:[1,0]
    v_pk_mul_f32 v[156:157], v[156:157], v[192:193] op_sel_hi:[1,0]
    v_pk_mul_f32 v[158:159], v[158:159], v[192:193] op_sel_hi:[1,0]
    v_cvt_pk_bf16_f32 v96, v144, v145
    v_cvt_pk_bf16_f32 v97, v146, v147
    v_cvt_pk_bf16_f32 v98, v148, v149
    v_cvt_pk_bf16_f32 v99, v150, v151
    v_cvt_pk_bf16_f32 v100, v152, v153
    v_cvt_pk_bf16_f32 v101, v154, v155
    v_cvt_pk_bf16_f32 v102, v156, v157
    v_cvt_pk_bf16_f32 v103, v158, v159
    v_pk_mul_f32 v[160:161], v[192:193], v[160:161] op_sel:[1,0] op_sel_hi:[1,1]
    v_pk_mul_f32 v[162:163], v[192:193], v[162:163] op_sel:[1,0] op_sel_hi:[1,1]
    v_pk_mul_f32 v[164:165], v[192:193], v[164:165] op_sel:[1,0] op_sel_hi:[1,1]
    v_pk_mul_f32 v[166:167], v[192:193], v[166:167] op_sel:[1,0] op_sel_hi:[1,1]
    v_pk_mul_f32 v[168:169], v[192:193], v[168:169] op_sel:[1,0] op_sel_hi:[1,1]
    v_pk_mul_f32 v[170:171], v[192:193], v[170:171] op_sel:[1,0] op_sel_hi:[1,1]
    v_pk_mul_f32 v[172:173], v[192:193], v[172:173] op_sel:[1,0] op_sel_hi:[1,1]
    v_pk_mul_f32 v[174:175], v[192:193], v[174:175] op_sel:[1,0] op_sel_hi:[1,1]
    v_cvt_pk_bf16_f32 v104, v160, v161
    v_cvt_pk_bf16_f32 v105, v162, v163
    v_cvt_pk_bf16_f32 v106, v164, v165
    v_cvt_pk_bf16_f32 v107, v166, v167
    v_cvt_pk_bf16_f32 v108, v168, v169
    v_cvt_pk_bf16_f32 v109, v170, v171
    v_cvt_pk_bf16_f32 v110, v172, v173
    v_cvt_pk_bf16_f32 v111, v174, v175
    s_waitcnt lgkmcnt(0)
    v_min_u32 v8, v8, v9
    s_nop 0
    v_readfirstlane_b32 s48, v8
    s_nop 1
    s_sub_i32 s48, s48, s49
    s_cmp_gt_i32 s48, 6
    s_cbranch_scc0 NW_37
NWB_38:
    ds_read_b64_tr_b16 v[128:129], v11 offset:32768
    ds_read_b64_tr_b16 v[130:131], v11 offset:33280
    ds_read_b64_tr_b16 v[132:133], v10 offset:32768
    ds_read_b64_tr_b16 v[134:135], v10 offset:33280
    ds_read_b64_tr_b16 v[136:137], v11 offset:34816
    ds_read_b64_tr_b16 v[138:139], v11 offset:35328
    ds_read_b64_tr_b16 v[140:141], v10 offset:34816
    ds_read_b64_tr_b16 v[142:143], v10 offset:35328
    ds_read_b64_tr_b16 v[144:145], v11 offset:36864
    ds_read_b64_tr_b16 v[146:147], v11 offset:37376
    ds_read_b64_tr_b16 v[148:149], v10 offset:36864
    ds_read_b64_tr_b16 v[150:151], v10 offset:37376
    ds_read_b64_tr_b16 v[152:153], v11 offset:38912
    ds_read_b64_tr_b16 v[154:155], v11 offset:39424
    ds_read_b64_tr_b16 v[156:157], v10 offset:38912
    ds_read_b64_tr_b16 v[158:159], v10 offset:39424
    s_cmp_gt_i32 s48, 7
    s_cbranch_scc0 NW_39
NWB_40:
    ds_read_b64_tr_b16 v[160:161], v11 offset:49152
    ds_read_b64_tr_b16 v[162:163], v11 offset:49664
    ds_read_b64_tr_b16 v[164:165], v10 offset:49152
    ds_read_b64_tr_b16 v[166:167], v10 offset:49664
    ds_read_b64_tr_b16 v[168:169], v11 offset:51200
    ds_read_b64_tr_b16 v[170:171], v11 offset:51712
    ds_read_b64_tr_b16 v[172:173], v10 offset:51200
    ds_read_b64_tr_b16 v[174:175], v10 offset:51712
    ds_read_b64_tr_b16 v[176:177], v11 offset:53248
    ds_read_b64_tr_b16 v[178:179], v11 offset:53760
    ds_read_b64_tr_b16 v[180:181], v10 offset:53248
    ds_read_b64_tr_b16 v[182:183], v10 offset:53760
    ds_read_b64_tr_b16 v[184:185], v11 offset:55296
    ds_read_b64_tr_b16 v[186:187], v11 offset:55808
    ds_read_b64_tr_b16 v[188:189], v10 offset:55296
    ds_read_b64_tr_b16 v[190:191], v10 offset:55808
    s_bitcmp1_b32 s62, 1
    s_mov_b32 s62, 1
    s_cbranch_scc0 GATHER2
    s_mov_b32 s55, 0
LW_41:
    ds_read_b32 v8, v4 offset:64
    s_waitcnt lgkmcnt(0)
    v_readfirstlane_b32 s52, v8
    s_nop 1
    s_cmp_ge_u32 s52, 2
    s_cbranch_scc1 LWD_42
    s_add_u32 s55, s55, 1
    s_cmp_lt_u32 s55, 4000000
    s_cbranch_scc1 LW_41
    s_branch ABORT
LWD_42:
    s_mov_b32 s47, s52
    s_branch GATHER
GATHER2:
    s_mov_b32 s52, 0x3f80
    s_mov_b32 s53, 0x3f800000
    v_mov_b32 v32, 0
    v_mov_b32 v33, 0
    v_mov_b32 v34, 0
    v_mov_b32 v35, 0
    v_mov_b32 v36, 0
    v_mov_b32 v37, 0
    v_mov_b32 v38, 0
    v_mov_b32 v39, 0
    s_waitcnt vmcnt(8)
    v_max3_u32 v40, v44, v45, v46
    v_max_u32 v40, v40, v47
    v_add_f32 v44, v44, v45
    v_add_f32 v46, v46, v47
    v_add_f32 v44, v44, v46
    v_mov_b32 v45, v44
    s_nop 1
    v_permlane32_swap_b32 v44, v45
    v_add_f32 v44, v44, v45
    v_mov_b32 v45, v44
    s_nop 1
    v_permlane16_swap_b32 v44, v45
    v_add_f32 v44, v44, v45
    v_cvt_pk_bf16_f32 v44, v44, v44
    s_waitcnt vmcnt(7)
    v_max3_u32 v40, v40, v64, v65
    v_max3_u32 v40, v40, v66, v67
    v_dot2c_f32_bf16 v32, s52, v64
    v_dot2c_f32_bf16 v33, s53, v64
    v_dot2c_f32_bf16 v34, s52, v65
    v_dot2c_f32_bf16 v35, s53, v65
    v_dot2c_f32_bf16 v36, s52, v66
    v_dot2c_f32_bf16 v37, s53, v66
    v_dot2c_f32_bf16 v38, s52, v67
    v_dot2c_f32_bf16 v39, s53, v67
    s_waitcnt vmcnt(6)
    v_max3_u32 v40, v40, v68, v69
    v_max3_u32 v40, v40, v70, v71
    v_dot2c_f32_bf16 v32, s52, v68
    v_dot2c_f32_bf16 v33, s53, v68
    v_dot2c_f32_bf16 v34, s52, v69
    v_dot2c_f32_bf16 v35, s53, v69
    v_dot2c_f32_bf16 v36, s52, v70
    v_dot2c_f32_bf16 v37, s53, v70
    v_dot2c_f32_bf16 v38, s52, v71
    v_dot2c_f32_bf16 v39, s53, v71
    s_waitcnt vmcnt(5)
    v_max3_u32 v40, v40, v72, v73
    v_max3_u32 v40, v40, v74, v75
    v_dot2c_f32_bf16 v32, s52, v72
    v_dot2c_f32_bf16 v33, s53, v72
    v_dot2c_f32_bf16 v34, s52, v73
    v_dot2c_f32_bf16 v35, s53, v73
    v_dot2c_f32_bf16 v36, s52, v74
    v_dot2c_f32_bf16 v37, s53, v74
    v_dot2c_f32_bf16 v38, s52, v75
    v_dot2c_f32_bf16 v39, s53, v75
    s_waitcnt vmcnt(4)
    v_max3_u32 v40, v40, v76, v77
    v_max3_u32 v40, v40, v78, v79
    v_dot2c_f32_bf16 v32, s52, v76
    v_dot2c_f32_bf16 v33, s53, v76
    v_dot2c_f32_bf16 v34, s52, v77
    v_dot2c_f32_bf16 v35, s53, v77
    v_dot2c_f32_bf16 v36, s52, v78
    v_dot2c_f32_bf16 v37, s53, v78
    v_dot2c_f32_bf16 v38, s52, v79
    v_dot2c_f32_bf16 v39, s53, v79
    s_waitcnt vmcnt(3)
    v_max3_u32 v40, v40, v80, v81
    v_max3_u32 v40, v40, v82, v83
    v_dot2c_f32_bf16 v32, s52, v80
    v_dot2c_f32_bf16 v33, s53, v80
    v_dot2c_f32_bf16 v34, s52, v81
    v_dot2c_f32_bf16 v35, s53, v81
    v_dot2c_f32_bf16 v36, s52, v82
    v_dot2c_f32_bf16 v37, s53, v82
    v_dot2c_f32_bf16 v38, s52, v83
    v_dot2c_f32_bf16 v39, s53, v83
    s_waitcnt vmcnt(2)
    v_max3_u32 v40, v40, v84, v85
    v_max3_u32 v40, v40, v86, v87
    v_dot2c_f32_bf16 v32, s52, v84
    v_dot2c_f32_bf16 v33, s53, v84
    v_dot2c_f32_bf16 v34, s52, v85
    v_dot2c_f32_bf16 v35, s53, v85
    v_dot2c_f32_bf16 v36, s52, v86
    v_dot2c_f32_bf16 v37, s53, v86
    v_dot2c_f32_bf16 v38, s52, v87
    v_dot2c_f32_bf16 v39, s53, v87
    s_waitcnt vmcnt(1)
    v_max3_u32 v40, v40, v88, v89
    v_max3_u32 v40, v40, v90, v91
    v_dot2c_f32_bf16 v32, s52, v88
    v_dot2c_f32_bf16 v33, s53, v88
    v_dot2c_f32_bf16 v34, s52, v89
    v_dot2c_f32_bf16 v35, s53, v89
    v_dot2c_f32_bf16 v36, s52, v90
    v_dot2c_f32_bf16 v37, s53, v90
    v_dot2c_f32_bf16 v38, s52, v91
    v_dot2c_f32_bf16 v39, s53, v91
    s_waitcnt vmcnt(0)
    v_max3_u32 v40, v40, v92, v93
    v_max3_u32 v40, v40, v94, v95
    v_dot2c_f32_bf16 v32, s52, v92
    v_dot2c_f32_bf16 v33, s53, v92
    v_dot2c_f32_bf16 v34, s52, v93
    v_dot2c_f32_bf16 v35, s53, v93
    v_dot2c_f32_bf16 v36, s52, v94
    v_dot2c_f32_bf16 v37, s53, v94
    v_dot2c_f32_bf16 v38, s52, v95
    v_dot2c_f32_bf16 v39, s53, v95
    v_cmp_eq_u32 vcc, -1, v40
    v_permlane32_swap_b32 v32, v36
    v_permlane32_swap_b32 v33, v37
    v_permlane32_swap_b32 v34, v38
    v_permlane32_swap_b32 v35, v39
    s_cmp_eq_u64 vcc, 0
    s_cbranch_scc0 GRETRY
    ds_write_b16 v117, v44
    s_waitcnt lgkmcnt(15)
    s_waitcnt lgkmcnt(1)
    v_add_u32 v6, 2, v6
    ds_write_b32 v5, v6
    v_pk_add_f32 v[32:33], v[32:33], v[36:37]
    v_pk_add_f32 v[34:35], v[34:35], v[38:39]
    v_cvt_pk_bf16_f32 v32, v32, v33
    v_cvt_pk_bf16_f32 v33, v34, v35
    ds_write_b64 v118, v[32:33]
    s_add_u32 s70, s70, 1
    v_mov_b32 v8, s70
    ds_write_b32 v5, v8 offset:32
    s_lshl_b32 s71, s42, 15
    s_lshl_b32 s51, s41, 11
    s_add_u32 s71, s71, s51
    s_add_u32 s71, s71, s63
    v_mov_b32 v112, 0x358637bd
    v_mov_b32 v113, 0
    s_mov_b32 s55, 0
SY_43:
    ds_read_b128 v[36:39], v4 offset:48
    s_waitcnt lgkmcnt(0)
    v_min3_u32 v36, v36, v37, v38
    v_min_u32 v36, v36, v39
    s_nop 0
    v_readfirstlane_b32 s52, v36
    s_nop 1
    s_cmp_ge_u32 s52, s70
    s_cbranch_scc1 SYD_44
    s_add_u32 s55, s55, 1
    s_cmp_lt_u32 s55, 4000000
    s_cbranch_scc1 SY_43
    s_branch ABORT
SYD_44:
    ds_read_b128 v[32:35], v119 offset:0
    ds_read_b128 v[36:39], v119 offset:16
    ds_read_b128 v[40:43], v119 offset:32
    ds_read_b128 v[44:47], v119 offset:48
    ds_read_b128 v[48:51], v120 offset:0
    ds_read_b128 v[52:55], v120 offset:16
    ds_read_b128 v[56:59], v120 offset:32
    ds_read_b128 v[60:63], v120 offset:48
    s_waitcnt lgkmcnt(7)
    v_mfma_f32_32x32x16_bf16 v[64:79], v[32:35], v[96:99], 0
    s_waitcnt lgkmcnt(6)
    v_mfma_f32_32x32x16_bf16 v[64:79], v[36:39], v[100:103], v[64:79]
    s_waitcnt lgkmcnt(5)
    v_mfma_f32_32x32x16_bf16 v[64:79], v[40:43], v[104:107], v[64:79]
    s_waitcnt lgkmcnt(4)
    v_mfma_f32_32x32x16_bf16 v[64:79], v[44:47], v[108:111], v[64:79]
    s_waitcnt lgkmcnt(0)
    v_dot2c_f32_bf16 v112, v48, v96
    v_dot2c_f32_bf16 v113, v49, v97
    v_dot2c_f32_bf16 v112, v50, v98
    v_dot2c_f32_bf16 v113, v51, v99
    v_dot2c_f32_bf16 v112, v52, v100
    v_dot2c_f32_bf16 v113, v53, v101
    v_dot2c_f32_bf16 v112, v54, v102
    v_dot2c_f32_bf16 v113, v55, v103
    v_dot2c_f32_bf16 v112, v56, v104
    v_dot2c_f32_bf16 v113, v57, v105
    v_dot2c_f32_bf16 v112, v58, v106
    v_dot2c_f32_bf16 v113, v59, v107
    v_dot2c_f32_bf16 v112, v60, v108
    v_dot2c_f32_bf16 v113, v61, v109
    v_dot2c_f32_bf16 v112, v62, v110
    v_dot2c_f32_bf16 v113, v63, v111
    s_nop 2
    v_add_f32 v112, v112, v113
    v_rcp_f32 v112, v112
    s_nop 0
    v_mov_b32 v113, v112
    s_nop 1
    v_permlane32_swap_b32 v112, v113
    v_pk_mul_f32 v[64:65], v[112:113], v[64:65] op_sel:[0,0] op_sel_hi:[0,1]
    v_pk_mul_f32 v[66:67], v[112:113], v[66:67] op_sel:[0,0] op_sel_hi:[0,1]
    v_pk_mul_f32 v[68:69], v[112:113], v[68:69] op_sel:[0,0] op_sel_hi:[0,1]
    v_pk_mul_f32 v[70:71], v[112:113], v[70:71] op_sel:[0,0] op_sel_hi:[0,1]
    v_pk_mul_f32 v[72:73], v[112:113], v[72:73] op_sel:[1,0] op_sel_hi:[1,1]
    v_pk_mul_f32 v[74:75], v[112:113], v[74:75] op_sel:[1,0] op_sel_hi:[1,1]
    v_pk_mul_f32 v[76:77], v[112:113], v[76:77] op_sel:[1,0] op_sel_hi:[1,1]
    v_pk_mul_f32 v[78:79], v[112:113], v[78:79] op_sel:[1,0] op_sel_hi:[1,1]
    v_cvt_pk_bf16_f32 v80, v64, v65
    v_cvt_pk_bf16_f32 v81, v66, v67
    v_cvt_pk_bf16_f32 v82, v68, v69
    v_cvt_pk_bf16_f32 v83, v70, v71
    v_cvt_pk_bf16_f32 v84, v72, v73
    v_cvt_pk_bf16_f32 v85, v74, v75
    v_cvt_pk_bf16_f32 v86, v76, v77
    v_cvt_pk_bf16_f32 v87, v78, v79
    s_cmp_eq_u32 s47, 3
    s_cbranch_scc0 STF_45
    buffer_store_dwordx4 v[80:83], v0, s[4:7], s71 offen
    buffer_store_dwordx4 v[84:87], v0, s[4:7], s71 offen offset:1024
STE_46:
    v_lshlrev_b32 v32, 16, v16
    v_and_b32 v33, 0xffff0000, v16
    v_lshlrev_b32 v34, 16, v17
    v_and_b32 v35, 0xffff0000, v17
    v_lshlrev_b32 v36, 16, v18
    v_and_b32 v37, 0xffff0000, v18
    v_lshlrev_b32 v38, 16, v19
    v_and_b32 v39, 0xffff0000, v19
    v_lshlrev_b32 v40, 16, v20
    v_and_b32 v41, 0xffff0000, v20
    v_lshlrev_b32 v42, 16, v21
    v_and_b32 v43, 0xffff0000, v21
    v_lshlrev_b32 v44, 16, v22
    v_and_b32 v45, 0xffff0000, v22
    v_lshlrev_b32 v46, 16, v23
    v_and_b32 v47, 0xffff0000, v23
    s_mul_i32 s51, s77, 128
    s_lshl_b32 s52, s45, 2
    s_add_u32 s51, s51, s52
    s_add_u32 s51, s51, s69
    v_and_b32 v64, 0x70, v0
    v_add_u32 v64, s51, v64
    s_add_u32 s54, s50, 1
    s_add_u32 s71, s63, s86
    s_add_u32 s73, s64, s85
    s_cmp_gt_i32 s48, 8
    s_cbranch_scc0 NW_47
NWB_48:
    v_xor_b32 v10, 0x10000, v10
    v_xor_b32 v11, 0x10000, v11
    ds_read_b64_tr_b16 v[192:193], v11 offset:0
    ds_read_b64_tr_b16 v[194:195], v11 offset:512
    ds_read_b64_tr_b16 v[196:197], v10 offset:0
    ds_read_b64_tr_b16 v[198:199], v10 offset:512
    ds_read_b64_tr_b16 v[200:201], v11 offset:2048
    ds_read_b64_tr_b16 v[202:203], v11 offset:2560
    ds_read_b64_tr_b16 v[204:205], v10 offset:2048
    ds_read_b64_tr_b16 v[206:207], v10 offset:2560
    ds_read_b64_tr_b16 v[208:209], v11 offset:4096
    ds_read_b64_tr_b16 v[210:211], v11 offset:4608
    ds_read_b64_tr_b16 v[212:213], v10 offset:4096
    ds_read_b64_tr_b16 v[214:215], v10 offset:4608
    ds_read_b64_tr_b16 v[216:217], v11 offset:6144
    ds_read_b64_tr_b16 v[218:219], v11 offset:6656
    ds_read_b64_tr_b16 v[220:221], v10 offset:6144
    ds_read_b64_tr_b16 v[222:223], v10 offset:6656
    s_cmp_gt_i32 s48, 9
    s_cbranch_scc0 NW_49
NWB_50:
    ds_read_b64_tr_b16 v[224:225], v11 offset:16384
    ds_read_b64_tr_b16 v[226:227], v11 offset:16896
    ds_read_b64_tr_b16 v[228:229], v10 offset:16384
    ds_read_b64_tr_b16 v[230:231], v10 offset:16896
    ds_read_b64_tr_b16 v[232:233], v11 offset:18432
    ds_read_b64_tr_b16 v[234:235], v11 offset:18944
    ds_read_b64_tr_b16 v[236:237], v10 offset:18432
    ds_read_b64_tr_b16 v[238:239], v10 offset:18944
    s_add_u32 s51, s50, 1
    v_mov_b32 v8, s51
    v_mov_b32 v9, 0
    s_mov_b64 exec, 1
    s_cmp_eq_u32 s47, 3
    s_waitcnt vmcnt(0)
    s_cbranch_scc0 STF_51
    buffer_store_dword v8, v9, s[4:7], s68 offen
STE_52:
    s_mov_b64 exec, -1
    buffer_load_dword v65, v64, s[4:7], 0 offen sc1
    ds_read_b64_tr_b16 v[240:241], v11 offset:20480
    ds_read_b64_tr_b16 v[242:243], v11 offset:20992
    ds_read_b64_tr_b16 v[244:245], v10 offset:20480
    ds_read_b64_tr_b16 v[246:247], v10 offset:20992
    ds_read_b64_tr_b16 v[248:249], v11 offset:22528
    ds_read_b64_tr_b16 v[250:251], v11 offset:23040
    ds_read_b64_tr_b16 v[252:253], v10 offset:22528
    ds_read_b64_tr_b16 v[254:255], v10 offset:23040
    s_mov_b32 s55, 0
    s_branch POLLC_54
POLLC_54:
POLL_53:
    buffer_load_dword v66, v64, s[4:7], 0 offen sc1
    s_waitcnt vmcnt(1)
    v_cmp_le_u32 vcc, s54, v65
    s_nop 1
    s_cmp_eq_u64 vcc, -1
    s_cbranch_scc1 POLLD_55
    buffer_load_dword v65, v64, s[4:7], 0 offen sc1
    s_waitcnt vmcnt(1)
    v_cmp_le_u32 vcc, s54, v66
    s_nop 1
    s_cmp_eq_u64 vcc, -1
    s_cbranch_scc1 POLLD_55
    s_add_u32 s55, s55, 1
    s_cmp_lt_u32 s55, 400000
    s_cbranch_scc1 POLL_53
    s_branch ABORT
POLLD_55:
    buffer_load_dwordx4 v[64:67], v0, s[4:7], s71 offen offset:0 sc1
    buffer_load_dwordx4 v[68:71], v0, s[4:7], s71 offen offset:1024 sc1
    buffer_load_dwordx4 v[72:75], v0, s[4:7], s71 offen offset:2048 sc1
    buffer_load_dwordx4 v[76:79], v0, s[4:7], s71 offen offset:3072 sc1
    s_add_u32 s71, s71, 4096
    buffer_load_dwordx4 v[80:83], v0, s[4:7], s71 offen offset:0 sc1
    buffer_load_dwordx4 v[84:87], v0, s[4:7], s71 offen offset:1024 sc1
    buffer_load_dwordx4 v[88:91], v0, s[4:7], s71 offen offset:2048 sc1
    buffer_load_dwordx4 v[92:95], v0, s[4:7], s71 offen offset:3072 sc1
    s_mul_i32 s51, s77, 8256
    s_add_u32 s51, s51, 0
    v_xor_b32 v10, s51, v2
    v_xor_b32 v11, 64, v10
    s_waitcnt vmcnt(7)
    v_mfma_f32_32x32x16_bf16 v[48:63], v[128:131], v[64:67], 0
    v_mfma_f32_32x32x16_bf16 v[32:47], v[132:135], v[64:67], v[32:47]
    s_add_u32 s71, s71, 4096
    buffer_load_dwordx4 v[96:99], v0, s[4:7], s71 offen offset:0 sc1
    s_waitcnt vmcnt(7)
    v_mfma_f32_32x32x16_bf16 v[48:63], v[136:139], v[68:71], v[48:63]
    v_mfma_f32_32x32x16_bf16 v[32:47], v[140:143], v[68:71], v[32:47]
    buffer_load_dwordx4 v[100:103], v0, s[4:7], s71 offen offset:1024 sc1
    s_waitcnt vmcnt(7)
    v_mfma_f32_32x32x16_bf16 v[48:63], v[144:147], v[72:75], v[48:63]
    v_mfma_f32_32x32x16_bf16 v[32:47], v[148:151], v[72:75], v[32:47]
    buffer_load_dwordx4 v[104:107], v0, s[4:7], s71 offen offset:2048 sc1
    s_waitcnt vmcnt(7)
    v_mfma_f32_32x32x16_bf16 v[48:63], v[152:155], v[76:79], v[48:63]
    v_mfma_f32_32x32x16_bf16 v[32:47], v[156:159], v[76:79], v[32:47]
    buffer_load_dwordx4 v[108:111], v0, s[4:7], s71 offen offset:3072 sc1
    s_waitcnt vmcnt(7)
    v_mfma_f32_32x32x16_bf16 v[48:63], v[160:163], v[80:83], v[48:63]
    v_mfma_f32_32x32x16_bf16 v[32:47], v[164:167], v[80:83], v[32:47]
    s_add_u32 s71, s71, 4096
    buffer_load_dwordx4 v[112:115], v0, s[4:7], s71 offen offset:0 sc1
    s_waitcnt vmcnt(7)
    v_mfma_f32_32x32x16_bf16 v[48:63], v[168:171], v[84:87], v[48:63]
    v_mfma_f32_32x32x16_bf16 v[32:47], v[172:175], v[84:87], v[32:47]
    buffer_load_dwordx4 v[116:119], v0, s[4:7], s71 offen offset:1024 sc1
    s_waitcnt vmcnt(7)
    v_mfma_f32_32x32x16_bf16 v[48:63], v[176:179], v[88:91], v[48:63]
    s_waitcnt lgkmcnt(15)
    v_add_u32 v6, 1, v6
    ds_write_b32 v5, v6
    s_lshl_b32 s51, s42, 12
    v_mfma_f32_32x32x16_bf16 v[32:47], v[180:183], v[88:91], v[32:47]
    buffer_load_dwordx4 v[120:123], v0, s[4:7], s71 offen offset:2048 sc1
    s_add_u32 s51, s51, 131072
    s_waitcnt vmcnt(7)
    v_mfma_f32_32x32x16_bf16 v[48:63], v[184:187], v[92:95], v[48:63]
    v_add_u32 v80, s51, v0
    v_mfma_f32_32x32x16_bf16 v[32:47], v[188:191], v[92:95], v[32:47]
    buffer_load_dwordx4 v[124:127], v0, s[4:7], s71 offen offset:3072 sc1
    v_xor_b32 v81, 0x2000, v80
    s_waitcnt vmcnt(7)
    v_mfma_f32_32x32x16_bf16 v[48:63], v[192:195], v[96:99], v[48:63]
    v_xor_b32 v82, 8, v5
    v_mfma_f32_32x32x16_bf16 v[32:47], v[196:199], v[96:99], v[32:47]
    s_add_u32 s70, s70, 1
    s_waitcnt vmcnt(6)
    v_mfma_f32_32x32x16_bf16 v[48:63], v[200:203], v[100:103], v[48:63]
    v_mov_b32 v83, s70
    v_mfma_f32_32x32x16_bf16 v[32:47], v[204:207], v[100:103], v[32:47]
    s_waitcnt vmcnt(5)
    v_mfma_f32_32x32x16_bf16 v[48:63], v[208:211], v[104:107], v[48:63]
    v_mfma_f32_32x32x16_bf16 v[32:47], v[212:215], v[104:107], v[32:47]
    s_waitcnt vmcnt(4)
    v_mfma_f32_32x32x16_bf16 v[48:63], v[216:219], v[108:111], v[48:63]
    ds_read_b64 v[8:9], v4 offset:32
    v_mfma_f32_32x32x16_bf16 v[32:47], v[220:223], v[108:111], v[32:47]
    s_waitcnt vmcnt(3) lgkmcnt(15)
    v_mfma_f32_32x32x16_bf16 v[48:63], v[224:227], v[112:115], v[48:63]
    v_mov_b32 v104, 0
    s_waitcnt lgkmcnt(14)
    v_mfma_f32_32x32x16_bf16 v[32:47], v[228:231], v[112:115], v[32:47]
    v_mov_b32 v105, 0
    s_waitcnt vmcnt(2) lgkmcnt(12)
    v_mfma_f32_32x32x16_bf16 v[48:63], v[232:235], v[116:119], v[48:63]
    v_and_b32 v106, 0x1f0, v0
    s_waitcnt lgkmcnt(0)
    v_min_u32 v8, v8, v9
    s_nop 0
    v_readfirstlane_b32 s48, v8
    s_nop 1
    s_sub_i32 s48, s48, s49
    v_mfma_f32_32x32x16_bf16 v[32:47], v[236:239], v[116:119], v[32:47]
    v_add_u32 v6, 1, v6
    ds_write_b32 v5, v6
    v_lshrrev_b32 v107, 9, v0
    s_waitcnt vmcnt(1)
    v_mfma_f32_32x32x16_bf16 v[48:63], v[240:243], v[120:123], v[48:63]
    v_lshl_or_b32 v106, v107, 2, v106
    v_mfma_f32_32x32x16_bf16 v[32:47], v[244:247], v[120:123], v[32:47]
    s_add_u32 s72, s74, 0
    s_waitcnt vmcnt(0)
    v_mfma_f32_32x32x16_bf16 v[48:63], v[248:251], v[124:127], v[48:63]
    v_mfma_f32_32x32x16_bf16 v[32:47], v[252:255], v[124:127], v[32:47]
    s_nop 10
    ds_write_b128 v80, v[48:51] offset:0
    ds_write_b128 v80, v[52:55] offset:1024
    ds_write_b128 v80, v[56:59] offset:2048
    ds_write_b128 v80, v[60:63] offset:3072
    ds_write_b32 v5, v83 offset:32
    s_mov_b32 s55, 0
XC_56:
    ds_read_b32 v84, v82 offset:32
    ds_read_b128 v[64:67], v81 offset:0
    ds_read_b128 v[68:71], v81 offset:1024
    ds_read_b128 v[72:75], v81 offset:2048
    ds_read_b128 v[76:79], v81 offset:3072
    s_waitcnt lgkmcnt(4)
    v_readfirstlane_b32 s52, v84
    s_nop 1
    s_cmp_ge_u32 s52, s70
    s_cbranch_scc1 XCD_57
    s_add_u32 s55, s55, 1
    s_cmp_lt_u32 s55, 4000000
    s_cbranch_scc1 XC_56
    s_branch ABORT
XCD_57:
    s_waitcnt lgkmcnt(3)
    v_pk_add_f32 v[32:33], v[32:33], v[64:65]
    v_pk_add_f32 v[34:35], v[34:35], v[66:67]
    s_waitcnt lgkmcnt(2)
    v_pk_add_f32 v[36:37], v[36:37], v[68:69]
    v_pk_add_f32 v[38:39], v[38:39], v[70:71]
    s_waitcnt lgkmcnt(1)
    v_pk_add_f32 v[40:41], v[40:41], v[72:73]
    v_pk_add_f32 v[42:43], v[42:43], v[74:75]
    s_waitcnt lgkmcnt(0)
    v_pk_add_f32 v[44:45], v[44:45], v[76:77]
    v_pk_add_f32 v[46:47], v[46:47], v[78:79]
    ds_write_b32 v5, v83 offset:64
    s_mov_b32 s84, s70
    v_cvt_pk_bf16_f32 v16, v32, v33
    v_cvt_pk_bf16_f32 v17, v34, v35
    v_cvt_pk_bf16_f32 v18, v36, v37
    v_cvt_pk_bf16_f32 v19, v38, v39
    v_cvt_pk_bf16_f32 v20, v40, v41
    v_cvt_pk_bf16_f32 v21, v42, v43
    v_cvt_pk_bf16_f32 v22, v44, v45
    v_cvt_pk_bf16_f32 v23, v46, v47
    s_cmp_eq_u32 s47, 3
    s_cbranch_scc0 STF_58
    buffer_store_dwordx4 v[16:19], v0, s[4:7], s73 offen
    buffer_store_dwordx4 v[20:23], v0, s[4:7], s73 offen offset:1024
STE_59:
    v_dot2c_f32_bf16 v104, s75, v16
    v_dot2c_f32_bf16 v105, v16, v16
    v_dot2c_f32_bf16 v104, s75, v17
    v_dot2c_f32_bf16 v105, v17, v17
    v_dot2c_f32_bf16 v104, s75, v18
    v_dot2c_f32_bf16 v105, v18, v18
    v_dot2c_f32_bf16 v104, s75, v19
    v_dot2c_f32_bf16 v105, v19, v19
    v_dot2c_f32_bf16 v104, s75, v20
    v_dot2c_f32_bf16 v105, v20, v20
    v_dot2c_f32_bf16 v104, s75, v21
    v_dot2c_f32_bf16 v105, v21, v21
    v_dot2c_f32_bf16 v104, s75, v22
    v_dot2c_f32_bf16 v105, v22, v22
    v_dot2c_f32_bf16 v104, s75, v23
    v_dot2c_f32_bf16 v105, v23, v23
    s_nop 2
    v_permlane32_swap_b32 v104, v105
    v_add_f32 v104, v104, v105
    s_cmp_eq_u32 s47, 3
    s_cbranch_scc0 STF_60
    buffer_store_dword v104, v106, s[4:7], s72 offen
STE_61:
    v_and_b32 v68, 0x70, v0
    v_bfe_u32 v69, v0, 7, 1
    v_lshl_or_b32 v68, v69, 3, v68
    v_add_u32 v68, s87, v68
    s_add_u32 s54, s50, 2
    s_add_u32 s71, s64, s86
    s_cmp_gt_i32 s48, 10
    s_cbranch_scc0 NW_62
NWB_63:
    ds_read_b64_tr_b16 v[128:129], v11 offset:32768
    ds_read_b64_tr_b16 v[130:131], v11 offset:33280
    ds_read_b64_tr_b16 v[132:133], v10 offset:32768
    ds_read_b64_tr_b16 v[134:135], v10 offset:33280
    ds_read_b64_tr_b16 v[136:137], v11 offset:34816
    ds_read_b64_tr_b16 v[138:139], v11 offset:35328
    ds_read_b64_tr_b16 v[140:141], v10 offset:34816
    ds_read_b64_tr_b16 v[142:143], v10 offset:35328
    ds_read_b64_tr_b16 v[144:145], v11 offset:36864
    ds_read_b64_tr_b16 v[146:147], v11 offset:37376
    ds_read_b64_tr_b16 v[148:149], v10 offset:36864
    ds_read_b64_tr_b16 v[150:151], v10 offset:37376
    ds_read_b64_tr_b16 v[152:153], v11 offset:38912
    ds_read_b64_tr_b16 v[154:155], v11 offset:39424
    ds_read_b64_tr_b16 v[156:157], v10 offset:38912
    ds_read_b64_tr_b16 v[158:159], v10 offset:39424
    s_cmp_gt_i32 s48, 11
    s_cbranch_scc0 NW_64
NWB_65:
    ds_read_b64_tr_b16 v[160:161], v11 offset:49152
    ds_read_b64_tr_b16 v[162:163], v11 offset:49664
    ds_read_b64_tr_b16 v[164:165], v10 offset:49152
    ds_read_b64_tr_b16 v[166:167], v10 offset:49664
    ds_read_b64_tr_b16 v[168:169], v11 offset:51200
    ds_read_b64_tr_b16 v[170:171], v11 offset:51712
    ds_read_b64_tr_b16 v[172:173], v10 offset:51200
    ds_read_b64_tr_b16 v[174:175], v10 offset:51712
    s_add_u32 s51, s50, 2
    v_mov_b32 v8, s51
    v_mov_b32 v9, 0
    s_mov_b64 exec, 1
    s_cmp_eq_u32 s47, 3
    s_waitcnt vmcnt(0)
    s_cbranch_scc0 STF_66
    buffer_store_dword v8, v9, s[4:7], s68 offen
STE_67:
    s_mov_b64 exec, -1
    buffer_load_dword v69, v68, s[4:7], 0 offen sc1
    ds_read_b64_tr_b16 v[176:177], v11 offset:53248
    ds_read_b64_tr_b16 v[178:179], v11 offset:53760
    ds_read_b64_tr_b16 v[180:181], v10 offset:53248
    ds_read_b64_tr_b16 v[182:183], v10 offset:53760
    ds_read_b64_tr_b16 v[184:185], v11 offset:55296
    ds_read_b64_tr_b16 v[186:187], v11 offset:55808
    ds_read_b64_tr_b16 v[188:189], v10 offset:55296
    ds_read_b64_tr_b16 v[190:191], v10 offset:55808
    s_cmp_gt_i32 s48, 12
    s_cbranch_scc0 NW_71
NWB_72:
    v_xor_b32 v10, 0x10000, v10
    v_xor_b32 v11, 0x10000, v11
    ds_read_b64_tr_b16 v[192:193], v11 offset:0
    ds_read_b64_tr_b16 v[194:195], v11 offset:512
    ds_read_b64_tr_b16 v[196:197], v10 offset:0
    ds_read_b64_tr_b16 v[198:199], v10 offset:512
    ds_read_b64_tr_b16 v[200:201], v11 offset:2048
    ds_read_b64_tr_b16 v[202:203], v11 offset:2560
    ds_read_b64_tr_b16 v[204:205], v10 offset:2048
    ds_read_b64_tr_b16 v[206:207], v10 offset:2560
    ds_read_b64_tr_b16 v[208:209], v11 offset:4096
    ds_read_b64_tr_b16 v[210:211], v11 offset:4608
    ds_read_b64_tr_b16 v[212:213], v10 offset:4096
    ds_read_b64_tr_b16 v[214:215], v10 offset:4608
    s_mov_b32 s55, 0
    s_branch POLLC_69
POLLC_69:
POLL_68:
    buffer_load_dword v70, v68, s[4:7], 0 offen sc1
    s_waitcnt vmcnt(1)
    v_cmp_le_u32 vcc, s54, v69
    s_nop 1
    s_cmp_eq_u64 vcc, -1
    s_cbranch_scc1 POLLD_70
    buffer_load_dword v69, v68, s[4:7], 0 offen sc1
    s_waitcnt vmcnt(1)
    v_cmp_le_u32 vcc, s54, v70
    s_nop 1
    s_cmp_eq_u64 vcc, -1
    s_cbranch_scc1 POLLD_70
    s_add_u32 s55, s55, 1
    s_cmp_lt_u32 s55, 400000
    s_cbranch_scc1 POLL_68
    s_branch ABORT
POLLD_70:
    s_lshl_b32 s51, s45, 12
    s_add_u32 s51, s51, s67
    s_add_u32 s51, s51, 0
    buffer_load_dwordx4 v[112:115], v0, s[4:7], s51 offen offset:0 sc1
    buffer_load_dwordx4 v[116:119], v0, s[4:7], s51 offen offset:1024 sc1
    buffer_load_dwordx4 v[120:123], v0, s[4:7], s51 offen offset:2048 sc1
    buffer_load_dwordx4 v[124:127], v0, s[4:7], s51 offen offset:3072 sc1
    buffer_load_dwordx4 v[64:67], v0, s[4:7], s71 offen offset:0 sc1
    buffer_load_dwordx4 v[68:71], v0, s[4:7], s71 offen offset:1024 sc1
    buffer_load_dwordx4 v[72:75], v0, s[4:7], s71 offen offset:2048 sc1
    buffer_load_dwordx4 v[76:79], v0, s[4:7], s71 offen offset:3072 sc1
    s_add_u32 s71, s71, 4096
    buffer_load_dwordx4 v[80:83], v0, s[4:7], s71 offen offset:0 sc1
    buffer_load_dwordx4 v[84:87], v0, s[4:7], s71 offen offset:1024 sc1
    buffer_load_dwordx4 v[88:91], v0, s[4:7], s71 offen offset:2048 sc1
    buffer_load_dwordx4 v[92:95], v0, s[4:7], s71 offen offset:3072 sc1
    ds_read_b64_tr_b16 v[216:217], v11 offset:6144
    ds_read_b64_tr_b16 v[218:219], v11 offset:6656
    ds_read_b64_tr_b16 v[220:221], v10 offset:6144
    ds_read_b64_tr_b16 v[222:223], v10 offset:6656
    s_cmp_gt_i32 s48, 13
    s_cbranch_scc0 NW_73
NWB_74:
    ds_read_b64_tr_b16 v[224:225], v11 offset:16384
    ds_read_b64_tr_b16 v[226:227], v11 offset:16896
    ds_read_b64_tr_b16 v[228:229], v10 offset:16384
    ds_read_b64_tr_b16 v[230:231], v10 offset:16896
    ds_read_b64_tr_b16 v[232:233], v11 offset:18432
    ds_read_b64_tr_b16 v[234:235], v11 offset:18944
    ds_read_b64_tr_b16 v[236:237], v10 offset:18432
    ds_read_b64_tr_b16 v[238:239], v10 offset:18944
    ds_read_b64_tr_b16 v[240:241], v11 offset:20480
    ds_read_b64_tr_b16 v[242:243], v11 offset:20992
    ds_read_b64_tr_b16 v[244:245], v10 offset:20480
    ds_read_b64_tr_b16 v[246:247], v10 offset:20992
    ds_read_b64_tr_b16 v[248:249], v11 offset:22528
    ds_read_b64_tr_b16 v[250:251], v11 offset:23040
    ds_read_b64_tr_b16 v[252:253], v10 offset:22528
    ds_read_b64_tr_b16 v[254:255], v10 offset:23040
    s_lshl_b32 s53, s77, 8
    s_add_u32 s53, s53, 163200
    s_cmp_eq_u32 s46, 0
    s_cbranch_scc0 HAVECS1
    s_waitcnt lgkmcnt(0)
    v_mov_b32 v25, 0
    v_mov_b32 v27, 0
    v_dot2c_f32_bf16 v25, s75, v128
    v_dot2c_f32_bf16 v25, s75, v129
    v_dot2c_f32_bf16 v25, s75, v130
    v_dot2c_f32_bf16 v25, s75, v131
    v_dot2c_f32_bf16 v27, s75, v132
    v_dot2c_f32_bf16 v27, s75, v133
    v_dot2c_f32_bf16 v27, s75, v134
    v_dot2c_f32_bf16 v27, s75, v135
    v_dot2c_f32_bf16 v25, s75, v136
    v_dot2c_f32_bf16 v25, s75, v137
    v_dot2c_f32_bf16 v25, s75, v138
    v_dot2c_f32_bf16 v25, s75, v139
    v_dot2c_f32_bf16 v27, s75, v140
    v_dot2c_f32_bf16 v27, s75, v141
    v_dot2c_f32_bf16 v27, s75, v142
    v_dot2c_f32_bf16 v27, s75, v143
    v_dot2c_f32_bf16 v25, s75, v144
    v_dot2c_f32_bf16 v25, s75, v145
    v_dot2c_f32_bf16 v25, s75, v146
    v_dot2c_f32_bf16 v25, s75, v147
    v_dot2c_f32_bf16 v27, s75, v148
    v_dot2c_f32_bf16 v27, s75, v149
    v_dot2c_f32_bf16 v27, s75, v150
    v_dot2c_f32_bf16 v27, s75, v151
    v_dot2c_f32_bf16 v25, s75, v152
    v_dot2c_f32_bf16 v25, s75, v153
    v_dot2c_f32_bf16 v25, s75, v154
    v_dot2c_f32_bf16 v25, s75, v155
    v_dot2c_f32_bf16 v27, s75, v156
    v_dot2c_f32_bf16 v27, s75, v157
    v_dot2c_f32_bf16 v27, s75, v158
    v_dot2c_f32_bf16 v27, s75, v159
    v_dot2c_f32_bf16 v25, s75, v160
    v_dot2c_f32_bf16 v25, s75, v161
    v_dot2c_f32_bf16 v25, s75, v162
    v_dot2c_f32_bf16 v25, s75, v163
    v_dot2c_f32_bf16 v27, s75, v164
    v_dot2c_f32_bf16 v27, s75, v165
    v_dot2c_f32_bf16 v27, s75, v166
    v_dot2c_f32_bf16 v27, s75, v167
    v_dot2c_f32_bf16 v25, s75, v168
    v_dot2c_f32_bf16 v25, s75, v169
    v_dot2c_f32_bf16 v25, s75, v170
    v_dot2c_f32_bf16 v25, s75, v171
    v_dot2c_f32_bf16 v27, s75, v172
    v_dot2c_f32_bf16 v27, s75, v173
    v_dot2c_f32_bf16 v27, s75, v174
    v_dot2c_f32_bf16 v27, s75, v175
    v_dot2c_f32_bf16 v25, s75, v176
    v_dot2c_f32_bf16 v25, s75, v177
    v_dot2c_f32_bf16 v25, s75, v178
    v_dot2c_f32_bf16 v25, s75, v179
    v_dot2c_f32_bf16 v27, s75, v180
    v_dot2c_f32_bf16 v27, s75, v181
    v_dot2c_f32_bf16 v27, s75, v182
    v_dot2c_f32_bf16 v27, s75, v183
    v_dot2c_f32_bf16 v25, s75, v184
    v_dot2c_f32_bf16 v25, s75, v185
    v_dot2c_f32_bf16 v25, s75, v186
    v_dot2c_f32_bf16 v25, s75, v187
    v_dot2c_f32_bf16 v27, s75, v188
    v_dot2c_f32_bf16 v27, s75, v189
    v_dot2c_f32_bf16 v27, s75, v190
    v_dot2c_f32_bf16 v27, s75, v191
    v_dot2c_f32_bf16 v25, s75, v192
    v_dot2c_f32_bf16 v25, s75, v193
    v_dot2c_f32_bf16 v25, s75, v194
    v_dot2c_f32_bf16 v25, s75, v195
    v_dot2c_f32_bf16 v27, s75, v196
    v_dot2c_f32_bf16 v27, s75, v197
    v_dot2c_f32_bf16 v27, s75, v198
    v_dot2c_f32_bf16 v27, s75, v199
    v_dot2c_f32_bf16 v25, s75, v200
    v_dot2c_f32_bf16 v25, s75, v201
    v_dot2c_f32_bf16 v25, s75, v202
    v_dot2c_f32_bf16 v25, s75, v203
    v_dot2c_f32_bf16 v27, s75, v204
    v_dot2c_f32_bf16 v27, s75, v205
    v_dot2c_f32_bf16 v27, s75, v206
    v_dot2c_f32_bf16 v27, s75, v207
    v_dot2c_f32_bf16 v25, s75, v208
    v_dot2c_f32_bf16 v25, s75, v209
    v_dot2c_f32_bf16 v25, s75, v210
    v_dot2c_f32_bf16 v25, s75, v211
    v_dot2c_f32_bf16 v27, s75, v212
    v_dot2c_f32_bf16 v27, s75, v213
    v_dot2c_f32_bf16 v27, s75, v214
    v_dot2c_f32_bf16 v27, s75, v215
    v_dot2c_f32_bf16 v25, s75, v216
    v_dot2c_f32_bf16 v25, s75, v217
    v_dot2c_f32_bf16 v25, s75, v218
    v_dot2c_f32_bf16 v25, s75, v219
    v_dot2c_f32_bf16 v27, s75, v220
    v_dot2c_f32_bf16 v27, s75, v221
    v_dot2c_f32_bf16 v27, s75, v222
    v_dot2c_f32_bf16 v27, s75, v223
    v_dot2c_f32_bf16 v25, s75, v224
    v_dot2c_f32_bf16 v25, s75, v225
    v_dot2c_f32_bf16 v25, s75, v226
    v_dot2c_f32_bf16 v25, s75, v227
    v_dot2c_f32_bf16 v27, s75, v228
    v_dot2c_f32_bf16 v27, s75, v229
    v_dot2c_f32_bf16 v27, s75, v230
    v_dot2c_f32_bf16 v27, s75, v231
    v_dot2c_f32_bf16 v25, s75, v232
    v_dot2c_f32_bf16 v25, s75, v233
    v_dot2c_f32_bf16 v25, s75, v234
    v_dot2c_f32_bf16 v25, s75, v235
    v_dot2c_f32_bf16 v27, s75, v236
    v_dot2c_f32_bf16 v27, s75, v237
    v_dot2c_f32_bf16 v27, s75, v238
    v_dot2c_f32_bf16 v27, s75, v239
    v_dot2c_f32_bf16 v25, s75, v240
    v_dot2c_f32_bf16 v25, s75, v241
    v_dot2c_f32_bf16 v25, s75, v242
    v_dot2c_f32_bf16 v25, s75, v243
    v_dot2c_f32_bf16 v27, s75, v244
    v_dot2c_f32_bf16 v27, s75, v245
    v_dot2c_f32_bf16 v27, s75, v246
    v_dot2c_f32_bf16 v27, s75, v247
    v_dot2c_f32_bf16 v25, s75, v248
    v_dot2c_f32_bf16 v25, s75, v249
    v_dot2c_f32_bf16 v25, s75, v250
    v_dot2c_f32_bf16 v25, s75, v251
    v_dot2c_f32_bf16 v27, s75, v252
    v_dot2c_f32_bf16 v27, s75, v253
    v_dot2c_f32_bf16 v27, s75, v254
    v_dot2c_f32_bf16 v27, s75, v255
    v_lshrrev_b32 v24, 2, v0
    v_add_u32 v24, s53, v24
    s_nop 0
    v_permlane32_swap_b32 v25, v27
    v_add_f32 v25, v25, v27
    ds_write_b32 v24, v25
HAVECS1:
    v_bfe_u32 v24, v0, 4, 5
    v_lshl_add_u32 v24, v24, 2, s53
    ds_read_b32 v25, v24
    ds_read_b32 v27, v24 offset:128
    s_cmp_eq_u32 s45, 0
    s_cselect_b32 s52, 0, 0x18000
    s_mul_i32 s51, s77, 8256
    s_add_u32 s51, s51, s52
    v_xor_b32 v10, s51, v2
    v_xor_b32 v11, 64, v10
    s_waitcnt vmcnt(7) lgkmcnt(15)
    v_mfma_f32_32x32x16_bf16 v[48:63], v[128:131], v[64:67], 0
    v_pk_add_f32 v[112:113], v[112:113], v[120:121]
    v_pk_add_f32 v[114:115], v[114:115], v[122:123]
    v_pk_add_f32 v[116:117], v[116:117], v[124:125]
    v_pk_add_f32 v[118:119], v[118:119], v[126:127]
    v_pk_add_f32 v[112:113], v[112:113], v[116:117]
    v_pk_add_f32 v[114:115], v[114:115], v[118:119]
    v_pk_add_f32 v[30:31], v[112:113], v[114:115]
    v_mfma_f32_32x32x16_bf16 v[32:47], v[132:135], v[64:67], 0
    s_add_u32 s71, s71, 4096
    buffer_load_dwordx4 v[96:99], v0, s[4:7], s71 offen offset:0 sc1
    v_mov_b32 v12, v30
    s_waitcnt vmcnt(7)
    v_mfma_f32_32x32x16_bf16 v[48:63], v[136:139], v[68:71], v[48:63]
    v_mov_b32 v13, v31
    v_mfma_f32_32x32x16_bf16 v[32:47], v[140:143], v[68:71], v[32:47]
    buffer_load_dwordx4 v[100:103], v0, s[4:7], s71 offen offset:1024 sc1
    v_permlane32_swap_b32 v30, v12
    s_waitcnt vmcnt(7)
    v_mfma_f32_32x32x16_bf16 v[48:63], v[144:147], v[72:75], v[48:63]
    v_permlane32_swap_b32 v31, v13
    s_waitcnt lgkmcnt(0)
    v_mov_b32 v29, 0
    v_cvt_pk_bf16_f32 v24, v25, v25
    v_and_b32 v28, 0xffff0000, v24
    v_sub_f32 v25, v25, v28
    v_cvt_pk_bf16_f32 v25, v25, 0
    v_cvt_pk_bf16_f32 v26, v27, v27
    v_and_b32 v28, 0xffff0000, v26
    v_sub_f32 v27, v27, v28
    v_cvt_pk_bf16_f32 v27, v27, 0
    v_mfma_f32_32x32x16_bf16 v[32:47], v[148:151], v[72:75], v[32:47]
    buffer_load_dwordx4 v[104:107], v0, s[4:7], s71 offen offset:2048 sc1
    v_pk_add_f32 v[30:31], v[30:31], v[12:13]
    s_waitcnt vmcnt(7)
    v_mfma_f32_32x32x16_bf16 v[48:63], v[152:155], v[76:79], v[48:63]
    v_mul_f32 v66, 0xba800000, v30
    v_cvt_pk_bf16_f32 v65, v66, 0
    v_mfma_f32_32x32x16_bf16 v[32:47], v[156:159], v[76:79], v[32:47]
    buffer_load_dwordx4 v[108:111], v0, s[4:7], s71 offen offset:3072 sc1
    v_lshlrev_b32 v67, 16, v65
    v_sub_f32 v67, v66, v67
    s_waitcnt vmcnt(7)
    v_mfma_f32_32x32x16_bf16 v[48:63], v[160:163], v[80:83], v[48:63]
    v_add_u32 v6, 4, v6
    ds_write_b32 v5, v6
    v_cvt_pk_bf16_f32 v64, v66, v67
    v_mov_b32 v66, 0
    v_mfma_f32_32x32x16_bf16 v[32:47], v[164:167], v[80:83], v[32:47]
    s_add_u32 s71, s71, 4096
    buffer_load_dwordx4 v[112:115], v0, s[4:7], s71 offen offset:0 sc1
    v_mov_b32 v67, 0
    v_mul_f32 v14, 0x3b000000, v30
    s_waitcnt vmcnt(7)
    v_mfma_f32_32x32x16_bf16 v[48:63], v[168:171], v[84:87], v[48:63]
    v_mul_f32 v31, 0x3b000000, v31
    v_fma_f32 v31, -v14, v14, v31
    v_mfma_f32_32x32x16_bf16 v[32:47], v[172:175], v[84:87], v[32:47]
    buffer_load_dwordx4 v[116:119], v0, s[4:7], s71 offen offset:1024 sc1
    v_max_f32 v31, 0, v31
    v_add_f32 v15, 0x3727c5ac, v31
    s_waitcnt vmcnt(7)
    v_mfma_f32_32x32x16_bf16 v[48:63], v[176:179], v[88:91], v[48:63]
    v_rsq_f32 v15, v15
    s_nop 0
    v_mul_f32 v30, v15, v15
    s_lshl_b32 s51, s42, 12
    v_mfma_f32_32x32x16_bf16 v[32:47], v[180:183], v[88:91], v[32:47]
    buffer_load_dwordx4 v[120:123], v0, s[4:7], s71 offen offset:2048 sc1
    v_mul_f32 v30, v30, v31
    v_add_f32 v30, 0x3727c5ac, v30
    s_add_u32 s51, s51, 131072
    s_waitcnt vmcnt(7)
    v_mfma_f32_32x32x16_bf16 v[48:63], v[184:187], v[92:95], v[48:63]
    v_rsq_f32 v30, v30
    s_nop 0
    v_mul_f32 v31, v30, v15
    v_add_u32 v80, s51, v0
    v_mfma_f32_32x32x16_bf16 v[32:47], v[188:191], v[92:95], v[32:47]
    buffer_load_dwordx4 v[124:127], v0, s[4:7], s71 offen offset:3072 sc1
    v_rcp_f32 v30, v31
    v_mul_f32 v13, v31, v31
    v_xor_b32 v81, 0x2000, v80
    s_waitcnt vmcnt(7)
    v_mfma_f32_32x32x16_bf16 v[48:63], v[192:195], v[96:99], v[48:63]
    v_mul_f32 v12, 0xc0135761, v31
    v_mul_f32 v13, v13, v12
    v_xor_b32 v82, 8, v5
    v_mfma_f32_32x32x16_bf16 v[32:47], v[196:199], v[96:99], v[32:47]
    v_mul_f32 v13, 0x3d372713, v13
    s_add_u32 s73, s65, s85
    s_add_u32 s70, s70, 1
    s_waitcnt vmcnt(6)
    v_mfma_f32_32x32x16_bf16 v[48:63], v[200:203], v[100:103], v[48:63]
    s_add_u32 s72, s73, 32768
    s_add_u32 s72, s72, s61
    v_mov_b32 v83, s70
    v_mfma_f32_32x32x16_bf16 v[32:47], v[204:207], v[100:103], v[32:47]
    v_and_b32 v90, 0x70, v0
    v_bfe_u32 v91, v0, 7, 1
    v_lshl_or_b32 v91, v91, 3, v90
    v_add_u32 v90, s79, v91
    s_mov_b64 exec, 0xffff
    v_add_u32 v90, s78, v91
    s_mov_b64 exec, -1
    buffer_load_dword v91, v90, s[4:7], 0 offen sc1
    s_lshr_b32 s53, s44, 2
    s_add_u32 s53, s53, 1
    s_waitcnt vmcnt(6)
    v_mfma_f32_32x32x16_bf16 v[48:63], v[208:211], v[104:107], v[48:63]
    s_sub_u32 s89, 32, s53
    s_add_u32 s53, s53, 32
    v_mfma_f32_32x32x16_bf16 v[48:63], v[24:27], v[64:67], v[48:63]
    v_mfma_f32_32x32x16_bf16 v[32:47], v[212:215], v[104:107], v[32:47]
    s_bitcmp1_b32 s44, 1
    s_cselect_b32 s53, s89, s53
    v_bfe_u32 v88, v0, 4, 5
    v_mfma_f32_32x32x16_bf16 v[32:47], v[26:29], v[64:67], v[32:47]
    s_waitcnt vmcnt(5)
    v_mfma_f32_32x32x16_bf16 v[48:63], v[216:219], v[108:111], v[48:63]
    v_add_u32 v88, s53, v88
    v_lshrrev_b32 v89, 5, v88
    ds_read_b64 v[8:9], v4 offset:32
    v_mfma_f32_32x32x16_bf16 v[32:47], v[220:223], v[108:111], v[32:47]
    v_and_b32 v88, 31, v88
    v_lshlrev_b32 v88, 4, v88
    v_xor_b32 v87, 8, v5
    ds_read_b32 v86, v87 offset:64
    s_waitcnt vmcnt(4)
    v_mfma_f32_32x32x16_bf16 v[48:63], v[224:227], v[112:115], v[48:63]
    v_lshl_or_b32 v88, v89, 15, v88
    v_and_b32 v89, 0x200, v0
    v_mfma_f32_32x32x16_bf16 v[32:47], v[228:231], v[112:115], v[32:47]
    v_or_b32 v88, v88, v89
    s_waitcnt vmcnt(3)
    v_mfma_f32_32x32x16_bf16 v[48:63], v[232:235], v[116:119], v[48:63]
    s_waitcnt lgkmcnt(1)
    v_min_u32 v8, v8, v9
    s_nop 0
    v_readfirstlane_b32 s48, v8
    s_nop 1
    s_sub_i32 s48, s48, s49
    v_mfma_f32_32x32x16_bf16 v[32:47], v[236:239], v[116:119], v[32:47]
    s_waitcnt lgkmcnt(0)
    v_readfirstlane_b32 s52, v86
    s_nop 1
    s_cmp_ge_u32 s52, s84
    s_cbranch_scc1 CK_75
    s_mov_b32 s55, 0
LW_76:
    ds_read_b32 v86, v87 offset:64
    s_waitcnt lgkmcnt(0)
    v_readfirstlane_b32 s52, v86
    s_nop 1
    s_cmp_ge_u32 s52, s84
    s_cbranch_scc1 LWD_77
    s_add_u32 s55, s55, 1
    s_cmp_lt_u32 s55, 4000000
    s_cbranch_scc1 LW_76
    s_branch ABORT
LWD_77:
CK_75:
    s_waitcnt vmcnt(2)
    v_mfma_f32_32x32x16_bf16 v[48:63], v[240:243], v[120:123], v[48:63]
    v_mfma_f32_32x32x16_bf16 v[32:47], v[244:247], v[120:123], v[32:47]
    s_waitcnt vmcnt(1)
    v_mfma_f32_32x32x16_bf16 v[48:63], v[248:251], v[124:127], v[48:63]
    v_mfma_f32_32x32x16_bf16 v[32:47], v[252:255], v[124:127], v[32:47]
    s_nop 10
    ds_write_b128 v80, v[48:51] offset:0
    ds_write_b128 v80, v[52:55] offset:1024
    ds_write_b128 v80, v[56:59] offset:2048
    ds_write_b128 v80, v[60:63] offset:3072
    ds_write_b32 v5, v83 offset:32
    s_mov_b32 s55, 0
    ds_read_b32 v84, v82 offset:32
    ds_read_b128 v[64:67], v81 offset:0
    ds_read_b128 v[68:71], v81 offset:1024
    ds_read_b128 v[72:75], v81 offset:2048
    ds_read_b128 v[76:79], v81 offset:3072
    s_waitcnt vmcnt(0)
    v_cmp_le_u32 vcc, s54, v91
    s_nop 1
    s_cmp_eq_u64 vcc, -1
    s_cbranch_scc1 NB_81
    s_mov_b32 s55, 0
POLL_82:
    buffer_load_dword v91, v90, s[4:7], 0 offen sc1
POLLC_83:
    s_waitcnt vmcnt(0)
    v_cmp_le_u32 vcc, s54, v91
    s_nop 1
    s_cmp_eq_u64 vcc, -1
    s_cbranch_scc1 POLLD_84
    s_add_u32 s55, s55, 1
    s_cmp_lt_u32 s55, 400000
    s_cbranch_scc1 POLL_82
    s_branch ABORT
POLLD_84:
NB_81:
    s_branch XCC_80
XC_78:
    ds_read_b32 v84, v82 offset:32
    ds_read_b128 v[64:67], v81 offset:0
    ds_read_b128 v[68:71], v81 offset:1024
    ds_read_b128 v[72:75], v81 offset:2048
    ds_read_b128 v[76:79], v81 offset:3072
XCC_80:
    s_waitcnt lgkmcnt(4)
    v_readfirstlane_b32 s52, v84
    s_nop 1
    s_cmp_ge_u32 s52, s70
    s_cbranch_scc1 XCD_79
    s_add_u32 s55, s55, 1
    s_cmp_lt_u32 s55, 4000000
    s_cbranch_scc1 XC_78
    s_branch ABORT
XCD_79:
    s_waitcnt lgkmcnt(3)
    v_pk_add_f32 v[32:33], v[32:33], v[64:65]
    v_pk_add_f32 v[34:35], v[34:35], v[66:67]
    s_waitcnt lgkmcnt(2)
    v_pk_add_f32 v[36:37], v[36:37], v[68:69]
    v_pk_add_f32 v[38:39], v[38:39], v[70:71]
    s_waitcnt lgkmcnt(1)
    v_pk_add_f32 v[40:41], v[40:41], v[72:73]
    v_pk_add_f32 v[42:43], v[42:43], v[74:75]
    s_waitcnt lgkmcnt(0)
    v_pk_add_f32 v[44:45], v[44:45], v[76:77]
    v_pk_add_f32 v[46:47], v[46:47], v[78:79]
    ds_write_b32 v5, v83 offset:64
    s_mov_b32 s84, s70
    v_pk_mul_f32 v[64:65], v[32:33], v[32:33]
    v_pk_mul_f32 v[66:67], v[34:35], v[34:35]
    v_pk_mul_f32 v[68:69], v[36:37], v[36:37]
    v_pk_mul_f32 v[70:71], v[38:39], v[38:39]
    v_pk_fma_f32 v[64:65], v[12:13], v[64:65], v[12:13] op_sel:[1,0,0] op_sel_hi:[1,1,0]
    v_pk_fma_f32 v[66:67], v[12:13], v[66:67], v[12:13] op_sel:[1,0,0] op_sel_hi:[1,1,0]
    v_pk_fma_f32 v[68:69], v[12:13], v[68:69], v[12:13] op_sel:[1,0,0] op_sel_hi:[1,1,0]
    v_pk_fma_f32 v[70:71], v[12:13], v[70:71], v[12:13] op_sel:[1,0,0] op_sel_hi:[1,1,0]
    v_pk_mul_f32 v[64:65], v[64:65], v[32:33]
    v_pk_mul_f32 v[66:67], v[66:67], v[34:35]
    v_pk_mul_f32 v[68:69], v[68:69], v[36:37]
    v_pk_mul_f32 v[70:71], v[70:71], v[38:39]
    v_pk_mul_f32 v[72:73], v[40:41], v[40:41]
    v_exp_f32 v64, v64
    v_pk_mul_f32 v[74:75], v[42:43], v[42:43]
    v_exp_f32 v65, v65
    v_pk_mul_f32 v[76:77], v[44:45], v[44:45]
    v_exp_f32 v66, v66
    v_pk_mul_f32 v[78:79], v[46:47], v[46:47]
    v_exp_f32 v67, v67
    v_pk_fma_f32 v[72:73], v[12:13], v[72:73], v[12:13] op_sel:[1,0,0] op_sel_hi:[1,1,0]
    v_exp_f32 v68, v68
    v_pk_fma_f32 v[74:75], v[12:13], v[74:75], v[12:13] op_sel:[1,0,0] op_sel_hi:[1,1,0]
    v_exp_f32 v69, v69
    v_pk_fma_f32 v[76:77], v[12:13], v[76:77], v[12:13] op_sel:[1,0,0] op_sel_hi:[1,1,0]
    v_exp_f32 v70, v70
    v_pk_fma_f32 v[78:79], v[12:13], v[78:79], v[12:13] op_sel:[1,0,0] op_sel_hi:[1,1,0]
    v_exp_f32 v71, v71
    v_pk_mul_f32 v[72:73], v[72:73], v[40:41]
    v_pk_fma_f32 v[64:65], v[64:65], v[30:31], v[30:31] op_sel:[0,0,0] op_sel_hi:[1,0,0]
    v_pk_mul_f32 v[74:75], v[74:75], v[42:43]
    v_pk_fma_f32 v[66:67], v[66:67], v[30:31], v[30:31] op_sel:[0,0,0] op_sel_hi:[1,0,0]
    v_pk_mul_f32 v[76:77], v[76:77], v[44:45]
    v_pk_fma_f32 v[68:69], v[68:69], v[30:31], v[30:31] op_sel:[0,0,0] op_sel_hi:[1,0,0]
    v_pk_mul_f32 v[78:79], v[78:79], v[46:47]
    v_pk_fma_f32 v[70:71], v[70:71], v[30:31], v[30:31] op_sel:[0,0,0] op_sel_hi:[1,0,0]
    v_exp_f32 v72, v72
    v_rcp_f32 v64, v64
    v_exp_f32 v73, v73
    v_rcp_f32 v65, v65
    v_exp_f32 v74, v74
    v_rcp_f32 v66, v66
    v_exp_f32 v75, v75
    v_rcp_f32 v67, v67
    v_exp_f32 v76, v76
    v_rcp_f32 v68, v68
    v_exp_f32 v77, v77
    v_rcp_f32 v69, v69
    v_exp_f32 v78, v78
    v_rcp_f32 v70, v70
    v_exp_f32 v79, v79
    v_rcp_f32 v71, v71
    v_pk_fma_f32 v[72:73], v[72:73], v[30:31], v[30:31] op_sel:[0,0,0] op_sel_hi:[1,0,0]
    v_pk_mul_f32 v[64:65], v[64:65], v[32:33]
    v_pk_fma_f32 v[74:75], v[74:75], v[30:31], v[30:31] op_sel:[0,0,0] op_sel_hi:[1,0,0]
    v_pk_mul_f32 v[66:67], v[66:67], v[34:35]
    v_pk_fma_f32 v[76:77], v[76:77], v[30:31], v[30:31] op_sel:[0,0,0] op_sel_hi:[1,0,0]
    v_pk_mul_f32 v[68:69], v[68:69], v[36:37]
    v_pk_fma_f32 v[78:79], v[78:79], v[30:31], v[30:31] op_sel:[0,0,0] op_sel_hi:[1,0,0]
    v_pk_mul_f32 v[70:71], v[70:71], v[38:39]
    v_rcp_f32 v72, v72
    v_cvt_pk_bf16_f32 v32, v64, v65
    v_rcp_f32 v73, v73
    v_cvt_pk_bf16_f32 v33, v66, v67
    v_rcp_f32 v74, v74
    v_cvt_pk_bf16_f32 v34, v68, v69
    v_rcp_f32 v75, v75
    v_cvt_pk_bf16_f32 v35, v70, v71
    v_rcp_f32 v76, v76
    v_rcp_f32 v77, v77
    v_rcp_f32 v78, v78
    v_rcp_f32 v79, v79
    v_pk_mul_f32 v[72:73], v[72:73], v[40:41]
    v_pk_mul_f32 v[74:75], v[74:75], v[42:43]
    v_pk_mul_f32 v[76:77], v[76:77], v[44:45]
    v_pk_mul_f32 v[78:79], v[78:79], v[46:47]
    v_cvt_pk_bf16_f32 v40, v72, v73
    v_cvt_pk_bf16_f32 v41, v74, v75
    v_cvt_pk_bf16_f32 v42, v76, v77
    v_cvt_pk_bf16_f32 v43, v78, v79
    s_cmp_eq_u32 s47, 3
    s_cbranch_scc0 STF_85
    buffer_store_dwordx4 v[32:35], v88, s[4:7], s73 offen
    buffer_store_dwordx4 v[40:43], v88, s[4:7], s73 offen offset:1024
STE_86:
    v_min_u32 v48, -2, v32
    v_min_u32 v49, -2, v33
    v_min_u32 v50, -2, v34
    v_min_u32 v51, -2, v35
    v_min_u32 v56, -2, v40
    v_min_u32 v57, -2, v41
    v_min_u32 v58, -2, v42
    v_min_u32 v59, -2, v43
    s_cmp_eq_u32 s60, 0
    s_cselect_b32 s72, 0x70000000, s72
    s_mov_b64 exec, s[58:59]
    buffer_store_dwordx4 v[48:51], v0, s[4:7], s72 offen sc1
    buffer_store_dwordx4 v[56:59], v0, s[4:7], s72 offen offset:1024 sc1
    s_mov_b64 exec, -1
    s_add_u32 s71, s65, s86
    v_bfe_u32 v64, v0, 4, 5
    v_and_b32 v65, 0x200, v0
    s_sub_u32 s51, 31, s77
    s_add_u32 s52, 33, s77
    v_add_u32 v66, s51, v64
    v_lshrrev_b32 v67, 5, v66
    v_and_b32 v66, 31, v66
    v_lshl_or_b32 v66, v66, 4, v65
    v_lshl_or_b32 v66, v67, 15, v66
    s_cmp_eq_u32 s45, 0
    s_cselect_b32 s53, 0, 7
    v_cmp_eq_u32 vcc, s53, v67
    v_add_u32 v67, 0x8000, v0
    s_nop 0
    v_cndmask_b32 v12, v67, v66, vcc
    v_add_u32 v66, s52, v64
    v_lshrrev_b32 v67, 5, v66
    v_and_b32 v66, 31, v66
    v_lshl_or_b32 v66, v66, 4, v65
    v_lshl_or_b32 v66, v67, 15, v66
    s_cmp_eq_u32 s45, 3
    s_cselect_b32 s53, 2, 7
    v_cmp_eq_u32 vcc, s53, v67
    v_add_u32 v67, 0x8000, v0
    s_nop 0
    v_cndmask_b32 v13, v67, v66, vcc
    v_add_u32 v13, 8192, v13
    s_cmp_eq_u32 s45, 0
    s_cbranch_scc0 NOSWAP
    v_swap_b32 v12, v13
NOSWAP:
    s_lshl_b32 s51, s77, 6
    s_add_u32 s52, s51, s78
    s_add_u32 s53, s51, s79
    s_add_u32 s53, s53, 32
    s_add_u32 s51, s51, s87
    v_and_b32 v68, 0x30, v0
    v_bfe_u32 v69, v0, 6, 1
    v_lshl_or_b32 v68, v69, 3, v68
    v_add_u32 v68, s51, v68
    v_and_b32 v69, 0x10, v0
    v_bfe_u32 v70, v0, 5, 1
    v_lshl_or_b32 v69, v70, 3, v69
    s_mov_b64 exec, 0x0f00
    v_add_u32 v68, s52, v69
    s_mov_b64 exec, 0xf000
    v_add_u32 v68, s53, v69
    s_mov_b64 exec, -1
    s_add_u32 s73, s64, s85
    s_add_u32 s54, s50, 3
    v_bfe_u32 v28, v0, 5, 4
    v_lshlrev_b32 v28, 9, v28
    v_and_b32 v29, 16, v0
    v_or_b32 v28, v28, v29
    s_lshl_b32 s53, s77, 14
    s_add_u32 s53, s53, s65
    s_cmp_eq_u32 s45, 0
    s_cselect_b32 s52, 480, 0
    s_cselect_b32 s51, 0, 172032
    s_add_u32 s53, s53, s52
    s_add_u32 s53, s53, s51
    s_cmp_gt_i32 s48, 17
    s_cbranch_scc0 NW_87
NWB_88:
    ds_read_b64_tr_b16 v[128:129], v11 offset:0
    ds_read_b64_tr_b16 v[130:131], v11 offset:512
    ds_read_b64_tr_b16 v[132:133], v10 offset:0
    ds_read_b64_tr_b16 v[134:135], v10 offset:512
    ds_read_b64_tr_b16 v[136:137], v11 offset:2048
    ds_read_b64_tr_b16 v[138:139], v11 offset:2560
    ds_read_b64_tr_b16 v[140:141], v10 offset:2048
    ds_read_b64_tr_b16 v[142:143], v10 offset:2560
    ds_read_b64_tr_b16 v[144:145], v11 offset:4096
    ds_read_b64_tr_b16 v[146:147], v11 offset:4608
    ds_read_b64_tr_b16 v[148:149], v10 offset:4096
    ds_read_b64_tr_b16 v[150:151], v10 offset:4608
    ds_read_b64_tr_b16 v[152:153], v11 offset:6144
    ds_read_b64_tr_b16 v[154:155], v11 offset:6656
    ds_read_b64_tr_b16 v[156:157], v10 offset:6144
    ds_read_b64_tr_b16 v[158:159], v10 offset:6656
    s_cmp_gt_i32 s48, 17
    s_cbranch_scc0 NW_89
NWB_90:
    ds_read_b64_tr_b16 v[160:161], v11 offset:16384
    ds_read_b64_tr_b16 v[162:163], v11 offset:16896
    ds_read_b64_tr_b16 v[164:165], v10 offset:16384
    ds_read_b64_tr_b16 v[166:167], v10 offset:16896
    ds_read_b64_tr_b16 v[168:169], v11 offset:18432
    ds_read_b64_tr_b16 v[170:171], v11 offset:18944
    ds_read_b64_tr_b16 v[172:173], v10 offset:18432
    ds_read_b64_tr_b16 v[174:175], v10 offset:18944
    s_add_u32 s51, s50, 3
    v_mov_b32 v8, s51
    v_mov_b32 v9, 0
    s_mov_b64 exec, 1
    s_cmp_eq_u32 s47, 3
    s_waitcnt vmcnt(2)
    s_cbranch_scc0 STF_91
    buffer_store_dword v8, v9, s[4:7], s68 offen
STE_92:
    s_mov_b64 exec, -1
    buffer_load_dword v69, v68, s[4:7], 0 offen sc1
    ds_read_b64_tr_b16 v[176:177], v11 offset:20480
    ds_read_b64_tr_b16 v[178:179], v11 offset:20992
    ds_read_b64_tr_b16 v[180:181], v10 offset:20480
    ds_read_b64_tr_b16 v[182:183], v10 offset:20992
    ds_read_b64_tr_b16 v[184:185], v11 offset:22528
    ds_read_b64_tr_b16 v[186:187], v11 offset:23040
    ds_read_b64_tr_b16 v[188:189], v10 offset:22528
    ds_read_b64_tr_b16 v[190:191], v10 offset:23040
    s_cmp_gt_i32 s48, 17
    s_cbranch_scc0 NW_96
NWB_97:
    v_xor_b32 v10, 0x18000, v10
    v_xor_b32 v11, 0x18000, v11
    ds_read_b64_tr_b16 v[192:193], v11 offset:0
    ds_read_b64_tr_b16 v[194:195], v11 offset:512
    ds_read_b64_tr_b16 v[196:197], v10 offset:0
    ds_read_b64_tr_b16 v[198:199], v10 offset:512
    ds_read_b64_tr_b16 v[200:201], v11 offset:2048
    ds_read_b64_tr_b16 v[202:203], v11 offset:2560
    ds_read_b64_tr_b16 v[204:205], v10 offset:2048
    ds_read_b64_tr_b16 v[206:207], v10 offset:2560
    ds_read_b64_tr_b16 v[208:209], v11 offset:4096
    ds_read_b64_tr_b16 v[210:211], v11 offset:4608
    ds_read_b64_tr_b16 v[212:213], v10 offset:4096
    ds_read_b64_tr_b16 v[214:215], v10 offset:4608
    s_mov_b32 s55, 0
    s_branch POLLC_94
POLLC_94:
POLL_93:
    buffer_load_dword v70, v68, s[4:7], 0 offen sc1
    s_waitcnt vmcnt(1)
    v_cmp_le_u32 vcc, s54, v69
    s_nop 1
    s_cmp_eq_u64 vcc, -1
    s_cbranch_scc1 POLLD_95
    buffer_load_dword v69, v68, s[4:7], 0 offen sc1
    s_waitcnt vmcnt(1)
    v_cmp_le_u32 vcc, s54, v70
    s_nop 1
    s_cmp_eq_u64 vcc, -1
    s_cbranch_scc1 POLLD_95
    s_add_u32 s55, s55, 1
    s_cmp_lt_u32 s55, 400000
    s_cbranch_scc1 POLL_93
    s_branch ABORT
POLLD_95:
    s_add_u32 s51, s45, 1
    s_bitcmp1_b32 s51, 1
    s_cselect_b32 s53, 0x70000000, s53
    buffer_load_dwordx4 v[24:27], v28, s[4:7], s53 offen sc1
    buffer_load_dwordx4 v[64:67], v12, s[4:7], s71 offen offset:0 sc1
    buffer_load_dwordx4 v[68:71], v12, s[4:7], s71 offen offset:1024 sc1
    buffer_load_dwordx4 v[72:75], v12, s[4:7], s71 offen offset:2048 sc1
    buffer_load_dwordx4 v[76:79], v12, s[4:7], s71 offen offset:3072 sc1
    s_add_u32 s71, s71, 4096
    buffer_load_dwordx4 v[80:83], v12, s[4:7], s71 offen offset:0 sc1
    buffer_load_dwordx4 v[84:87], v12, s[4:7], s71 offen offset:1024 sc1
    buffer_load_dwordx4 v[88:91], v12, s[4:7], s71 offen offset:2048 sc1
    buffer_load_dwordx4 v[92:95], v12, s[4:7], s71 offen offset:3072 sc1
    ds_read_b64_tr_b16 v[216:217], v11 offset:6144
    ds_read_b64_tr_b16 v[218:219], v11 offset:6656
    ds_read_b64_tr_b16 v[220:221], v10 offset:6144
    ds_read_b64_tr_b16 v[222:223], v10 offset:6656
    s_cmp_gt_i32 s48, 17
    s_cbranch_scc0 NW_98
NWB_99:
    ds_read_b64_tr_b16 v[224:225], v11 offset:16384
    ds_read_b64_tr_b16 v[226:227], v11 offset:16896
    ds_read_b64_tr_b16 v[228:229], v10 offset:16384
    ds_read_b64_tr_b16 v[230:231], v10 offset:16896
    ds_read_b64_tr_b16 v[232:233], v11 offset:18432
    ds_read_b64_tr_b16 v[234:235], v11 offset:18944
    ds_read_b64_tr_b16 v[236:237], v10 offset:18432
    ds_read_b64_tr_b16 v[238:239], v10 offset:18944
    ds_read_b64_tr_b16 v[240:241], v11 offset:20480
    ds_read_b64_tr_b16 v[242:243], v11 offset:20992
    ds_read_b64_tr_b16 v[244:245], v10 offset:20480
    ds_read_b64_tr_b16 v[246:247], v10 offset:20992
    ds_read_b64_tr_b16 v[248:249], v11 offset:22528
    ds_read_b64_tr_b16 v[250:251], v11 offset:23040
    ds_read_b64_tr_b16 v[252:253], v10 offset:22528
    ds_read_b64_tr_b16 v[254:255], v10 offset:23040
    s_waitcnt vmcnt(7) lgkmcnt(15)
    v_mfma_f32_32x32x16_bf16 v[48:63], v[128:131], v[64:67], 0
    v_mfma_f32_32x32x16_bf16 v[32:47], v[132:135], v[64:67], 0
    s_mov_b32 s55, 0
P4_PC:
    v_max3_u32 v24, v24, v25, v26
    v_max_u32 v24, v24, v27
    v_cmp_eq_u32 vcc, -1, v24
    s_nop 1
    s_cmp_eq_u64 vcc, 0
    s_cbranch_scc0 P4_PR
    s_add_u32 s71, s71, 4294963200
    buffer_load_dwordx4 v[96:99], v13, s[4:7], s71 offen offset:0 sc1
    s_waitcnt vmcnt(7)
    v_mfma_f32_32x32x16_bf16 v[48:63], v[136:139], v[68:71], v[48:63]
    v_mfma_f32_32x32x16_bf16 v[32:47], v[140:143], v[68:71], v[32:47]
    buffer_load_dwordx4 v[100:103], v13, s[4:7], s71 offen offset:1024 sc1
    s_waitcnt vmcnt(7)
    v_mfma_f32_32x32x16_bf16 v[48:63], v[144:147], v[72:75], v[48:63]
    v_mfma_f32_32x32x16_bf16 v[32:47], v[148:151], v[72:75], v[32:47]
    buffer_load_dwordx4 v[104:107], v13, s[4:7], s71 offen offset:2048 sc1
    s_waitcnt vmcnt(7)
    v_mfma_f32_32x32x16_bf16 v[48:63], v[152:155], v[76:79], v[48:63]
    v_mfma_f32_32x32x16_bf16 v[32:47], v[156:159], v[76:79], v[32:47]
    buffer_load_dwordx4 v[108:111], v13, s[4:7], s71 offen offset:3072 sc1
    s_waitcnt vmcnt(7)
    v_mfma_f32_32x32x16_bf16 v[48:63], v[160:163], v[80:83], v[48:63]
    v_add_u32 v6, 3, v6
    ds_write_b32 v5, v6
    v_mfma_f32_32x32x16_bf16 v[32:47], v[164:167], v[80:83], v[32:47]
    s_add_u32 s71, s71, 4096
    buffer_load_dwordx4 v[112:115], v13, s[4:7], s71 offen offset:0 sc1
    s_waitcnt vmcnt(7)
    v_mfma_f32_32x32x16_bf16 v[48:63], v[168:171], v[84:87], v[48:63]
    v_mfma_f32_32x32x16_bf16 v[32:47], v[172:175], v[84:87], v[32:47]
    buffer_load_dwordx4 v[116:119], v13, s[4:7], s71 offen offset:1024 sc1
    s_waitcnt vmcnt(7)
    v_mfma_f32_32x32x16_bf16 v[48:63], v[176:179], v[88:91], v[48:63]
    s_lshl_b32 s51, s42, 12
    v_mfma_f32_32x32x16_bf16 v[32:47], v[180:183], v[88:91], v[32:47]
    buffer_load_dwordx4 v[120:123], v13, s[4:7], s71 offen offset:2048 sc1
    s_add_u32 s51, s51, 131072
    s_waitcnt vmcnt(7)
    v_mfma_f32_32x32x16_bf16 v[48:63], v[184:187], v[92:95], v[48:63]
    v_add_u32 v80, s51, v0
    v_mfma_f32_32x32x16_bf16 v[32:47], v[188:191], v[92:95], v[32:47]
    buffer_load_dwordx4 v[124:127], v13, s[4:7], s71 offen offset:3072 sc1
    v_xor_b32 v81, 0x2000, v80
    s_waitcnt vmcnt(7)
    v_mfma_f32_32x32x16_bf16 v[48:63], v[192:195], v[96:99], v[48:63]
    v_xor_b32 v82, 8, v5
    v_mfma_f32_32x32x16_bf16 v[32:47], v[196:199], v[96:99], v[32:47]
    s_add_u32 s70, s70, 1
    s_waitcnt vmcnt(6)
    v_mfma_f32_32x32x16_bf16 v[48:63], v[200:203], v[100:103], v[48:63]
    v_mov_b32 v83, s70
    v_mfma_f32_32x32x16_bf16 v[32:47], v[204:207], v[100:103], v[32:47]
    s_waitcnt vmcnt(5)
    v_mfma_f32_32x32x16_bf16 v[48:63], v[208:211], v[104:107], v[48:63]
    v_lshlrev_b32 v88, 16, v16
    v_and_b32 v89, 0xffff0000, v16
    v_mfma_f32_32x32x16_bf16 v[32:47], v[212:215], v[104:107], v[32:47]
    v_lshlrev_b32 v90, 16, v17
    v_and_b32 v91, 0xffff0000, v17
    s_waitcnt vmcnt(4)
    v_mfma_f32_32x32x16_bf16 v[48:63], v[216:219], v[108:111], v[48:63]
    v_lshlrev_b32 v92, 16, v18
    v_and_b32 v93, 0xffff0000, v18
    ds_read_b64 v[8:9], v4 offset:32
    v_mfma_f32_32x32x16_bf16 v[32:47], v[220:223], v[108:111], v[32:47]
    v_lshlrev_b32 v94, 16, v19
    v_and_b32 v95, 0xffff0000, v19
    v_xor_b32 v87, 8, v5
    ds_read_b32 v86, v87 offset:64
    s_waitcnt vmcnt(3) lgkmcnt(15)
    v_mfma_f32_32x32x16_bf16 v[48:63], v[224:227], v[112:115], v[48:63]
    v_mov_b32 v104, 0
    v_lshlrev_b32 v96, 16, v20
    v_and_b32 v97, 0xffff0000, v20
    v_mfma_f32_32x32x16_bf16 v[32:47], v[228:231], v[112:115], v[32:47]
    v_mov_b32 v105, 0
    v_lshlrev_b32 v98, 16, v21
    v_and_b32 v99, 0xffff0000, v21
    s_waitcnt vmcnt(2) lgkmcnt(13)
    v_mfma_f32_32x32x16_bf16 v[48:63], v[232:235], v[116:119], v[48:63]
    v_and_b32 v106, 0x1f0, v0
    v_lshlrev_b32 v100, 16, v22
    v_and_b32 v101, 0xffff0000, v22
    s_waitcnt lgkmcnt(1)
    v_min_u32 v8, v8, v9
    s_nop 0
    v_readfirstlane_b32 s48, v8
    s_nop 1
    s_sub_i32 s48, s48, s49
    v_mfma_f32_32x32x16_bf16 v[32:47], v[236:239], v[116:119], v[32:47]
    v_add_u32 v6, 1, v6
    ds_write_b32 v5, v6
    v_lshrrev_b32 v107, 9, v0
    v_lshlrev_b32 v102, 16, v23
    v_and_b32 v103, 0xffff0000, v23
    s_waitcnt lgkmcnt(1)
    v_readfirstlane_b32 s52, v86
    s_nop 1
    s_cmp_ge_u32 s52, s84
    s_cbranch_scc1 CK_100
    s_mov_b32 s55, 0
LW_101:
    ds_read_b32 v86, v87 offset:64
    s_waitcnt lgkmcnt(0)
    v_readfirstlane_b32 s52, v86
    s_nop 1
    s_cmp_ge_u32 s52, s84
    s_cbranch_scc1 LWD_102
    s_add_u32 s55, s55, 1
    s_cmp_lt_u32 s55, 4000000
    s_cbranch_scc1 LW_101
    s_branch ABORT
LWD_102:
CK_100:
    s_waitcnt vmcnt(1)
    v_mfma_f32_32x32x16_bf16 v[48:63], v[240:243], v[120:123], v[48:63]
    v_lshl_or_b32 v106, v107, 2, v106
    v_pk_add_f32 v[88:89], v[88:89], v[14:15] op_sel_hi:[1,0] neg_lo:[0,1] neg_hi:[0,1]
    v_pk_add_f32 v[90:91], v[90:91], v[14:15] op_sel_hi:[1,0] neg_lo:[0,1] neg_hi:[0,1]
    v_mfma_f32_32x32x16_bf16 v[32:47], v[244:247], v[120:123], v[32:47]
    s_add_u32 s72, s74, 16384
    v_pk_add_f32 v[92:93], v[92:93], v[14:15] op_sel_hi:[1,0] neg_lo:[0,1] neg_hi:[0,1]
    v_pk_add_f32 v[94:95], v[94:95], v[14:15] op_sel_hi:[1,0] neg_lo:[0,1] neg_hi:[0,1]
    s_waitcnt vmcnt(0)
    v_mfma_f32_32x32x16_bf16 v[48:63], v[248:251], v[124:127], v[48:63]
    v_pk_add_f32 v[96:97], v[96:97], v[14:15] op_sel_hi:[1,0] neg_lo:[0,1] neg_hi:[0,1]
    v_pk_add_f32 v[98:99], v[98:99], v[14:15] op_sel_hi:[1,0] neg_lo:[0,1] neg_hi:[0,1]
    v_mfma_f32_32x32x16_bf16 v[32:47], v[252:255], v[124:127], v[32:47]
    v_pk_add_f32 v[100:101], v[100:101], v[14:15] op_sel_hi:[1,0] neg_lo:[0,1] neg_hi:[0,1]
    v_pk_add_f32 v[102:103], v[102:103], v[14:15] op_sel_hi:[1,0] neg_lo:[0,1] neg_hi:[0,1]
    s_nop 6
    ds_write_b128 v80, v[48:51] offset:0
    ds_write_b128 v80, v[52:55] offset:1024
    ds_write_b128 v80, v[56:59] offset:2048
    ds_write_b128 v80, v[60:63] offset:3072
    ds_write_b32 v5, v83 offset:32
    s_mov_b32 s55, 0
    ds_read_b32 v84, v82 offset:32
    ds_read_b128 v[64:67], v81 offset:0
    ds_read_b128 v[68:71], v81 offset:1024
    ds_read_b128 v[72:75], v81 offset:2048
    ds_read_b128 v[76:79], v81 offset:3072
    v_pk_fma_f32 v[32:33], v[14:15], v[88:89], v[32:33] op_sel:[1,0,0] op_sel_hi:[1,1,1]
    v_pk_fma_f32 v[34:35], v[14:15], v[90:91], v[34:35] op_sel:[1,0,0] op_sel_hi:[1,1,1]
    v_pk_fma_f32 v[36:37], v[14:15], v[92:93], v[36:37] op_sel:[1,0,0] op_sel_hi:[1,1,1]
    v_pk_fma_f32 v[38:39], v[14:15], v[94:95], v[38:39] op_sel:[1,0,0] op_sel_hi:[1,1,1]
    v_pk_fma_f32 v[40:41], v[14:15], v[96:97], v[40:41] op_sel:[1,0,0] op_sel_hi:[1,1,1]
    v_pk_fma_f32 v[42:43], v[14:15], v[98:99], v[42:43] op_sel:[1,0,0] op_sel_hi:[1,1,1]
    v_pk_fma_f32 v[44:45], v[14:15], v[100:101], v[44:45] op_sel:[1,0,0] op_sel_hi:[1,1,1]
    v_pk_fma_f32 v[46:47], v[14:15], v[102:103], v[46:47] op_sel:[1,0,0] op_sel_hi:[1,1,1]
    s_branch XCC_105
XC_103:
    ds_read_b32 v84, v82 offset:32
    ds_read_b128 v[64:67], v81 offset:0
    ds_read_b128 v[68:71], v81 offset:1024
    ds_read_b128 v[72:75], v81 offset:2048
    ds_read_b128 v[76:79], v81 offset:3072
XCC_105:
    s_waitcnt lgkmcnt(4)
    v_readfirstlane_b32 s52, v84
    s_nop 1
    s_cmp_ge_u32 s52, s70
    s_cbranch_scc1 XCD_104
    s_add_u32 s55, s55, 1
    s_cmp_lt_u32 s55, 4000000
    s_cbranch_scc1 XC_103
    s_branch ABORT
XCD_104:
    s_waitcnt lgkmcnt(3)
    v_pk_add_f32 v[32:33], v[32:33], v[64:65]
    v_pk_add_f32 v[34:35], v[34:35], v[66:67]
    s_waitcnt lgkmcnt(2)
    v_pk_add_f32 v[36:37], v[36:37], v[68:69]
    v_pk_add_f32 v[38:39], v[38:39], v[70:71]
    s_waitcnt lgkmcnt(1)
    v_pk_add_f32 v[40:41], v[40:41], v[72:73]
    v_pk_add_f32 v[42:43], v[42:43], v[74:75]
    s_waitcnt lgkmcnt(0)
    v_pk_add_f32 v[44:45], v[44:45], v[76:77]
    v_pk_add_f32 v[46:47], v[46:47], v[78:79]
    ds_write_b32 v5, v83 offset:64
    s_mov_b32 s84, s70
    v_cvt_pk_bf16_f32 v24, v32, v33
    v_cvt_pk_bf16_f32 v25, v34, v35
    v_cvt_pk_bf16_f32 v26, v36, v37
    v_cvt_pk_bf16_f32 v27, v38, v39
    v_cvt_pk_bf16_f32 v28, v40, v41
    v_cvt_pk_bf16_f32 v29, v42, v43
    v_cvt_pk_bf16_f32 v30, v44, v45
    v_cvt_pk_bf16_f32 v31, v46, v47
    s_cmp_eq_u32 s47, 3
    s_cbranch_scc0 STF_106
    buffer_store_dwordx4 v[24:27], v0, s[4:7], s73 offen
    buffer_store_dwordx4 v[28:31], v0, s[4:7], s73 offen offset:1024
STE_107:
    v_dot2c_f32_bf16 v104, s75, v24
    v_dot2c_f32_bf16 v105, v24, v24
    v_dot2c_f32_bf16 v104, s75, v25
    v_dot2c_f32_bf16 v105, v25, v25
    v_dot2c_f32_bf16 v104, s75, v26
    v_dot2c_f32_bf16 v105, v26, v26
    v_dot2c_f32_bf16 v104, s75, v27
    v_dot2c_f32_bf16 v105, v27, v27
    v_dot2c_f32_bf16 v104, s75, v28
    v_dot2c_f32_bf16 v105, v28, v28
    v_dot2c_f32_bf16 v104, s75, v29
    v_dot2c_f32_bf16 v105, v29, v29
    v_dot2c_f32_bf16 v104, s75, v30
    v_dot2c_f32_bf16 v105, v30, v30
    v_dot2c_f32_bf16 v104, s75, v31
    v_dot2c_f32_bf16 v105, v31, v31
    s_nop 2
    v_permlane32_swap_b32 v104, v105
    v_add_f32 v104, v104, v105
    s_cmp_eq_u32 s47, 3
    s_cbranch_scc0 STF_108
    buffer_store_dword v104, v106, s[4:7], s72 offen
STE_109:
    s_cmp_ge_u32 s41, 14
    s_cbranch_scc1 P5_SKIP
    v_xor_b32 v10, 0x0, v2
    v_xor_b32 v11, 0x40, v2
    s_lshl_b32 s51, s77, 7
    s_lshl_b32 s52, s76, 2
    s_add_u32 s51, s51, s52
    s_add_u32 s51, s51, s69
    v_and_b32 v58, 0x70, v0
    v_bfe_u32 v59, v0, 7, 1
    v_lshl_or_b32 v58, v59, 3, v58
    v_add_u32 v58, s51, v58
    s_add_u32 s54, s50, 4
    s_lshl_b32 s71, s42, 15
    s_add_u32 s71, s71, s64
    s_mul_i32 s73, s42, 114688
    s_lshl_b32 s51, s41, 12
    s_add_u32 s73, s73, s51
    s_add_u32 s73, s73, s66
    s_add_u32 s72, s73, 57344
    s_add_u32 s51, s50, 4
    v_mov_b32 v8, s51
    v_mov_b32 v9, 0
    s_mov_b64 exec, 1
    s_cmp_eq_u32 s47, 3
    s_waitcnt vmcnt(0)
    s_cbranch_scc0 STF_110
    buffer_store_dword v8, v9, s[4:7], s68 offen
STE_111:
    s_mov_b64 exec, -1
    buffer_load_dword v59, v58, s[4:7], 0 offen sc1
    s_cmp_gt_i32 s48, 18
    s_cbranch_scc0 NW_115
NWB_116:
    ds_read_b64_tr_b16 v[32:33], v10 offset:32768
    ds_read_b64_tr_b16 v[34:35], v10 offset:33280
    ds_read_b64_tr_b16 v[36:37], v11 offset:32768
    ds_read_b64_tr_b16 v[38:39], v11 offset:33280
    ds_read_b64_tr_b16 v[40:41], v10 offset:34816
    ds_read_b64_tr_b16 v[42:43], v10 offset:35328
    ds_read_b64_tr_b16 v[44:45], v11 offset:34816
    ds_read_b64_tr_b16 v[46:47], v11 offset:35328
    ds_read_b64_tr_b16 v[48:49], v10 offset:36864
    ds_read_b64_tr_b16 v[50:51], v10 offset:37376
    ds_read_b64_tr_b16 v[52:53], v11 offset:36864
    ds_read_b64_tr_b16 v[54:55], v11 offset:37376
    s_mov_b32 s55, 0
    s_branch POLLC_113
POLLC_113:
POLL_112:
    buffer_load_dword v60, v58, s[4:7], 0 offen sc1
    s_waitcnt vmcnt(1)
    v_cmp_le_u32 vcc, s54, v59
    s_nop 1
    s_cmp_eq_u64 vcc, -1
    s_cbranch_scc1 POLLD_114
    buffer_load_dword v59, v58, s[4:7], 0 offen sc1
    s_waitcnt vmcnt(1)
    v_cmp_le_u32 vcc, s54, v60
    s_nop 1
    s_cmp_eq_u64 vcc, -1
    s_cbranch_scc1 POLLD_114
    s_add_u32 s55, s55, 1
    s_cmp_lt_u32 s55, 400000
    s_cbranch_scc1 POLL_112
    s_branch ABORT
POLLD_114:
    s_lshl_b32 s51, s42, 12
    s_add_u32 s51, s51, s67
    s_add_u32 s51, s51, 16384
    buffer_load_dwordx4 v[240:243], v0, s[4:7], s51 offen offset:0 sc1
    buffer_load_dwordx4 v[244:247], v0, s[4:7], s51 offen offset:1024 sc1
    buffer_load_dwordx4 v[248:251], v0, s[4:7], s51 offen offset:2048 sc1
    buffer_load_dwordx4 v[252:255], v0, s[4:7], s51 offen offset:3072 sc1
    buffer_load_dwordx4 v[128:131], v0, s[4:7], s71 offen offset:0 sc1
    buffer_load_dwordx4 v[132:135], v0, s[4:7], s71 offen offset:1024 sc1
    buffer_load_dwordx4 v[136:139], v0, s[4:7], s71 offen offset:2048 sc1
    buffer_load_dwordx4 v[140:143], v0, s[4:7], s71 offen offset:3072 sc1
    s_add_u32 s71, s71, 4096
    buffer_load_dwordx4 v[144:147], v0, s[4:7], s71 offen offset:0 sc1
    buffer_load_dwordx4 v[148:151], v0, s[4:7], s71 offen offset:1024 sc1
    buffer_load_dwordx4 v[152:155], v0, s[4:7], s71 offen offset:2048 sc1
    buffer_load_dwordx4 v[156:159], v0, s[4:7], s71 offen offset:3072 sc1
    s_waitcnt vmcnt(7) lgkmcnt(10)
    v_mfma_f32_32x32x16_bf16 v[64:79], v[32:35], v[128:131], 0
    ds_read_b64_tr_b16 v[32:33], v10 offset:38912
    ds_read_b64_tr_b16 v[34:35], v10 offset:39424
    s_add_u32 s71, s71, 4096
    buffer_load_dwordx4 v[160:163], v0, s[4:7], s71 offen offset:0 sc1
    s_waitcnt lgkmcnt(10)
    v_mfma_f32_32x32x16_bf16 v[80:95], v[36:39], v[128:131], 0
    ds_read_b64_tr_b16 v[36:37], v11 offset:38912
    ds_read_b64_tr_b16 v[38:39], v11 offset:39424
    v_pk_add_f32 v[240:241], v[240:241], v[248:249]
    v_pk_add_f32 v[242:243], v[242:243], v[250:251]
    v_pk_add_f32 v[244:245], v[244:245], v[252:253]
    v_pk_add_f32 v[246:247], v[246:247], v[254:255]
    v_pk_add_f32 v[240:241], v[240:241], v[244:245]
    v_pk_add_f32 v[242:243], v[242:243], v[246:247]
    v_pk_add_f32 v[56:57], v[240:241], v[242:243]
    s_waitcnt vmcnt(7) lgkmcnt(10)
    v_mfma_f32_32x32x16_bf16 v[64:79], v[40:43], v[132:135], v[64:79]
    ds_read_b64_tr_b16 v[40:41], v10 offset:40960
    ds_read_b64_tr_b16 v[42:43], v10 offset:41472
    buffer_load_dwordx4 v[164:167], v0, s[4:7], s71 offen offset:1024 sc1
    s_waitcnt lgkmcnt(10)
    v_mfma_f32_32x32x16_bf16 v[80:95], v[44:47], v[132:135], v[80:95]
    ds_read_b64_tr_b16 v[44:45], v11 offset:40960
    ds_read_b64_tr_b16 v[46:47], v11 offset:41472
    s_waitcnt vmcnt(7) lgkmcnt(10)
    v_mfma_f32_32x32x16_bf16 v[64:79], v[48:51], v[136:139], v[64:79]
    ds_read_b64_tr_b16 v[48:49], v10 offset:43008
    ds_read_b64_tr_b16 v[50:51], v10 offset:43520
    buffer_load_dwordx4 v[168:171], v0, s[4:7], s71 offen offset:2048 sc1
    v_mov_b32 v58, v56
    s_waitcnt lgkmcnt(10)
    v_mfma_f32_32x32x16_bf16 v[80:95], v[52:55], v[136:139], v[80:95]
    ds_read_b64_tr_b16 v[52:53], v11 offset:43008
    ds_read_b64_tr_b16 v[54:55], v11 offset:43520
    v_mov_b32 v59, v57
    s_waitcnt vmcnt(7) lgkmcnt(10)
    v_mfma_f32_32x32x16_bf16 v[64:79], v[32:35], v[140:143], v[64:79]
    ds_read_b64 v[8:9], v4 offset:32
    ds_read_b64_tr_b16 v[32:33], v10 offset:45056
    ds_read_b64_tr_b16 v[34:35], v10 offset:45568
    buffer_load_dwordx4 v[172:175], v0, s[4:7], s71 offen offset:3072 sc1
    v_permlane32_swap_b32 v56, v58
    s_waitcnt lgkmcnt(11)
    v_mfma_f32_32x32x16_bf16 v[80:95], v[36:39], v[140:143], v[80:95]
    ds_read_b64_tr_b16 v[36:37], v11 offset:45056
    ds_read_b64_tr_b16 v[38:39], v11 offset:45568
    v_permlane32_swap_b32 v57, v59
    s_waitcnt vmcnt(7) lgkmcnt(11)
    v_mfma_f32_32x32x16_bf16 v[64:79], v[40:43], v[144:147], v[64:79]
    ds_read_b64_tr_b16 v[40:41], v10 offset:47104
    ds_read_b64_tr_b16 v[42:43], v10 offset:47616
    s_add_u32 s71, s71, 4096
    buffer_load_dwordx4 v[176:179], v0, s[4:7], s71 offen offset:0 sc1
    v_pk_add_f32 v[56:57], v[56:57], v[58:59]
    s_waitcnt lgkmcnt(11)
    v_mfma_f32_32x32x16_bf16 v[80:95], v[44:47], v[144:147], v[80:95]
    ds_read_b64_tr_b16 v[44:45], v11 offset:47104
    ds_read_b64_tr_b16 v[46:47], v11 offset:47616
    v_mul_f32 v62, 0xbb000000, v56
    s_waitcnt vmcnt(7) lgkmcnt(11)
    v_mfma_f32_32x32x16_bf16 v[64:79], v[48:51], v[148:151], v[64:79]
    s_waitcnt lgkmcnt(8)
    v_min_u32 v8, v8, v9
    s_nop 0
    v_readfirstlane_b32 s48, v8
    s_nop 1
    s_sub_i32 s48, s48, s49
    s_cmp_gt_i32 s48, 19
    s_cbranch_scc0 NW_117
NWB_118:
    ds_read_b64_tr_b16 v[48:49], v10 offset:49152
    ds_read_b64_tr_b16 v[50:51], v10 offset:49664
    buffer_load_dwordx4 v[180:183], v0, s[4:7], s71 offen offset:1024 sc1
    v_cvt_pk_bf16_f32 v61, v62, 0
    v_mfma_f32_32x32x16_bf16 v[80:95], v[52:55], v[148:151], v[80:95]
    ds_read_b64_tr_b16 v[52:53], v11 offset:49152
    ds_read_b64_tr_b16 v[54:55], v11 offset:49664
    v_lshlrev_b32 v63, 16, v61
    s_waitcnt vmcnt(7) lgkmcnt(10)
    v_mfma_f32_32x32x16_bf16 v[64:79], v[32:35], v[152:155], v[64:79]
    ds_read_b64_tr_b16 v[32:33], v10 offset:51200
    ds_read_b64_tr_b16 v[34:35], v10 offset:51712
    buffer_load_dwordx4 v[184:187], v0, s[4:7], s71 offen offset:2048 sc1
    v_sub_f32 v63, v62, v63
    s_waitcnt lgkmcnt(10)
    v_mfma_f32_32x32x16_bf16 v[80:95], v[36:39], v[152:155], v[80:95]
    ds_read_b64_tr_b16 v[36:37], v11 offset:51200
    ds_read_b64_tr_b16 v[38:39], v11 offset:51712
    v_cvt_pk_bf16_f32 v60, v62, v63
    s_waitcnt vmcnt(7) lgkmcnt(10)
    v_mfma_f32_32x32x16_bf16 v[64:79], v[40:43], v[156:159], v[64:79]
    ds_read_b64_tr_b16 v[40:41], v10 offset:53248
    ds_read_b64_tr_b16 v[42:43], v10 offset:53760
    buffer_load_dwordx4 v[188:191], v0, s[4:7], s71 offen offset:3072 sc1
    v_mov_b32 v62, 0
    s_waitcnt lgkmcnt(10)
    v_mfma_f32_32x32x16_bf16 v[80:95], v[44:47], v[156:159], v[80:95]
    v_add_u32 v6, 1, v6
    ds_write_b32 v5, v6
    ds_read_b64_tr_b16 v[44:45], v11 offset:53248
    ds_read_b64_tr_b16 v[46:47], v11 offset:53760
    v_mov_b32 v63, 0
    s_waitcnt vmcnt(7) lgkmcnt(11)
    v_mfma_f32_32x32x16_bf16 v[64:79], v[48:51], v[160:163], v[64:79]
    ds_read_b64_tr_b16 v[48:49], v10 offset:55296
    ds_read_b64_tr_b16 v[50:51], v10 offset:55808
    s_add_u32 s71, s71, 4096
    buffer_load_dwordx4 v[192:195], v0, s[4:7], s71 offen offset:0 sc1
    v_lshrrev_b32 v13, 2, v0
    s_waitcnt lgkmcnt(11)
    v_mfma_f32_32x32x16_bf16 v[80:95], v[52:55], v[160:163], v[80:95]
    ds_read_b64_tr_b16 v[52:53], v11 offset:55296
    ds_read_b64_tr_b16 v[54:55], v11 offset:55808
    v_add_u32 v13, 162176, v13
    s_waitcnt vmcnt(7) lgkmcnt(11)
    v_mfma_f32_32x32x16_bf16 v[64:79], v[32:35], v[164:167], v[64:79]
    ds_read_b64_tr_b16 v[32:33], v10 offset:57344
    ds_read_b64_tr_b16 v[34:35], v10 offset:57856
    buffer_load_dwordx4 v[196:199], v0, s[4:7], s71 offen offset:1024 sc1
    v_mul_f32 v58, 0x3b000000, v56
    s_waitcnt lgkmcnt(11)
    v_mfma_f32_32x32x16_bf16 v[80:95], v[36:39], v[164:167], v[80:95]
    ds_read_b64_tr_b16 v[36:37], v11 offset:57344
    ds_read_b64_tr_b16 v[38:39], v11 offset:57856
    v_mul_f32 v57, 0x3b000000, v57
    s_waitcnt vmcnt(7) lgkmcnt(11)
    v_mfma_f32_32x32x16_bf16 v[64:79], v[40:43], v[168:171], v[64:79]
    ds_read_b64_tr_b16 v[40:41], v10 offset:59392
    ds_read_b64_tr_b16 v[42:43], v10 offset:59904
    buffer_load_dwordx4 v[200:203], v0, s[4:7], s71 offen offset:2048 sc1
    v_fma_f32 v57, -v58, v58, v57
    s_waitcnt lgkmcnt(10)
    v_mfma_f32_32x32x16_bf16 v[80:95], v[44:47], v[168:171], v[80:95]
    ds_read_b64_tr_b16 v[44:45], v11 offset:59392
    ds_read_b64_tr_b16 v[46:47], v11 offset:59904
    v_max_f32 v57, 0, v57
    s_waitcnt vmcnt(7) lgkmcnt(10)
    v_mfma_f32_32x32x16_bf16 v[64:79], v[48:51], v[172:175], v[64:79]
    ds_read_b64 v[8:9], v4 offset:32
    ds_read_b64_tr_b16 v[48:49], v10 offset:61440
    ds_read_b64_tr_b16 v[50:51], v10 offset:61952
    buffer_load_dwordx4 v[204:207], v0, s[4:7], s71 offen offset:3072 sc1
    v_add_f32 v59, 0x3727c5ac, v57
    s_waitcnt lgkmcnt(11)
    v_mfma_f32_32x32x16_bf16 v[80:95], v[52:55], v[172:175], v[80:95]
    ds_read_b64_tr_b16 v[52:53], v11 offset:61440
    ds_read_b64_tr_b16 v[54:55], v11 offset:61952
    v_rsq_f32 v59, v59
    s_waitcnt vmcnt(7) lgkmcnt(11)
    v_mfma_f32_32x32x16_bf16 v[64:79], v[32:35], v[176:179], v[64:79]
    ds_read_b64_tr_b16 v[32:33], v10 offset:63488
    ds_read_b64_tr_b16 v[34:35], v10 offset:64000
    s_add_u32 s71, s71, 4096
    buffer_load_dwordx4 v[208:211], v0, s[4:7], s71 offen offset:0 sc1
    v_rcp_f32 v12, v59
    s_waitcnt lgkmcnt(11)
    v_mfma_f32_32x32x16_bf16 v[80:95], v[36:39], v[176:179], v[80:95]
    ds_read_b64_tr_b16 v[36:37], v11 offset:63488
    ds_read_b64_tr_b16 v[38:39], v11 offset:64000
    v_mul_f32 v15, v59, v59
    s_waitcnt vmcnt(7) lgkmcnt(11)
    v_mfma_f32_32x32x16_bf16 v[64:79], v[40:43], v[180:183], v[64:79]
    s_waitcnt lgkmcnt(8)
    v_min_u32 v8, v8, v9
    s_nop 0
    v_readfirstlane_b32 s48, v8
    s_nop 1
    s_sub_i32 s48, s48, s49
    s_cmp_gt_i32 s48, 20
    s_cbranch_scc0 NW_119
NWB_120:
    v_xor_b32 v10, 0x10000, v10
    v_xor_b32 v11, 0x10000, v11
    ds_read_b64_tr_b16 v[40:41], v10 offset:0
    ds_read_b64_tr_b16 v[42:43], v10 offset:512
    buffer_load_dwordx4 v[212:215], v0, s[4:7], s71 offen offset:1024 sc1
    v_mul_f32 v14, 0xc0135761, v59
    v_mfma_f32_32x32x16_bf16 v[80:95], v[44:47], v[180:183], v[80:95]
    ds_read_b64_tr_b16 v[44:45], v11 offset:0
    ds_read_b64_tr_b16 v[46:47], v11 offset:512
    v_mul_f32 v15, v15, v14
    s_waitcnt vmcnt(7) lgkmcnt(10)
    v_mfma_f32_32x32x16_bf16 v[64:79], v[48:51], v[184:187], v[64:79]
    ds_read_b64_tr_b16 v[48:49], v10 offset:2048
    ds_read_b64_tr_b16 v[50:51], v10 offset:2560
    buffer_load_dwordx4 v[216:219], v0, s[4:7], s71 offen offset:2048 sc1
    v_mul_f32 v15, 0x3d372713, v15
    s_waitcnt lgkmcnt(10)
    v_mfma_f32_32x32x16_bf16 v[80:95], v[52:55], v[184:187], v[80:95]
    ds_read_b64_tr_b16 v[52:53], v11 offset:2048
    ds_read_b64_tr_b16 v[54:55], v11 offset:2560
    s_waitcnt vmcnt(7) lgkmcnt(10)
    v_mfma_f32_32x32x16_bf16 v[64:79], v[32:35], v[188:191], v[64:79]
    ds_read_b64_tr_b16 v[32:33], v10 offset:4096
    ds_read_b64_tr_b16 v[34:35], v10 offset:4608
    buffer_load_dwordx4 v[220:223], v0, s[4:7], s71 offen offset:3072 sc1
    s_waitcnt lgkmcnt(10)
    v_mfma_f32_32x32x16_bf16 v[80:95], v[36:39], v[188:191], v[80:95]
    v_add_u32 v6, 1, v6
    ds_write_b32 v5, v6
    ds_read_b64_tr_b16 v[36:37], v11 offset:4096
    ds_read_b64_tr_b16 v[38:39], v11 offset:4608
    s_waitcnt vmcnt(7) lgkmcnt(11)
    v_mfma_f32_32x32x16_bf16 v[64:79], v[40:43], v[192:195], v[64:79]
    ds_read_b64_tr_b16 v[40:41], v10 offset:6144
    ds_read_b64_tr_b16 v[42:43], v10 offset:6656
    s_add_u32 s71, s71, 4096
    buffer_load_dwordx4 v[224:227], v0, s[4:7], s71 offen offset:0 sc1
    s_waitcnt lgkmcnt(11)
    v_mfma_f32_32x32x16_bf16 v[80:95], v[44:47], v[192:195], v[80:95]
    ds_read_b64_tr_b16 v[44:45], v11 offset:6144
    ds_read_b64_tr_b16 v[46:47], v11 offset:6656
    s_waitcnt vmcnt(7) lgkmcnt(11)
    v_mfma_f32_32x32x16_bf16 v[64:79], v[48:51], v[196:199], v[64:79]
    ds_read_b64_tr_b16 v[48:49], v10 offset:8192
    ds_read_b64_tr_b16 v[50:51], v10 offset:8704
    buffer_load_dwordx4 v[228:231], v0, s[4:7], s71 offen offset:1024 sc1
    s_waitcnt lgkmcnt(11)
    v_mfma_f32_32x32x16_bf16 v[80:95], v[52:55], v[196:199], v[80:95]
    ds_read_b64_tr_b16 v[52:53], v11 offset:8192
    ds_read_b64_tr_b16 v[54:55], v11 offset:8704
    s_waitcnt vmcnt(7) lgkmcnt(11)
    v_mfma_f32_32x32x16_bf16 v[64:79], v[32:35], v[200:203], v[64:79]
    ds_read_b64_tr_b16 v[32:33], v10 offset:10240
    ds_read_b64_tr_b16 v[34:35], v10 offset:10752
    buffer_load_dwordx4 v[232:235], v0, s[4:7], s71 offen offset:2048 sc1
    s_waitcnt lgkmcnt(10)
    v_mfma_f32_32x32x16_bf16 v[80:95], v[36:39], v[200:203], v[80:95]
    ds_read_b64_tr_b16 v[36:37], v11 offset:10240
    ds_read_b64_tr_b16 v[38:39], v11 offset:10752
    s_waitcnt vmcnt(7) lgkmcnt(10)
    v_mfma_f32_32x32x16_bf16 v[64:79], v[40:43], v[204:207], v[64:79]
    ds_read_b64 v[8:9], v4 offset:32
    ds_read_b64_tr_b16 v[40:41], v10 offset:12288
    ds_read_b64_tr_b16 v[42:43], v10 offset:12800
    buffer_load_dwordx4 v[236:239], v0, s[4:7], s71 offen offset:3072 sc1
    s_waitcnt lgkmcnt(11)
    v_mfma_f32_32x32x16_bf16 v[80:95], v[44:47], v[204:207], v[80:95]
    ds_read_b64_tr_b16 v[44:45], v11 offset:12288
    ds_read_b64_tr_b16 v[46:47], v11 offset:12800
    s_waitcnt vmcnt(7) lgkmcnt(11)
    v_mfma_f32_32x32x16_bf16 v[64:79], v[48:51], v[208:211], v[64:79]
    ds_read_b64_tr_b16 v[48:49], v10 offset:14336
    ds_read_b64_tr_b16 v[50:51], v10 offset:14848
    s_add_u32 s71, s71, 4096
    buffer_load_dwordx4 v[240:243], v0, s[4:7], s71 offen offset:0 sc1
    s_waitcnt lgkmcnt(11)
    v_mfma_f32_32x32x16_bf16 v[80:95], v[52:55], v[208:211], v[80:95]
    ds_read_b64_tr_b16 v[52:53], v11 offset:14336
    ds_read_b64_tr_b16 v[54:55], v11 offset:14848
    s_waitcnt vmcnt(7) lgkmcnt(11)
    v_mfma_f32_32x32x16_bf16 v[64:79], v[32:35], v[212:215], v[64:79]
    s_waitcnt lgkmcnt(8)
    v_min_u32 v8, v8, v9
    s_nop 0
    v_readfirstlane_b32 s48, v8
    s_nop 1
    s_sub_i32 s48, s48, s49
    s_cmp_gt_i32 s48, 21
    s_cbranch_scc0 NW_121
NWB_122:
    ds_read_b64_tr_b16 v[32:33], v10 offset:16384
    ds_read_b64_tr_b16 v[34:35], v10 offset:16896
    buffer_load_dwordx4 v[244:247], v0, s[4:7], s71 offen offset:1024 sc1
    v_mfma_f32_32x32x16_bf16 v[80:95], v[36:39], v[212:215], v[80:95]
    ds_read_b64_tr_b16 v[36:37], v11 offset:16384
    ds_read_b64_tr_b16 v[38:39], v11 offset:16896
    s_waitcnt vmcnt(7) lgkmcnt(10)
    v_mfma_f32_32x32x16_bf16 v[64:79], v[40:43], v[216:219], v[64:79]
    ds_read_b64_tr_b16 v[40:41], v10 offset:18432
    ds_read_b64_tr_b16 v[42:43], v10 offset:18944
    buffer_load_dwordx4 v[248:251], v0, s[4:7], s71 offen offset:2048 sc1
    s_waitcnt lgkmcnt(10)
    v_mfma_f32_32x32x16_bf16 v[80:95], v[44:47], v[216:219], v[80:95]
    ds_read_b64_tr_b16 v[44:45], v11 offset:18432
    ds_read_b64_tr_b16 v[46:47], v11 offset:18944
    s_waitcnt vmcnt(7) lgkmcnt(10)
    v_mfma_f32_32x32x16_bf16 v[64:79], v[48:51], v[220:223], v[64:79]
    ds_read_b64_tr_b16 v[48:49], v10 offset:20480
    ds_read_b64_tr_b16 v[50:51], v10 offset:20992
    buffer_load_dwordx4 v[252:255], v0, s[4:7], s71 offen offset:3072 sc1
    s_waitcnt lgkmcnt(10)
    v_mfma_f32_32x32x16_bf16 v[80:95], v[52:55], v[220:223], v[80:95]
    v_add_u32 v6, 1, v6
    ds_write_b32 v5, v6
    ds_read_b64_tr_b16 v[52:53], v11 offset:20480
    ds_read_b64_tr_b16 v[54:55], v11 offset:20992
    s_waitcnt vmcnt(7) lgkmcnt(11)
    v_mfma_f32_32x32x16_bf16 v[64:79], v[32:35], v[224:227], v[64:79]
    ds_read_b64_tr_b16 v[32:33], v10 offset:22528
    ds_read_b64_tr_b16 v[34:35], v10 offset:23040
    s_cmp_eq_u32 s46, 0
    s_cbranch_scc0 CSK_123
    s_mov_b32 s55, 0
LW_124:
    ds_read_b32 v112, v4 offset:112
    s_waitcnt lgkmcnt(0)
    v_readfirstlane_b32 s52, v112
    s_nop 1
    s_cmp_ge_u32 s52, 2
    s_cbranch_scc1 LWD_125
    s_add_u32 s55, s55, 1
    s_cmp_lt_u32 s55, 4000000
    s_cbranch_scc1 LW_124
    s_branch ABORT
LWD_125:
CSK_123:
    ds_read_b32 v113, v13 offset:0
    ds_read_b32 v115, v13 offset:256
    s_waitcnt lgkmcnt(13)
    v_mfma_f32_32x32x16_bf16 v[80:95], v[36:39], v[224:227], v[80:95]
    ds_read_b64_tr_b16 v[36:37], v11 offset:22528
    ds_read_b64_tr_b16 v[38:39], v11 offset:23040
    s_waitcnt vmcnt(6) lgkmcnt(13)
    v_mfma_f32_32x32x16_bf16 v[64:79], v[40:43], v[228:231], v[64:79]
    ds_read_b64_tr_b16 v[40:41], v10 offset:24576
    ds_read_b64_tr_b16 v[42:43], v10 offset:25088
    s_waitcnt lgkmcnt(13)
    v_mfma_f32_32x32x16_bf16 v[80:95], v[44:47], v[228:231], v[80:95]
    ds_read_b64_tr_b16 v[44:45], v11 offset:24576
    ds_read_b64_tr_b16 v[46:47], v11 offset:25088
    s_waitcnt vmcnt(5) lgkmcnt(13)
    v_mfma_f32_32x32x16_bf16 v[64:79], v[48:51], v[232:235], v[64:79]
    ds_read_b64_tr_b16 v[48:49], v10 offset:26624
    ds_read_b64_tr_b16 v[50:51], v10 offset:27136
    s_waitcnt lgkmcnt(12)
    v_mfma_f32_32x32x16_bf16 v[80:95], v[52:55], v[232:235], v[80:95]
    ds_read_b64_tr_b16 v[52:53], v11 offset:26624
    ds_read_b64_tr_b16 v[54:55], v11 offset:27136
    s_waitcnt vmcnt(4) lgkmcnt(12)
    v_mfma_f32_32x32x16_bf16 v[64:79], v[32:35], v[236:239], v[64:79]
    ds_read_b64 v[8:9], v4 offset:32
    ds_read_b64_tr_b16 v[32:33], v10 offset:28672
    ds_read_b64_tr_b16 v[34:35], v10 offset:29184
    s_waitcnt lgkmcnt(13)
    v_mov_b32 v117, 0
    v_cvt_pk_bf16_f32 v112, v113, v113
    v_and_b32 v116, 0xffff0000, v112
    v_sub_f32 v113, v113, v116
    v_cvt_pk_bf16_f32 v113, v113, 0
    v_cvt_pk_bf16_f32 v114, v115, v115
    v_and_b32 v116, 0xffff0000, v114
    v_sub_f32 v115, v115, v116
    v_cvt_pk_bf16_f32 v115, v115, 0
    s_waitcnt lgkmcnt(11)
    v_mfma_f32_32x32x16_bf16 v[80:95], v[36:39], v[236:239], v[80:95]
    ds_read_b64_tr_b16 v[36:37], v11 offset:28672
    ds_read_b64_tr_b16 v[38:39], v11 offset:29184
    s_waitcnt vmcnt(3) lgkmcnt(11)
    v_mfma_f32_32x32x16_bf16 v[64:79], v[40:43], v[240:243], v[64:79]
    ds_read_b64_tr_b16 v[40:41], v10 offset:30720
    ds_read_b64_tr_b16 v[42:43], v10 offset:31232
    s_waitcnt lgkmcnt(11)
    v_mfma_f32_32x32x16_bf16 v[80:95], v[44:47], v[240:243], v[80:95]
    ds_read_b64_tr_b16 v[44:45], v11 offset:30720
    ds_read_b64_tr_b16 v[46:47], v11 offset:31232
    s_waitcnt vmcnt(2) lgkmcnt(11)
    v_mfma_f32_32x32x16_bf16 v[64:79], v[48:51], v[244:247], v[64:79]
    s_waitcnt lgkmcnt(8)
    v_min_u32 v8, v8, v9
    s_nop 0
    v_readfirstlane_b32 s48, v8
    s_nop 1
    s_sub_i32 s48, s48, s49
    s_cmp_gt_i32 s48, 22
    s_cbranch_scc0 NW_126
NWB_127:
    ds_read_b64_tr_b16 v[48:49], v10 offset:32768
    ds_read_b64_tr_b16 v[50:51], v10 offset:33280
    v_mfma_f32_32x32x16_bf16 v[80:95], v[52:55], v[244:247], v[80:95]
    ds_read_b64_tr_b16 v[52:53], v11 offset:32768
    ds_read_b64_tr_b16 v[54:55], v11 offset:33280
    v_mfma_f32_32x32x16_bf16 v[64:79], v[112:115], v[60:63], v[64:79]
    s_waitcnt vmcnt(1) lgkmcnt(10)
    v_mfma_f32_32x32x16_bf16 v[64:79], v[32:35], v[248:251], v[64:79]
    ds_read_b64_tr_b16 v[32:33], v10 offset:34816
    ds_read_b64_tr_b16 v[34:35], v10 offset:35328
    v_mfma_f32_32x32x16_bf16 v[80:95], v[114:117], v[60:63], v[80:95]
    s_waitcnt lgkmcnt(10)
    v_mfma_f32_32x32x16_bf16 v[80:95], v[36:39], v[248:251], v[80:95]
    ds_read_b64_tr_b16 v[36:37], v11 offset:34816
    ds_read_b64_tr_b16 v[38:39], v11 offset:35328
    s_waitcnt vmcnt(0) lgkmcnt(10)
    v_mfma_f32_32x32x16_bf16 v[64:79], v[40:43], v[252:255], v[64:79]
    ds_read_b64_tr_b16 v[40:41], v10 offset:36864
    ds_read_b64_tr_b16 v[42:43], v10 offset:37376
    s_waitcnt lgkmcnt(10)
    v_mfma_f32_32x32x16_bf16 v[80:95], v[44:47], v[252:255], v[80:95]
    v_add_u32 v6, 1, v6
    ds_write_b32 v5, v6
    ds_read_b64_tr_b16 v[44:45], v11 offset:36864
    ds_read_b64_tr_b16 v[46:47], v11 offset:37376
    s_nop 3
    v_pk_mul_f32 v[96:97], v[64:65], v[64:65]
    v_pk_mul_f32 v[98:99], v[66:67], v[66:67]
    v_pk_mul_f32 v[100:101], v[68:69], v[68:69]
    v_pk_mul_f32 v[102:103], v[70:71], v[70:71]
    v_pk_fma_f32 v[96:97], v[14:15], v[96:97], v[14:15] op_sel:[1,0,0] op_sel_hi:[1,1,0]
    v_pk_fma_f32 v[98:99], v[14:15], v[98:99], v[14:15] op_sel:[1,0,0] op_sel_hi:[1,1,0]
    v_pk_fma_f32 v[100:101], v[14:15], v[100:101], v[14:15] op_sel:[1,0,0] op_sel_hi:[1,1,0]
    v_pk_fma_f32 v[102:103], v[14:15], v[102:103], v[14:15] op_sel:[1,0,0] op_sel_hi:[1,1,0]
    v_pk_mul_f32 v[96:97], v[96:97], v[64:65]
    v_pk_mul_f32 v[98:99], v[98:99], v[66:67]
    v_pk_mul_f32 v[100:101], v[100:101], v[68:69]
    v_pk_mul_f32 v[102:103], v[102:103], v[70:71]
    v_pk_mul_f32 v[104:105], v[72:73], v[72:73]
    v_exp_f32 v96, v96
    v_pk_mul_f32 v[106:107], v[74:75], v[74:75]
    v_exp_f32 v97, v97
    v_pk_mul_f32 v[108:109], v[76:77], v[76:77]
    v_exp_f32 v98, v98
    v_pk_mul_f32 v[110:111], v[78:79], v[78:79]
    v_exp_f32 v99, v99
    v_pk_fma_f32 v[104:105], v[14:15], v[104:105], v[14:15] op_sel:[1,0,0] op_sel_hi:[1,1,0]
    v_exp_f32 v100, v100
    v_pk_fma_f32 v[106:107], v[14:15], v[106:107], v[14:15] op_sel:[1,0,0] op_sel_hi:[1,1,0]
    v_exp_f32 v101, v101
    v_pk_fma_f32 v[108:109], v[14:15], v[108:109], v[14:15] op_sel:[1,0,0] op_sel_hi:[1,1,0]
    v_exp_f32 v102, v102
    v_pk_fma_f32 v[110:111], v[14:15], v[110:111], v[14:15] op_sel:[1,0,0] op_sel_hi:[1,1,0]
    v_exp_f32 v103, v103
    v_pk_mul_f32 v[104:105], v[104:105], v[72:73]
    v_pk_fma_f32 v[96:97], v[96:97], v[12:13], v[12:13] op_sel:[0,0,0] op_sel_hi:[1,0,0]
    v_pk_mul_f32 v[106:107], v[106:107], v[74:75]
    v_pk_fma_f32 v[98:99], v[98:99], v[12:13], v[12:13] op_sel:[0,0,0] op_sel_hi:[1,0,0]
    v_pk_mul_f32 v[108:109], v[108:109], v[76:77]
    v_pk_fma_f32 v[100:101], v[100:101], v[12:13], v[12:13] op_sel:[0,0,0] op_sel_hi:[1,0,0]
    v_pk_mul_f32 v[110:111], v[110:111], v[78:79]
    v_pk_fma_f32 v[102:103], v[102:103], v[12:13], v[12:13] op_sel:[0,0,0] op_sel_hi:[1,0,0]
    v_exp_f32 v104, v104
    v_rcp_f32 v96, v96
    v_exp_f32 v105, v105
    v_rcp_f32 v97, v97
    v_exp_f32 v106, v106
    v_rcp_f32 v98, v98
    v_exp_f32 v107, v107
    v_rcp_f32 v99, v99
    v_exp_f32 v108, v108
    v_rcp_f32 v100, v100
    v_exp_f32 v109, v109
    v_rcp_f32 v101, v101
    v_exp_f32 v110, v110
    v_rcp_f32 v102, v102
    v_exp_f32 v111, v111
    v_rcp_f32 v103, v103
    v_pk_fma_f32 v[104:105], v[104:105], v[12:13], v[12:13] op_sel:[0,0,0] op_sel_hi:[1,0,0]
    v_pk_mul_f32 v[96:97], v[96:97], v[64:65]
    v_pk_fma_f32 v[106:107], v[106:107], v[12:13], v[12:13] op_sel:[0,0,0] op_sel_hi:[1,0,0]
    v_pk_mul_f32 v[98:99], v[98:99], v[66:67]
    v_pk_fma_f32 v[108:109], v[108:109], v[12:13], v[12:13] op_sel:[0,0,0] op_sel_hi:[1,0,0]
    v_pk_mul_f32 v[100:101], v[100:101], v[68:69]
    v_pk_fma_f32 v[110:111], v[110:111], v[12:13], v[12:13] op_sel:[0,0,0] op_sel_hi:[1,0,0]
    v_pk_mul_f32 v[102:103], v[102:103], v[70:71]
    v_rcp_f32 v104, v104
    v_cvt_pk_bf16_f32 v64, v96, v97
    v_rcp_f32 v105, v105
    v_cvt_pk_bf16_f32 v65, v98, v99
    v_rcp_f32 v106, v106
    v_cvt_pk_bf16_f32 v66, v100, v101
    v_rcp_f32 v107, v107
    v_cvt_pk_bf16_f32 v67, v102, v103
    v_rcp_f32 v108, v108
    v_rcp_f32 v109, v109
    v_rcp_f32 v110, v110
    v_rcp_f32 v111, v111
    v_pk_mul_f32 v[104:105], v[104:105], v[72:73]
    v_pk_mul_f32 v[106:107], v[106:107], v[74:75]
    v_pk_mul_f32 v[108:109], v[108:109], v[76:77]
    v_pk_mul_f32 v[110:111], v[110:111], v[78:79]
    v_cvt_pk_bf16_f32 v72, v104, v105
    v_cvt_pk_bf16_f32 v73, v106, v107
    v_cvt_pk_bf16_f32 v74, v108, v109
    v_cvt_pk_bf16_f32 v75, v110, v111
    buffer_store_dwordx4 v[64:67], v0, s[4:7], s73 offen offset:0 sc1
    buffer_store_dwordx4 v[72:75], v0, s[4:7], s73 offen offset:1024 sc1
    v_pk_mul_f32 v[96:97], v[80:81], v[80:81]
    v_pk_mul_f32 v[98:99], v[82:83], v[82:83]
    v_pk_mul_f32 v[100:101], v[84:85], v[84:85]
    v_pk_mul_f32 v[102:103], v[86:87], v[86:87]
    v_pk_fma_f32 v[96:97], v[14:15], v[96:97], v[14:15] op_sel:[1,0,0] op_sel_hi:[1,1,0]
    v_pk_fma_f32 v[98:99], v[14:15], v[98:99], v[14:15] op_sel:[1,0,0] op_sel_hi:[1,1,0]
    v_pk_fma_f32 v[100:101], v[14:15], v[100:101], v[14:15] op_sel:[1,0,0] op_sel_hi:[1,1,0]
    v_pk_fma_f32 v[102:103], v[14:15], v[102:103], v[14:15] op_sel:[1,0,0] op_sel_hi:[1,1,0]
    v_pk_mul_f32 v[96:97], v[96:97], v[80:81]
    v_pk_mul_f32 v[98:99], v[98:99], v[82:83]
    v_pk_mul_f32 v[100:101], v[100:101], v[84:85]
    v_pk_mul_f32 v[102:103], v[102:103], v[86:87]
    v_pk_mul_f32 v[104:105], v[88:89], v[88:89]
    v_exp_f32 v96, v96
    v_pk_mul_f32 v[106:107], v[90:91], v[90:91]
    v_exp_f32 v97, v97
    v_pk_mul_f32 v[108:109], v[92:93], v[92:93]
    v_exp_f32 v98, v98
    v_pk_mul_f32 v[110:111], v[94:95], v[94:95]
    v_exp_f32 v99, v99
    v_pk_fma_f32 v[104:105], v[14:15], v[104:105], v[14:15] op_sel:[1,0,0] op_sel_hi:[1,1,0]
    v_exp_f32 v100, v100
    v_pk_fma_f32 v[106:107], v[14:15], v[106:107], v[14:15] op_sel:[1,0,0] op_sel_hi:[1,1,0]
    v_exp_f32 v101, v101
    v_pk_fma_f32 v[108:109], v[14:15], v[108:109], v[14:15] op_sel:[1,0,0] op_sel_hi:[1,1,0]
    v_exp_f32 v102, v102
    v_pk_fma_f32 v[110:111], v[14:15], v[110:111], v[14:15] op_sel:[1,0,0] op_sel_hi:[1,1,0]
    v_exp_f32 v103, v103
    v_pk_mul_f32 v[104:105], v[104:105], v[88:89]
    v_pk_fma_f32 v[96:97], v[96:97], v[12:13], v[12:13] op_sel:[0,0,0] op_sel_hi:[1,0,0]
    v_pk_mul_f32 v[106:107], v[106:107], v[90:91]
    v_pk_fma_f32 v[98:99], v[98:99], v[12:13], v[12:13] op_sel:[0,0,0] op_sel_hi:[1,0,0]
    v_pk_mul_f32 v[108:109], v[108:109], v[92:93]
    v_pk_fma_f32 v[100:101], v[100:101], v[12:13], v[12:13] op_sel:[0,0,0] op_sel_hi:[1,0,0]
    v_pk_mul_f32 v[110:111], v[110:111], v[94:95]
    v_pk_fma_f32 v[102:103], v[102:103], v[12:13], v[12:13] op_sel:[0,0,0] op_sel_hi:[1,0,0]
    v_exp_f32 v104, v104
    v_rcp_f32 v96, v96
    v_exp_f32 v105, v105
    v_rcp_f32 v97, v97
    v_exp_f32 v106, v106
    v_rcp_f32 v98, v98
    v_exp_f32 v107, v107
    v_rcp_f32 v99, v99
    v_exp_f32 v108, v108
    v_rcp_f32 v100, v100
    v_exp_f32 v109, v109
    v_rcp_f32 v101, v101
    v_exp_f32 v110, v110
    v_rcp_f32 v102, v102
    v_exp_f32 v111, v111
    v_rcp_f32 v103, v103
    v_pk_fma_f32 v[104:105], v[104:105], v[12:13], v[12:13] op_sel:[0,0,0] op_sel_hi:[1,0,0]
    v_pk_mul_f32 v[96:97], v[96:97], v[80:81]
    v_pk_fma_f32 v[106:107], v[106:107], v[12:13], v[12:13] op_sel:[0,0,0] op_sel_hi:[1,0,0]
    v_pk_mul_f32 v[98:99], v[98:99], v[82:83]
    v_pk_fma_f32 v[108:109], v[108:109], v[12:13], v[12:13] op_sel:[0,0,0] op_sel_hi:[1,0,0]
    v_pk_mul_f32 v[100:101], v[100:101], v[84:85]
    v_pk_fma_f32 v[110:111], v[110:111], v[12:13], v[12:13] op_sel:[0,0,0] op_sel_hi:[1,0,0]
    v_pk_mul_f32 v[102:103], v[102:103], v[86:87]
    v_rcp_f32 v104, v104
    v_cvt_pk_bf16_f32 v80, v96, v97
    v_rcp_f32 v105, v105
    v_cvt_pk_bf16_f32 v81, v98, v99
    v_rcp_f32 v106, v106
    v_cvt_pk_bf16_f32 v82, v100, v101
    v_rcp_f32 v107, v107
    v_cvt_pk_bf16_f32 v83, v102, v103
    v_rcp_f32 v108, v108
    v_rcp_f32 v109, v109
    v_rcp_f32 v110, v110
    v_rcp_f32 v111, v111
    v_pk_mul_f32 v[104:105], v[104:105], v[88:89]
    v_pk_mul_f32 v[106:107], v[106:107], v[90:91]
    v_pk_mul_f32 v[108:109], v[108:109], v[92:93]
    v_pk_mul_f32 v[110:111], v[110:111], v[94:95]
    v_cvt_pk_bf16_f32 v88, v104, v105
    v_cvt_pk_bf16_f32 v89, v106, v107
    v_cvt_pk_bf16_f32 v90, v108, v109
    v_cvt_pk_bf16_f32 v91, v110, v111
    buffer_store_dwordx4 v[80:83], v0, s[4:7], s73 offen offset:2048 sc1
    buffer_store_dwordx4 v[88:91], v0, s[4:7], s73 offen offset:3072 sc1
    v_add_u32 v13, 512, v13
    s_waitcnt lgkmcnt(11)
    v_mfma_f32_32x32x16_bf16 v[96:111], v[48:51], v[128:131], 0
    ds_read_b64_tr_b16 v[48:49], v10 offset:38912
    ds_read_b64_tr_b16 v[50:51], v10 offset:39424
    s_waitcnt lgkmcnt(11)
    v_mfma_f32_32x32x16_bf16 v[112:127], v[52:55], v[128:131], 0
    ds_read_b64_tr_b16 v[52:53], v11 offset:38912
    ds_read_b64_tr_b16 v[54:55], v11 offset:39424
    s_waitcnt lgkmcnt(11)
    v_mfma_f32_32x32x16_bf16 v[96:111], v[32:35], v[132:135], v[96:111]
    ds_read_b64_tr_b16 v[32:33], v10 offset:40960
    ds_read_b64_tr_b16 v[34:35], v10 offset:41472
    s_waitcnt lgkmcnt(11)
    v_mfma_f32_32x32x16_bf16 v[112:127], v[36:39], v[132:135], v[112:127]
    ds_read_b64_tr_b16 v[36:37], v11 offset:40960
    ds_read_b64_tr_b16 v[38:39], v11 offset:41472
    s_waitcnt lgkmcnt(11)
    v_mfma_f32_32x32x16_bf16 v[96:111], v[40:43], v[136:139], v[96:111]
    ds_read_b64_tr_b16 v[40:41], v10 offset:43008
    ds_read_b64_tr_b16 v[42:43], v10 offset:43520
    s_waitcnt lgkmcnt(10)
    v_mfma_f32_32x32x16_bf16 v[112:127], v[44:47], v[136:139], v[112:127]
    ds_read_b64_tr_b16 v[44:45], v11 offset:43008
    ds_read_b64_tr_b16 v[46:47], v11 offset:43520
    s_waitcnt lgkmcnt(10)
    v_mfma_f32_32x32x16_bf16 v[96:111], v[48:51], v[140:143], v[96:111]
    ds_read_b64 v[8:9], v4 offset:32
    ds_read_b64_tr_b16 v[48:49], v10 offset:45056
    ds_read_b64_tr_b16 v[50:51], v10 offset:45568
    s_waitcnt lgkmcnt(11)
    v_mfma_f32_32x32x16_bf16 v[112:127], v[52:55], v[140:143], v[112:127]
    ds_read_b64_tr_b16 v[52:53], v11 offset:45056
    ds_read_b64_tr_b16 v[54:55], v11 offset:45568
    s_waitcnt lgkmcnt(11)
    v_mfma_f32_32x32x16_bf16 v[96:111], v[32:35], v[144:147], v[96:111]
    ds_read_b64_tr_b16 v[32:33], v10 offset:47104
    ds_read_b64_tr_b16 v[34:35], v10 offset:47616
    s_mul_i32 s51, s77, 112
    s_waitcnt lgkmcnt(11)
    v_mfma_f32_32x32x16_bf16 v[112:127], v[36:39], v[144:147], v[112:127]
    ds_read_b64_tr_b16 v[36:37], v11 offset:47104
    ds_read_b64_tr_b16 v[38:39], v11 offset:47616
    s_lshl_b32 s52, s45, 2
    s_waitcnt lgkmcnt(11)
    v_mfma_f32_32x32x16_bf16 v[96:111], v[40:43], v[148:151], v[96:111]
    s_waitcnt lgkmcnt(8)
    v_min_u32 v8, v8, v9
    s_nop 0
    v_readfirstlane_b32 s48, v8
    s_nop 1
    s_sub_i32 s48, s48, s49
    s_cmp_gt_i32 s48, 23
    s_cbranch_scc0 NW_128
NWB_129:
    ds_read_b64_tr_b16 v[40:41], v10 offset:49152
    ds_read_b64_tr_b16 v[42:43], v10 offset:49664
    s_add_u32 s51, s51, s52
    v_mfma_f32_32x32x16_bf16 v[112:127], v[44:47], v[148:151], v[112:127]
    ds_read_b64_tr_b16 v[44:45], v11 offset:49152
    ds_read_b64_tr_b16 v[46:47], v11 offset:49664
    s_add_u32 s51, s51, s69
    s_waitcnt lgkmcnt(10)
    v_mfma_f32_32x32x16_bf16 v[96:111], v[48:51], v[152:155], v[96:111]
    ds_read_b64_tr_b16 v[48:49], v10 offset:51200
    ds_read_b64_tr_b16 v[50:51], v10 offset:51712
    v_and_b32 v56, 0x70, v0
    s_waitcnt lgkmcnt(10)
    v_mfma_f32_32x32x16_bf16 v[112:127], v[52:55], v[152:155], v[112:127]
    ds_read_b64_tr_b16 v[52:53], v11 offset:51200
    ds_read_b64_tr_b16 v[54:55], v11 offset:51712
    v_min_u32 v56, 96, v56
    s_waitcnt lgkmcnt(10)
    v_mfma_f32_32x32x16_bf16 v[96:111], v[32:35], v[156:159], v[96:111]
    ds_read_b64_tr_b16 v[32:33], v10 offset:53248
    ds_read_b64_tr_b16 v[34:35], v10 offset:53760
    v_add_u32 v56, s51, v56
    s_waitcnt lgkmcnt(10)
    v_mfma_f32_32x32x16_bf16 v[112:127], v[36:39], v[156:159], v[112:127]
    v_add_u32 v6, 1, v6
    ds_write_b32 v5, v6
    ds_read_b64_tr_b16 v[36:37], v11 offset:53248
    ds_read_b64_tr_b16 v[38:39], v11 offset:53760
    s_add_u32 s54, s50, 5
    s_waitcnt lgkmcnt(11)
    v_mfma_f32_32x32x16_bf16 v[96:111], v[40:43], v[160:163], v[96:111]
    ds_read_b64_tr_b16 v[40:41], v10 offset:55296
    ds_read_b64_tr_b16 v[42:43], v10 offset:55808
    s_mul_i32 s71, s45, 114688
    s_waitcnt lgkmcnt(11)
    v_mfma_f32_32x32x16_bf16 v[112:127], v[44:47], v[160:163], v[112:127]
    ds_read_b64_tr_b16 v[44:45], v11 offset:55296
    ds_read_b64_tr_b16 v[46:47], v11 offset:55808
    s_mul_i32 s51, s77, 28672
    s_waitcnt lgkmcnt(11)
    v_mfma_f32_32x32x16_bf16 v[96:111], v[48:51], v[164:167], v[96:111]
    ds_read_b64_tr_b16 v[48:49], v10 offset:57344
    ds_read_b64_tr_b16 v[50:51], v10 offset:57856
    s_add_u32 s71, s71, s51
    s_waitcnt lgkmcnt(11)
    v_mfma_f32_32x32x16_bf16 v[112:127], v[52:55], v[164:167], v[112:127]
    ds_read_b64_tr_b16 v[52:53], v11 offset:57344
    ds_read_b64_tr_b16 v[54:55], v11 offset:57856
    s_add_u32 s71, s71, s66
    s_waitcnt lgkmcnt(11)
    v_mfma_f32_32x32x16_bf16 v[96:111], v[32:35], v[168:171], v[96:111]
    ds_read_b64_tr_b16 v[32:33], v10 offset:59392
    ds_read_b64_tr_b16 v[34:35], v10 offset:59904
    s_waitcnt lgkmcnt(10)
    v_mfma_f32_32x32x16_bf16 v[112:127], v[36:39], v[168:171], v[112:127]
    ds_read_b64_tr_b16 v[36:37], v11 offset:59392
    ds_read_b64_tr_b16 v[38:39], v11 offset:59904
    s_waitcnt lgkmcnt(10)
    v_mfma_f32_32x32x16_bf16 v[96:111], v[40:43], v[172:175], v[96:111]
    ds_read_b64 v[8:9], v4 offset:32
    ds_read_b64_tr_b16 v[40:41], v10 offset:61440
    ds_read_b64_tr_b16 v[42:43], v10 offset:61952
    s_waitcnt lgkmcnt(11)
    v_mfma_f32_32x32x16_bf16 v[112:127], v[44:47], v[172:175], v[112:127]
    ds_read_b64_tr_b16 v[44:45], v11 offset:61440
    ds_read_b64_tr_b16 v[46:47], v11 offset:61952
    s_waitcnt lgkmcnt(11)
    v_mfma_f32_32x32x16_bf16 v[96:111], v[48:51], v[176:179], v[96:111]
    ds_read_b64_tr_b16 v[48:49], v10 offset:63488
    ds_read_b64_tr_b16 v[50:51], v10 offset:64000
    s_waitcnt vmcnt(0)
    s_add_u32 s51, s50, 5
    v_mov_b32 v58, s51
    v_mov_b32 v59, 0
    s_mov_b64 exec, 1
    s_cmp_eq_u32 s47, 3
    s_cbranch_scc0 STF_130
    buffer_store_dword v58, v59, s[4:7], s68 offen
STE_131:
    s_mov_b64 exec, -1
    s_waitcnt lgkmcnt(11)
    v_mfma_f32_32x32x16_bf16 v[112:127], v[52:55], v[176:179], v[112:127]
    ds_read_b64_tr_b16 v[52:53], v11 offset:63488
    ds_read_b64_tr_b16 v[54:55], v11 offset:64000
    s_waitcnt lgkmcnt(11)
    v_mfma_f32_32x32x16_bf16 v[96:111], v[32:35], v[180:183], v[96:111]
    s_waitcnt lgkmcnt(8)
    v_min_u32 v8, v8, v9
    s_nop 0
    v_readfirstlane_b32 s48, v8
    s_nop 1
    s_sub_i32 s48, s48, s49
    s_cmp_gt_i32 s48, 24
    s_cbranch_scc0 NW_132
NWB_133:
    v_xor_b32 v10, 0x10000, v10
    v_xor_b32 v11, 0x10000, v11
    ds_read_b64_tr_b16 v[32:33], v10 offset:0
    ds_read_b64_tr_b16 v[34:35], v10 offset:512
    v_mfma_f32_32x32x16_bf16 v[112:127], v[36:39], v[180:183], v[112:127]
    ds_read_b64_tr_b16 v[36:37], v11 offset:0
    ds_read_b64_tr_b16 v[38:39], v11 offset:512
    s_waitcnt lgkmcnt(10)
    v_mfma_f32_32x32x16_bf16 v[96:111], v[40:43], v[184:187], v[96:111]
    ds_read_b64_tr_b16 v[40:41], v10 offset:2048
    ds_read_b64_tr_b16 v[42:43], v10 offset:2560
    s_waitcnt lgkmcnt(10)
    v_mfma_f32_32x32x16_bf16 v[112:127], v[44:47], v[184:187], v[112:127]
    ds_read_b64_tr_b16 v[44:45], v11 offset:2048
    ds_read_b64_tr_b16 v[46:47], v11 offset:2560
    s_waitcnt lgkmcnt(10)
    v_mfma_f32_32x32x16_bf16 v[96:111], v[48:51], v[188:191], v[96:111]
    ds_read_b64_tr_b16 v[48:49], v10 offset:4096
    ds_read_b64_tr_b16 v[50:51], v10 offset:4608
    s_waitcnt lgkmcnt(10)
    v_mfma_f32_32x32x16_bf16 v[112:127], v[52:55], v[188:191], v[112:127]
    v_add_u32 v6, 1, v6
    ds_write_b32 v5, v6
    ds_read_b64_tr_b16 v[52:53], v11 offset:4096
    ds_read_b64_tr_b16 v[54:55], v11 offset:4608
    s_waitcnt lgkmcnt(11)
    v_mfma_f32_32x32x16_bf16 v[96:111], v[32:35], v[192:195], v[96:111]
    ds_read_b64_tr_b16 v[32:33], v10 offset:6144
    ds_read_b64_tr_b16 v[34:35], v10 offset:6656
    s_waitcnt lgkmcnt(11)
    v_mfma_f32_32x32x16_bf16 v[112:127], v[36:39], v[192:195], v[112:127]
    ds_read_b64_tr_b16 v[36:37], v11 offset:6144
    ds_read_b64_tr_b16 v[38:39], v11 offset:6656
    s_waitcnt lgkmcnt(11)
    v_mfma_f32_32x32x16_bf16 v[96:111], v[40:43], v[196:199], v[96:111]
    ds_read_b64_tr_b16 v[40:41], v10 offset:8192
    ds_read_b64_tr_b16 v[42:43], v10 offset:8704
    s_waitcnt lgkmcnt(11)
    v_mfma_f32_32x32x16_bf16 v[112:127], v[44:47], v[196:199], v[112:127]
    ds_read_b64_tr_b16 v[44:45], v11 offset:8192
    ds_read_b64_tr_b16 v[46:47], v11 offset:8704
    s_waitcnt lgkmcnt(11)
    v_mfma_f32_32x32x16_bf16 v[96:111], v[48:51], v[200:203], v[96:111]
    ds_read_b64_tr_b16 v[48:49], v10 offset:10240
    ds_read_b64_tr_b16 v[50:51], v10 offset:10752
    s_waitcnt lgkmcnt(10)
    v_mfma_f32_32x32x16_bf16 v[112:127], v[52:55], v[200:203], v[112:127]
    ds_read_b64_tr_b16 v[52:53], v11 offset:10240
    ds_read_b64_tr_b16 v[54:55], v11 offset:10752
    s_waitcnt lgkmcnt(10)
    v_mfma_f32_32x32x16_bf16 v[96:111], v[32:35], v[204:207], v[96:111]
    ds_read_b64 v[8:9], v4 offset:32
    ds_read_b64_tr_b16 v[32:33], v10 offset:12288
    ds_read_b64_tr_b16 v[34:35], v10 offset:12800
    s_waitcnt lgkmcnt(11)
    v_mfma_f32_32x32x16_bf16 v[112:127], v[36:39], v[204:207], v[112:127]
    ds_read_b64_tr_b16 v[36:37], v11 offset:12288
    ds_read_b64_tr_b16 v[38:39], v11 offset:12800
    s_waitcnt lgkmcnt(11)
    v_mfma_f32_32x32x16_bf16 v[96:111], v[40:43], v[208:211], v[96:111]
    ds_read_b64_tr_b16 v[40:41], v10 offset:14336
    ds_read_b64_tr_b16 v[42:43], v10 offset:14848
    s_waitcnt lgkmcnt(11)
    v_mfma_f32_32x32x16_bf16 v[112:127], v[44:47], v[208:211], v[112:127]
    ds_read_b64_tr_b16 v[44:45], v11 offset:14336
    ds_read_b64_tr_b16 v[46:47], v11 offset:14848
    s_waitcnt lgkmcnt(11)
    v_mfma_f32_32x32x16_bf16 v[96:111], v[48:51], v[212:215], v[96:111]
    s_waitcnt lgkmcnt(8)
    v_min_u32 v8, v8, v9
    s_nop 0
    v_readfirstlane_b32 s48, v8
    s_nop 1
    s_sub_i32 s48, s48, s49
    s_cmp_gt_i32 s48, 25
    s_cbranch_scc0 NW_134
NWB_135:
    ds_read_b64_tr_b16 v[48:49], v10 offset:16384
    ds_read_b64_tr_b16 v[50:51], v10 offset:16896
    v_mfma_f32_32x32x16_bf16 v[112:127], v[52:55], v[212:215], v[112:127]
    ds_read_b64_tr_b16 v[52:53], v11 offset:16384
    ds_read_b64_tr_b16 v[54:55], v11 offset:16896
    s_waitcnt lgkmcnt(10)
    v_mfma_f32_32x32x16_bf16 v[96:111], v[32:35], v[216:219], v[96:111]
    ds_read_b64_tr_b16 v[32:33], v10 offset:18432
    ds_read_b64_tr_b16 v[34:35], v10 offset:18944
    s_cmp_eq_u32 s46, 0
    s_cbranch_scc0 CSK_136
    s_mov_b32 s55, 0
LW_137:
    ds_read_b32 v64, v4 offset:116
    s_waitcnt lgkmcnt(0)
    v_readfirstlane_b32 s52, v64
    s_nop 1
    s_cmp_ge_u32 s52, 2
    s_cbranch_scc1 LWD_138
    s_add_u32 s55, s55, 1
    s_cmp_lt_u32 s55, 4000000
    s_cbranch_scc1 LW_137
    s_branch ABORT
LWD_138:
CSK_136:
    ds_read_b32 v65, v13 offset:0
    ds_read_b32 v67, v13 offset:256
    s_waitcnt lgkmcnt(12)
    v_mfma_f32_32x32x16_bf16 v[112:127], v[36:39], v[216:219], v[112:127]
    ds_read_b64_tr_b16 v[36:37], v11 offset:18432
    ds_read_b64_tr_b16 v[38:39], v11 offset:18944
    s_waitcnt lgkmcnt(12)
    v_mfma_f32_32x32x16_bf16 v[96:111], v[40:43], v[220:223], v[96:111]
    s_waitcnt lgkmcnt(10)
    v_add_u32 v6, 1, v6
    ds_write_b32 v5, v6
    ds_read_b64_tr_b16 v[40:41], v10 offset:20480
    ds_read_b64_tr_b16 v[42:43], v10 offset:20992
    v_mfma_f32_32x32x16_bf16 v[112:127], v[44:47], v[220:223], v[112:127]
    ds_read_b64_tr_b16 v[44:45], v11 offset:20480
    ds_read_b64_tr_b16 v[46:47], v11 offset:20992
    s_waitcnt lgkmcnt(13)
    v_mfma_f32_32x32x16_bf16 v[96:111], v[48:51], v[224:227], v[96:111]
    ds_read_b64_tr_b16 v[48:49], v10 offset:22528
    ds_read_b64_tr_b16 v[50:51], v10 offset:23040
    s_waitcnt lgkmcnt(13)
    v_mfma_f32_32x32x16_bf16 v[112:127], v[52:55], v[224:227], v[112:127]
    ds_read_b64_tr_b16 v[52:53], v11 offset:22528
    ds_read_b64_tr_b16 v[54:55], v11 offset:23040
    s_waitcnt lgkmcnt(13)
    v_mfma_f32_32x32x16_bf16 v[96:111], v[32:35], v[228:231], v[96:111]
    ds_read_b64_tr_b16 v[32:33], v10 offset:24576
    ds_read_b64_tr_b16 v[34:35], v10 offset:25088
    s_waitcnt lgkmcnt(13)
    v_mov_b32 v69, 0
    v_cvt_pk_bf16_f32 v64, v65, v65
    v_and_b32 v68, 0xffff0000, v64
    v_sub_f32 v65, v65, v68
    v_cvt_pk_bf16_f32 v65, v65, 0
    v_cvt_pk_bf16_f32 v66, v67, v67
    v_and_b32 v68, 0xffff0000, v66
    v_sub_f32 v67, v67, v68
    v_cvt_pk_bf16_f32 v67, v67, 0
    s_waitcnt lgkmcnt(11)
    v_mfma_f32_32x32x16_bf16 v[112:127], v[36:39], v[228:231], v[112:127]
    ds_read_b64_tr_b16 v[36:37], v11 offset:24576
    ds_read_b64_tr_b16 v[38:39], v11 offset:25088
    s_waitcnt lgkmcnt(10)
    v_mfma_f32_32x32x16_bf16 v[96:111], v[40:43], v[232:235], v[96:111]
    ds_read_b64_tr_b16 v[40:41], v10 offset:26624
    ds_read_b64_tr_b16 v[42:43], v10 offset:27136
    buffer_load_dword v57, v56, s[4:7], 0 offen sc1
    s_waitcnt lgkmcnt(10)
    v_mfma_f32_32x32x16_bf16 v[112:127], v[44:47], v[232:235], v[112:127]
    ds_read_b64_tr_b16 v[44:45], v11 offset:26624
    ds_read_b64_tr_b16 v[46:47], v11 offset:27136
    s_waitcnt lgkmcnt(10)
    v_mfma_f32_32x32x16_bf16 v[96:111], v[48:51], v[236:239], v[96:111]
    ds_read_b64_tr_b16 v[48:49], v10 offset:28672
    ds_read_b64_tr_b16 v[50:51], v10 offset:29184
    s_waitcnt lgkmcnt(10)
    v_mfma_f32_32x32x16_bf16 v[112:127], v[52:55], v[236:239], v[112:127]
    ds_read_b64_tr_b16 v[52:53], v11 offset:28672
    ds_read_b64_tr_b16 v[54:55], v11 offset:29184
    v_mfma_f32_32x32x16_bf16 v[96:111], v[64:67], v[60:63], v[96:111]
    s_waitcnt lgkmcnt(10)
    v_mfma_f32_32x32x16_bf16 v[96:111], v[32:35], v[240:243], v[96:111]
    ds_read_b64_tr_b16 v[32:33], v10 offset:30720
    ds_read_b64_tr_b16 v[34:35], v10 offset:31232
    v_mfma_f32_32x32x16_bf16 v[112:127], v[66:69], v[60:63], v[112:127]
    s_waitcnt lgkmcnt(10)
    v_mfma_f32_32x32x16_bf16 v[112:127], v[36:39], v[240:243], v[112:127]
    ds_read_b64_tr_b16 v[36:37], v11 offset:30720
    ds_read_b64_tr_b16 v[38:39], v11 offset:31232
    s_waitcnt lgkmcnt(10)
    v_mfma_f32_32x32x16_bf16 v[96:111], v[40:43], v[244:247], v[96:111]
    s_waitcnt lgkmcnt(8)
    v_mfma_f32_32x32x16_bf16 v[112:127], v[44:47], v[244:247], v[112:127]
    s_waitcnt lgkmcnt(6)
    v_mfma_f32_32x32x16_bf16 v[96:111], v[48:51], v[248:251], v[96:111]
    s_waitcnt lgkmcnt(4)
    v_mfma_f32_32x32x16_bf16 v[112:127], v[52:55], v[248:251], v[112:127]
    s_waitcnt lgkmcnt(2)
    v_mfma_f32_32x32x16_bf16 v[96:111], v[32:35], v[252:255], v[96:111]
    s_waitcnt lgkmcnt(0)
    v_mfma_f32_32x32x16_bf16 v[112:127], v[36:39], v[252:255], v[112:127]
    v_add_u32 v6, 1, v6
    ds_write_b32 v5, v6
    s_mul_i32 s51, s77, 8256
    s_add_u32 s51, s51, 0
    v_xor_b32 v10, s51, v2
    v_xor_b32 v11, 64, v10
    s_waitcnt vmcnt(0)
    v_cmp_le_u32 vcc, s54, v57
    s_nop 1
    s_cmp_eq_u64 vcc, -1
    s_cbranch_scc1 P6_P
    s_mov_b32 s55, 0
POLL_139:
    buffer_load_dword v57, v56, s[4:7], 0 offen sc1
POLLC_140:
    s_waitcnt vmcnt(0)
    v_cmp_le_u32 vcc, s54, v57
    s_nop 1
    s_cmp_eq_u64 vcc, -1
    s_cbranch_scc1 POLLD_141
    s_add_u32 s55, s55, 1
    s_cmp_lt_u32 s55, 400000
    s_cbranch_scc1 POLL_139
    s_branch ABORT
POLLD_141:
P6_P:
    buffer_load_dwordx4 v[64:67], v0, s[4:7], s71 offen offset:0 sc1
    buffer_load_dwordx4 v[68:71], v0, s[4:7], s71 offen offset:1024 sc1
    buffer_load_dwordx4 v[72:75], v0, s[4:7], s71 offen offset:2048 sc1
    buffer_load_dwordx4 v[76:79], v0, s[4:7], s71 offen offset:3072 sc1
    s_add_u32 s71, s71, 4096
    buffer_load_dwordx4 v[80:83], v0, s[4:7], s71 offen offset:0 sc1
    buffer_load_dwordx4 v[84:87], v0, s[4:7], s71 offen offset:1024 sc1
    buffer_load_dwordx4 v[88:91], v0, s[4:7], s71 offen offset:2048 sc1
    buffer_load_dwordx4 v[92:95], v0, s[4:7], s71 offen offset:3072 sc1
    v_pk_mul_f32 v[32:33], v[96:97], v[96:97]
    v_pk_mul_f32 v[34:35], v[98:99], v[98:99]
    v_pk_mul_f32 v[36:37], v[100:101], v[100:101]
    v_pk_mul_f32 v[38:39], v[102:103], v[102:103]
    s_cmp_gt_i32 s48, 26
    s_cbranch_scc0 NW_142
NWB_143:
    ds_read_b64_tr_b16 v[128:129], v11 offset:32768
    ds_read_b64_tr_b16 v[130:131], v11 offset:33280
    v_pk_fma_f32 v[32:33], v[14:15], v[32:33], v[14:15] op_sel:[1,0,0] op_sel_hi:[1,1,0]
    v_pk_fma_f32 v[34:35], v[14:15], v[34:35], v[14:15] op_sel:[1,0,0] op_sel_hi:[1,1,0]
    v_pk_fma_f32 v[36:37], v[14:15], v[36:37], v[14:15] op_sel:[1,0,0] op_sel_hi:[1,1,0]
    v_pk_fma_f32 v[38:39], v[14:15], v[38:39], v[14:15] op_sel:[1,0,0] op_sel_hi:[1,1,0]
    ds_read_b64_tr_b16 v[132:133], v10 offset:32768
    ds_read_b64_tr_b16 v[134:135], v10 offset:33280
    v_pk_mul_f32 v[32:33], v[32:33], v[96:97]
    v_pk_mul_f32 v[34:35], v[34:35], v[98:99]
    v_pk_mul_f32 v[36:37], v[36:37], v[100:101]
    v_pk_mul_f32 v[38:39], v[38:39], v[102:103]
    ds_read_b64_tr_b16 v[136:137], v11 offset:34816
    ds_read_b64_tr_b16 v[138:139], v11 offset:35328
    v_pk_mul_f32 v[40:41], v[104:105], v[104:105]
    v_exp_f32 v32, v32
    v_pk_mul_f32 v[42:43], v[106:107], v[106:107]
    v_exp_f32 v33, v33
    ds_read_b64_tr_b16 v[140:141], v10 offset:34816
    ds_read_b64_tr_b16 v[142:143], v10 offset:35328
    v_pk_mul_f32 v[44:45], v[108:109], v[108:109]
    v_exp_f32 v34, v34
    v_pk_mul_f32 v[46:47], v[110:111], v[110:111]
    v_exp_f32 v35, v35
    ds_read_b64_tr_b16 v[144:145], v11 offset:36864
    ds_read_b64_tr_b16 v[146:147], v11 offset:37376
    v_pk_fma_f32 v[40:41], v[14:15], v[40:41], v[14:15] op_sel:[1,0,0] op_sel_hi:[1,1,0]
    v_exp_f32 v36, v36
    v_pk_fma_f32 v[42:43], v[14:15], v[42:43], v[14:15] op_sel:[1,0,0] op_sel_hi:[1,1,0]
    v_exp_f32 v37, v37
    ds_read_b64_tr_b16 v[148:149], v10 offset:36864
    ds_read_b64_tr_b16 v[150:151], v10 offset:37376
    v_pk_fma_f32 v[44:45], v[14:15], v[44:45], v[14:15] op_sel:[1,0,0] op_sel_hi:[1,1,0]
    v_exp_f32 v38, v38
    v_pk_fma_f32 v[46:47], v[14:15], v[46:47], v[14:15] op_sel:[1,0,0] op_sel_hi:[1,1,0]
    v_exp_f32 v39, v39
    ds_read_b64_tr_b16 v[152:153], v11 offset:38912
    ds_read_b64_tr_b16 v[154:155], v11 offset:39424
    v_pk_mul_f32 v[40:41], v[40:41], v[104:105]
    v_pk_fma_f32 v[32:33], v[32:33], v[12:13], v[12:13] op_sel:[0,0,0] op_sel_hi:[1,0,0]
    v_pk_mul_f32 v[42:43], v[42:43], v[106:107]
    v_pk_fma_f32 v[34:35], v[34:35], v[12:13], v[12:13] op_sel:[0,0,0] op_sel_hi:[1,0,0]
    ds_read_b64_tr_b16 v[156:157], v10 offset:38912
    ds_read_b64_tr_b16 v[158:159], v10 offset:39424
    v_pk_mul_f32 v[44:45], v[44:45], v[108:109]
    v_pk_fma_f32 v[36:37], v[36:37], v[12:13], v[12:13] op_sel:[0,0,0] op_sel_hi:[1,0,0]
    v_pk_mul_f32 v[46:47], v[46:47], v[110:111]
    v_pk_fma_f32 v[38:39], v[38:39], v[12:13], v[12:13] op_sel:[0,0,0] op_sel_hi:[1,0,0]
    s_cmp_gt_i32 s48, 27
    s_cbranch_scc0 NW_144
NWB_145:
    ds_read_b64_tr_b16 v[160:161], v11 offset:49152
    ds_read_b64_tr_b16 v[162:163], v11 offset:49664
    v_exp_f32 v40, v40
    v_rcp_f32 v32, v32
    v_exp_f32 v41, v41
    v_rcp_f32 v33, v33
    ds_read_b64_tr_b16 v[164:165], v10 offset:49152
    ds_read_b64_tr_b16 v[166:167], v10 offset:49664
    v_exp_f32 v42, v42
    v_rcp_f32 v34, v34
    v_exp_f32 v43, v43
    v_rcp_f32 v35, v35
    ds_read_b64_tr_b16 v[168:169], v11 offset:51200
    ds_read_b64_tr_b16 v[170:171], v11 offset:51712
    s_waitcnt lgkmcnt(6)
    v_add_u32 v6, 1, v6
    ds_write_b32 v5, v6
    v_exp_f32 v44, v44
    v_rcp_f32 v36, v36
    v_exp_f32 v45, v45
    v_rcp_f32 v37, v37
    ds_read_b64_tr_b16 v[172:173], v10 offset:51200
    ds_read_b64_tr_b16 v[174:175], v10 offset:51712
    v_exp_f32 v46, v46
    v_rcp_f32 v38, v38
    v_exp_f32 v47, v47
    v_rcp_f32 v39, v39
    ds_read_b64_tr_b16 v[176:177], v11 offset:53248
    ds_read_b64_tr_b16 v[178:179], v11 offset:53760
    v_pk_fma_f32 v[40:41], v[40:41], v[12:13], v[12:13] op_sel:[0,0,0] op_sel_hi:[1,0,0]
    v_pk_mul_f32 v[32:33], v[32:33], v[96:97]
    v_pk_fma_f32 v[42:43], v[42:43], v[12:13], v[12:13] op_sel:[0,0,0] op_sel_hi:[1,0,0]
    v_pk_mul_f32 v[34:35], v[34:35], v[98:99]
    ds_read_b64_tr_b16 v[180:181], v10 offset:53248
    ds_read_b64_tr_b16 v[182:183], v10 offset:53760
    v_pk_fma_f32 v[44:45], v[44:45], v[12:13], v[12:13] op_sel:[0,0,0] op_sel_hi:[1,0,0]
    v_pk_mul_f32 v[36:37], v[36:37], v[100:101]
    v_pk_fma_f32 v[46:47], v[46:47], v[12:13], v[12:13] op_sel:[0,0,0] op_sel_hi:[1,0,0]
    v_pk_mul_f32 v[38:39], v[38:39], v[102:103]
    ds_read_b64_tr_b16 v[184:185], v11 offset:55296
    ds_read_b64_tr_b16 v[186:187], v11 offset:55808
    v_rcp_f32 v40, v40
    v_cvt_pk_bf16_f32 v96, v32, v33
    v_rcp_f32 v41, v41
    v_cvt_pk_bf16_f32 v97, v34, v35
    ds_read_b64_tr_b16 v[188:189], v10 offset:55296
    ds_read_b64_tr_b16 v[190:191], v10 offset:55808
    v_rcp_f32 v42, v42
    v_cvt_pk_bf16_f32 v98, v36, v37
    v_rcp_f32 v43, v43
    v_cvt_pk_bf16_f32 v99, v38, v39
    v_rcp_f32 v44, v44
    v_rcp_f32 v45, v45
    v_rcp_f32 v46, v46
    v_rcp_f32 v47, v47
    v_pk_mul_f32 v[40:41], v[40:41], v[104:105]
    v_pk_mul_f32 v[42:43], v[42:43], v[106:107]
    v_pk_mul_f32 v[44:45], v[44:45], v[108:109]
    v_pk_mul_f32 v[46:47], v[46:47], v[110:111]
    v_cvt_pk_bf16_f32 v104, v40, v41
    v_cvt_pk_bf16_f32 v105, v42, v43
    v_cvt_pk_bf16_f32 v106, v44, v45
    v_cvt_pk_bf16_f32 v107, v46, v47
    buffer_store_dwordx4 v[96:99], v0, s[4:7], s72 offen offset:0 sc1
    buffer_store_dwordx4 v[104:107], v0, s[4:7], s72 offen offset:1024 sc1
    v_pk_mul_f32 v[32:33], v[112:113], v[112:113]
    v_pk_mul_f32 v[34:35], v[114:115], v[114:115]
    v_pk_mul_f32 v[36:37], v[116:117], v[116:117]
    v_pk_mul_f32 v[38:39], v[118:119], v[118:119]
    s_cmp_gt_i32 s48, 28
    s_cbranch_scc0 NW_146
NWB_147:
    v_xor_b32 v10, 0x10000, v10
    v_xor_b32 v11, 0x10000, v11
    ds_read_b64_tr_b16 v[192:193], v11 offset:0
    ds_read_b64_tr_b16 v[194:195], v11 offset:512
    s_add_u32 s71, s71, 4096
    buffer_load_dwordx4 v[96:99], v0, s[4:7], s71 offen offset:0 sc1
    v_pk_fma_f32 v[32:33], v[14:15], v[32:33], v[14:15] op_sel:[1,0,0] op_sel_hi:[1,1,0]
    v_pk_fma_f32 v[34:35], v[14:15], v[34:35], v[14:15] op_sel:[1,0,0] op_sel_hi:[1,1,0]
    v_pk_fma_f32 v[36:37], v[14:15], v[36:37], v[14:15] op_sel:[1,0,0] op_sel_hi:[1,1,0]
    v_pk_fma_f32 v[38:39], v[14:15], v[38:39], v[14:15] op_sel:[1,0,0] op_sel_hi:[1,1,0]
    ds_read_b64_tr_b16 v[196:197], v10 offset:0
    ds_read_b64_tr_b16 v[198:199], v10 offset:512
    v_pk_mul_f32 v[32:33], v[32:33], v[112:113]
    v_pk_mul_f32 v[34:35], v[34:35], v[114:115]
    v_pk_mul_f32 v[36:37], v[36:37], v[116:117]
    v_pk_mul_f32 v[38:39], v[38:39], v[118:119]
    ds_read_b64_tr_b16 v[200:201], v11 offset:2048
    ds_read_b64_tr_b16 v[202:203], v11 offset:2560
    s_waitcnt lgkmcnt(6)
    v_add_u32 v6, 1, v6
    ds_write_b32 v5, v6
    buffer_load_dwordx4 v[100:103], v0, s[4:7], s71 offen offset:1024 sc1
    v_pk_mul_f32 v[40:41], v[120:121], v[120:121]
    v_exp_f32 v32, v32
    v_pk_mul_f32 v[42:43], v[122:123], v[122:123]
    v_exp_f32 v33, v33
    ds_read_b64_tr_b16 v[204:205], v10 offset:2048
    ds_read_b64_tr_b16 v[206:207], v10 offset:2560
    v_pk_mul_f32 v[44:45], v[124:125], v[124:125]
    v_exp_f32 v34, v34
    v_pk_mul_f32 v[46:47], v[126:127], v[126:127]
    v_exp_f32 v35, v35
    ds_read_b64_tr_b16 v[208:209], v11 offset:4096
    ds_read_b64_tr_b16 v[210:211], v11 offset:4608
    buffer_load_dwordx4 v[104:107], v0, s[4:7], s71 offen offset:2048 sc1
    v_pk_fma_f32 v[40:41], v[14:15], v[40:41], v[14:15] op_sel:[1,0,0] op_sel_hi:[1,1,0]
    v_exp_f32 v36, v36
    v_pk_fma_f32 v[42:43], v[14:15], v[42:43], v[14:15] op_sel:[1,0,0] op_sel_hi:[1,1,0]
    v_exp_f32 v37, v37
    ds_read_b64_tr_b16 v[212:213], v10 offset:4096
    ds_read_b64_tr_b16 v[214:215], v10 offset:4608
    v_pk_fma_f32 v[44:45], v[14:15], v[44:45], v[14:15] op_sel:[1,0,0] op_sel_hi:[1,1,0]
    v_exp_f32 v38, v38
    v_pk_fma_f32 v[46:47], v[14:15], v[46:47], v[14:15] op_sel:[1,0,0] op_sel_hi:[1,1,0]
    v_exp_f32 v39, v39
    ds_read_b64_tr_b16 v[216:217], v11 offset:6144
    ds_read_b64_tr_b16 v[218:219], v11 offset:6656
    buffer_load_dwordx4 v[108:111], v0, s[4:7], s71 offen offset:3072 sc1
    v_pk_mul_f32 v[40:41], v[40:41], v[120:121]
    v_pk_fma_f32 v[32:33], v[32:33], v[12:13], v[12:13] op_sel:[0,0,0] op_sel_hi:[1,0,0]
    v_pk_mul_f32 v[42:43], v[42:43], v[122:123]
    v_pk_fma_f32 v[34:35], v[34:35], v[12:13], v[12:13] op_sel:[0,0,0] op_sel_hi:[1,0,0]
    ds_read_b64_tr_b16 v[220:221], v10 offset:6144
    ds_read_b64_tr_b16 v[222:223], v10 offset:6656
    v_pk_mul_f32 v[44:45], v[44:45], v[124:125]
    v_pk_fma_f32 v[36:37], v[36:37], v[12:13], v[12:13] op_sel:[0,0,0] op_sel_hi:[1,0,0]
    v_pk_mul_f32 v[46:47], v[46:47], v[126:127]
    v_pk_fma_f32 v[38:39], v[38:39], v[12:13], v[12:13] op_sel:[0,0,0] op_sel_hi:[1,0,0]
    s_cmp_gt_i32 s48, 29
    s_cbranch_scc0 NW_148
NWB_149:
    ds_read_b64_tr_b16 v[224:225], v11 offset:16384
    ds_read_b64_tr_b16 v[226:227], v11 offset:16896
    v_exp_f32 v40, v40
    v_rcp_f32 v32, v32
    v_exp_f32 v41, v41
    v_rcp_f32 v33, v33
    ds_read_b64_tr_b16 v[228:229], v10 offset:16384
    ds_read_b64_tr_b16 v[230:231], v10 offset:16896
    v_exp_f32 v42, v42
    v_rcp_f32 v34, v34
    v_exp_f32 v43, v43
    v_rcp_f32 v35, v35
    ds_read_b64_tr_b16 v[232:233], v11 offset:18432
    ds_read_b64_tr_b16 v[234:235], v11 offset:18944
    s_waitcnt lgkmcnt(6)
    v_add_u32 v6, 1, v6
    ds_write_b32 v5, v6
    v_exp_f32 v44, v44
    v_rcp_f32 v36, v36
    v_exp_f32 v45, v45
    v_rcp_f32 v37, v37
    ds_read_b64_tr_b16 v[236:237], v10 offset:18432
    ds_read_b64_tr_b16 v[238:239], v10 offset:18944
    v_exp_f32 v46, v46
    v_rcp_f32 v38, v38
    v_exp_f32 v47, v47
    v_rcp_f32 v39, v39
    ds_read_b64_tr_b16 v[240:241], v11 offset:20480
    ds_read_b64_tr_b16 v[242:243], v11 offset:20992
    v_pk_fma_f32 v[40:41], v[40:41], v[12:13], v[12:13] op_sel:[0,0,0] op_sel_hi:[1,0,0]
    v_pk_mul_f32 v[32:33], v[32:33], v[112:113]
    v_pk_fma_f32 v[42:43], v[42:43], v[12:13], v[12:13] op_sel:[0,0,0] op_sel_hi:[1,0,0]
    v_pk_mul_f32 v[34:35], v[34:35], v[114:115]
    ds_read_b64_tr_b16 v[244:245], v10 offset:20480
    ds_read_b64_tr_b16 v[246:247], v10 offset:20992
    v_pk_fma_f32 v[44:45], v[44:45], v[12:13], v[12:13] op_sel:[0,0,0] op_sel_hi:[1,0,0]
    v_pk_mul_f32 v[36:37], v[36:37], v[116:117]
    v_pk_fma_f32 v[46:47], v[46:47], v[12:13], v[12:13] op_sel:[0,0,0] op_sel_hi:[1,0,0]
    v_pk_mul_f32 v[38:39], v[38:39], v[118:119]
    ds_read_b64_tr_b16 v[248:249], v11 offset:22528
    ds_read_b64_tr_b16 v[250:251], v11 offset:23040
    v_rcp_f32 v40, v40
    v_cvt_pk_bf16_f32 v112, v32, v33
    v_rcp_f32 v41, v41
    v_cvt_pk_bf16_f32 v113, v34, v35
    ds_read_b64_tr_b16 v[252:253], v10 offset:22528
    ds_read_b64_tr_b16 v[254:255], v10 offset:23040
    v_rcp_f32 v42, v42
    v_cvt_pk_bf16_f32 v114, v36, v37
    v_rcp_f32 v43, v43
    v_cvt_pk_bf16_f32 v115, v38, v39
    v_rcp_f32 v44, v44
    v_rcp_f32 v45, v45
    v_rcp_f32 v46, v46
    v_rcp_f32 v47, v47
    v_pk_mul_f32 v[40:41], v[40:41], v[120:121]
    v_pk_mul_f32 v[42:43], v[42:43], v[122:123]
    v_pk_mul_f32 v[44:45], v[44:45], v[124:125]
    v_pk_mul_f32 v[46:47], v[46:47], v[126:127]
    v_cvt_pk_bf16_f32 v120, v40, v41
    v_cvt_pk_bf16_f32 v121, v42, v43
    v_cvt_pk_bf16_f32 v122, v44, v45
    v_cvt_pk_bf16_f32 v123, v46, v47
    buffer_store_dwordx4 v[112:115], v0, s[4:7], s72 offen offset:2048 sc1
    buffer_store_dwordx4 v[120:123], v0, s[4:7], s72 offen offset:3072 sc1
    s_branch P6_START
P5_SKIP:
    s_add_u32 s51, s50, 4
    v_mov_b32 v8, s51
    v_mov_b32 v9, 0
    s_mov_b64 exec, 1
    s_cmp_eq_u32 s47, 3
    s_waitcnt vmcnt(0)
    s_cbranch_scc0 STF_150
    buffer_store_dword v8, v9, s[4:7], s68 offen
STE_151:
    s_mov_b64 exec, -1
    v_add_u32 v6, 8, v6
    ds_write_b32 v5, v6
    s_mul_i32 s51, s77, 8256
    s_add_u32 s51, s51, 0
    v_xor_b32 v10, s51, v2
    v_xor_b32 v11, 64, v10
    s_cmp_gt_i32 s48, 26
    s_cbranch_scc0 NW_152
NWB_153:
    ds_read_b64_tr_b16 v[128:129], v11 offset:32768
    ds_read_b64_tr_b16 v[130:131], v11 offset:33280
    ds_read_b64_tr_b16 v[132:133], v10 offset:32768
    ds_read_b64_tr_b16 v[134:135], v10 offset:33280
    ds_read_b64_tr_b16 v[136:137], v11 offset:34816
    ds_read_b64_tr_b16 v[138:139], v11 offset:35328
    ds_read_b64_tr_b16 v[140:141], v10 offset:34816
    ds_read_b64_tr_b16 v[142:143], v10 offset:35328
    ds_read_b64_tr_b16 v[144:145], v11 offset:36864
    ds_read_b64_tr_b16 v[146:147], v11 offset:37376
    ds_read_b64_tr_b16 v[148:149], v10 offset:36864
    ds_read_b64_tr_b16 v[150:151], v10 offset:37376
    ds_read_b64_tr_b16 v[152:153], v11 offset:38912
    ds_read_b64_tr_b16 v[154:155], v11 offset:39424
    ds_read_b64_tr_b16 v[156:157], v10 offset:38912
    ds_read_b64_tr_b16 v[158:159], v10 offset:39424
    s_cmp_gt_i32 s48, 27
    s_cbranch_scc0 NW_154
NWB_155:
    ds_read_b64_tr_b16 v[160:161], v11 offset:49152
    ds_read_b64_tr_b16 v[162:163], v11 offset:49664
    ds_read_b64_tr_b16 v[164:165], v10 offset:49152
    ds_read_b64_tr_b16 v[166:167], v10 offset:49664
    ds_read_b64_tr_b16 v[168:169], v11 offset:51200
    ds_read_b64_tr_b16 v[170:171], v11 offset:51712
    ds_read_b64_tr_b16 v[172:173], v10 offset:51200
    ds_read_b64_tr_b16 v[174:175], v10 offset:51712
    ds_read_b64_tr_b16 v[176:177], v11 offset:53248
    ds_read_b64_tr_b16 v[178:179], v11 offset:53760
    ds_read_b64_tr_b16 v[180:181], v10 offset:53248
    ds_read_b64_tr_b16 v[182:183], v10 offset:53760
    ds_read_b64_tr_b16 v[184:185], v11 offset:55296
    ds_read_b64_tr_b16 v[186:187], v11 offset:55808
    ds_read_b64_tr_b16 v[188:189], v10 offset:55296
    ds_read_b64_tr_b16 v[190:191], v10 offset:55808
    s_cmp_gt_i32 s48, 28
    s_cbranch_scc0 NW_156
NWB_157:
    v_xor_b32 v10, 0x10000, v10
    v_xor_b32 v11, 0x10000, v11
    ds_read_b64_tr_b16 v[192:193], v11 offset:0
    ds_read_b64_tr_b16 v[194:195], v11 offset:512
    ds_read_b64_tr_b16 v[196:197], v10 offset:0
    ds_read_b64_tr_b16 v[198:199], v10 offset:512
    ds_read_b64_tr_b16 v[200:201], v11 offset:2048
    ds_read_b64_tr_b16 v[202:203], v11 offset:2560
    ds_read_b64_tr_b16 v[204:205], v10 offset:2048
    ds_read_b64_tr_b16 v[206:207], v10 offset:2560
    ds_read_b64_tr_b16 v[208:209], v11 offset:4096
    ds_read_b64_tr_b16 v[210:211], v11 offset:4608
    ds_read_b64_tr_b16 v[212:213], v10 offset:4096
    ds_read_b64_tr_b16 v[214:215], v10 offset:4608
    ds_read_b64_tr_b16 v[216:217], v11 offset:6144
    ds_read_b64_tr_b16 v[218:219], v11 offset:6656
    ds_read_b64_tr_b16 v[220:221], v10 offset:6144
    ds_read_b64_tr_b16 v[222:223], v10 offset:6656
    s_cmp_gt_i32 s48, 29
    s_cbranch_scc0 NW_158
NWB_159:
    ds_read_b64_tr_b16 v[224:225], v11 offset:16384
    ds_read_b64_tr_b16 v[226:227], v11 offset:16896
    ds_read_b64_tr_b16 v[228:229], v10 offset:16384
    ds_read_b64_tr_b16 v[230:231], v10 offset:16896
    ds_read_b64_tr_b16 v[232:233], v11 offset:18432
    ds_read_b64_tr_b16 v[234:235], v11 offset:18944
    ds_read_b64_tr_b16 v[236:237], v10 offset:18432
    ds_read_b64_tr_b16 v[238:239], v10 offset:18944
    ds_read_b64_tr_b16 v[240:241], v11 offset:20480
    ds_read_b64_tr_b16 v[242:243], v11 offset:20992
    ds_read_b64_tr_b16 v[244:245], v10 offset:20480
    ds_read_b64_tr_b16 v[246:247], v10 offset:20992
    ds_read_b64_tr_b16 v[248:249], v11 offset:22528
    ds_read_b64_tr_b16 v[250:251], v11 offset:23040
    ds_read_b64_tr_b16 v[252:253], v10 offset:22528
    ds_read_b64_tr_b16 v[254:255], v10 offset:23040
    s_waitcnt lgkmcnt(0)
    v_add_u32 v6, 3, v6
    ds_write_b32 v5, v6
    s_mul_i32 s51, s77, 112
    s_lshl_b32 s52, s45, 2
    s_add_u32 s51, s51, s52
    s_add_u32 s51, s51, s69
    v_and_b32 v56, 0x70, v0
    v_min_u32 v56, 96, v56
    v_add_u32 v56, s51, v56
    s_add_u32 s54, s50, 5
    s_mul_i32 s71, s45, 114688
    s_mul_i32 s51, s77, 28672
    s_add_u32 s71, s71, s51
    s_add_u32 s71, s71, s66
    s_mov_b32 s55, 0
POLL_160:
    buffer_load_dword v57, v56, s[4:7], 0 offen sc1
POLLC_161:
    s_waitcnt vmcnt(0)
    v_cmp_le_u32 vcc, s54, v57
    s_nop 1
    s_cmp_eq_u64 vcc, -1
    s_cbranch_scc1 POLLD_162
    s_add_u32 s55, s55, 1
    s_cmp_lt_u32 s55, 400000
    s_cbranch_scc1 POLL_160
    s_branch ABORT
POLLD_162:
    buffer_load_dwordx4 v[64:67], v0, s[4:7], s71 offen offset:0 sc1
    buffer_load_dwordx4 v[68:71], v0, s[4:7], s71 offen offset:1024 sc1
    buffer_load_dwordx4 v[72:75], v0, s[4:7], s71 offen offset:2048 sc1
    buffer_load_dwordx4 v[76:79], v0, s[4:7], s71 offen offset:3072 sc1
    s_add_u32 s71, s71, 4096
    buffer_load_dwordx4 v[80:83], v0, s[4:7], s71 offen offset:0 sc1
    buffer_load_dwordx4 v[84:87], v0, s[4:7], s71 offen offset:1024 sc1
    buffer_load_dwordx4 v[88:91], v0, s[4:7], s71 offen offset:2048 sc1
    buffer_load_dwordx4 v[92:95], v0, s[4:7], s71 offen offset:3072 sc1
    s_add_u32 s71, s71, 4096
    buffer_load_dwordx4 v[96:99], v0, s[4:7], s71 offen offset:0 sc1
    buffer_load_dwordx4 v[100:103], v0, s[4:7], s71 offen offset:1024 sc1
    buffer_load_dwordx4 v[104:107], v0, s[4:7], s71 offen offset:2048 sc1
    buffer_load_dwordx4 v[108:111], v0, s[4:7], s71 offen offset:3072 sc1
    s_waitcnt vmcnt(0)
P6_START:
    ds_read_b64 v[8:9], v4 offset:32
    v_mov_b32 v12, v56
    v_lshlrev_b32 v32, 16, v16
    v_and_b32 v33, 0xffff0000, v16
    v_lshlrev_b32 v34, 16, v17
    v_and_b32 v35, 0xffff0000, v17
    v_lshlrev_b32 v36, 16, v18
    v_and_b32 v37, 0xffff0000, v18
    v_lshlrev_b32 v38, 16, v19
    v_and_b32 v39, 0xffff0000, v19
    v_lshlrev_b32 v40, 16, v20
    v_and_b32 v41, 0xffff0000, v20
    v_lshlrev_b32 v42, 16, v21
    v_and_b32 v43, 0xffff0000, v21
    v_lshlrev_b32 v44, 16, v22
    v_and_b32 v45, 0xffff0000, v22
    v_lshlrev_b32 v46, 16, v23
    v_and_b32 v47, 0xffff0000, v23
    v_lshlrev_b32 v48, 16, v24
    v_and_b32 v49, 0xffff0000, v24
    v_lshlrev_b32 v50, 16, v25
    v_and_b32 v51, 0xffff0000, v25
    v_lshlrev_b32 v52, 16, v26
    v_and_b32 v53, 0xffff0000, v26
    v_lshlrev_b32 v54, 16, v27
    v_and_b32 v55, 0xffff0000, v27
    v_lshlrev_b32 v56, 16, v28
    v_and_b32 v57, 0xffff0000, v28
    v_lshlrev_b32 v58, 16, v29
    v_and_b32 v59, 0xffff0000, v29
    v_lshlrev_b32 v60, 16, v30
    v_and_b32 v61, 0xffff0000, v30
    v_lshlrev_b32 v62, 16, v31
    v_and_b32 v63, 0xffff0000, v31
    v_pk_add_f32 v[32:33], v[32:33], v[48:49]
    v_pk_add_f32 v[34:35], v[34:35], v[50:51]
    v_pk_add_f32 v[36:37], v[36:37], v[52:53]
    v_pk_add_f32 v[38:39], v[38:39], v[54:55]
    v_pk_add_f32 v[40:41], v[40:41], v[56:57]
    v_pk_add_f32 v[42:43], v[42:43], v[58:59]
    v_pk_add_f32 v[44:45], v[44:45], v[60:61]
    v_pk_add_f32 v[46:47], v[46:47], v[62:63]
    s_add_u32 s73, s63, s85
    s_add_u32 s54, s50, 6
    s_waitcnt lgkmcnt(0)
    v_min_u32 v8, v8, v9
    s_nop 0
    v_readfirstlane_b32 s48, v8
    s_nop 1
    s_sub_i32 s48, s48, s49
    v_add_u32 v6, 1, v6
    ds_write_b32 v5, v6
    s_waitcnt vmcnt(15)
    v_mfma_f32_32x32x16_bf16 v[48:63], v[128:131], v[64:67], 0
    s_cmp_gt_i32 s48, 30
    s_cbranch_scc0 NW_163
NWB_164:
    ds_read_b64_tr_b16 v[128:129], v11 offset:32768
    ds_read_b64_tr_b16 v[130:131], v11 offset:33280
    v_mfma_f32_32x32x16_bf16 v[32:47], v[132:135], v[64:67], v[32:47]
    ds_read_b64_tr_b16 v[132:133], v10 offset:32768
    ds_read_b64_tr_b16 v[134:135], v10 offset:33280
    s_waitcnt vmcnt(14)
    v_mfma_f32_32x32x16_bf16 v[48:63], v[136:139], v[68:71], v[48:63]
    ds_read_b64_tr_b16 v[136:137], v11 offset:34816
    ds_read_b64_tr_b16 v[138:139], v11 offset:35328
    v_mfma_f32_32x32x16_bf16 v[32:47], v[140:143], v[68:71], v[32:47]
    ds_read_b64_tr_b16 v[140:141], v10 offset:34816
    ds_read_b64_tr_b16 v[142:143], v10 offset:35328
    s_waitcnt vmcnt(13)
    v_mfma_f32_32x32x16_bf16 v[48:63], v[144:147], v[72:75], v[48:63]
    ds_read_b64 v[8:9], v4 offset:32
    ds_read_b64_tr_b16 v[144:145], v11 offset:36864
    ds_read_b64_tr_b16 v[146:147], v11 offset:37376
    v_mfma_f32_32x32x16_bf16 v[32:47], v[148:151], v[72:75], v[32:47]
    ds_read_b64_tr_b16 v[148:149], v10 offset:36864
    ds_read_b64_tr_b16 v[150:151], v10 offset:37376
    s_waitcnt vmcnt(12)
    v_mfma_f32_32x32x16_bf16 v[48:63], v[152:155], v[76:79], v[48:63]
    ds_read_b64_tr_b16 v[152:153], v11 offset:38912
    ds_read_b64_tr_b16 v[154:155], v11 offset:39424
    v_mfma_f32_32x32x16_bf16 v[32:47], v[156:159], v[76:79], v[32:47]
    ds_read_b64_tr_b16 v[156:157], v10 offset:38912
    ds_read_b64_tr_b16 v[158:159], v10 offset:39424
    s_waitcnt vmcnt(11)
    v_mfma_f32_32x32x16_bf16 v[48:63], v[160:163], v[80:83], v[48:63]
    s_waitcnt lgkmcnt(8)
    v_min_u32 v8, v8, v9
    s_nop 0
    v_readfirstlane_b32 s48, v8
    s_nop 1
    s_sub_i32 s48, s48, s49
    s_cmp_gt_i32 s48, 31
    s_cbranch_scc0 NW_165
NWB_166:
    ds_read_b64_tr_b16 v[160:161], v11 offset:49152
    ds_read_b64_tr_b16 v[162:163], v11 offset:49664
    v_mfma_f32_32x32x16_bf16 v[32:47], v[164:167], v[80:83], v[32:47]
    ds_read_b64_tr_b16 v[164:165], v10 offset:49152
    ds_read_b64_tr_b16 v[166:167], v10 offset:49664
    s_add_u32 s71, s71, 4096
    buffer_load_dwordx4 v[112:115], v0, s[4:7], s71 offen offset:0 sc1
    s_waitcnt vmcnt(11)
    v_mfma_f32_32x32x16_bf16 v[48:63], v[168:171], v[84:87], v[48:63]
    ds_read_b64_tr_b16 v[168:169], v11 offset:51200
    ds_read_b64_tr_b16 v[170:171], v11 offset:51712
    v_mfma_f32_32x32x16_bf16 v[32:47], v[172:175], v[84:87], v[32:47]
    ds_read_b64_tr_b16 v[172:173], v10 offset:51200
    ds_read_b64_tr_b16 v[174:175], v10 offset:51712
    buffer_load_dwordx4 v[116:119], v0, s[4:7], s71 offen offset:1024 sc1
    s_waitcnt vmcnt(11)
    v_mfma_f32_32x32x16_bf16 v[48:63], v[176:179], v[88:91], v[48:63]
    ds_read_b64 v[8:9], v4 offset:32
    ds_read_b64_tr_b16 v[176:177], v11 offset:53248
    ds_read_b64_tr_b16 v[178:179], v11 offset:53760
    s_waitcnt vmcnt(2)
    s_add_u32 s51, s50, 6
    v_mov_b32 v24, s51
    v_mov_b32 v25, 0
    s_mov_b64 exec, 1
    s_cmp_eq_u32 s47, 3
    s_cbranch_scc0 STF_167
    buffer_store_dword v24, v25, s[4:7], s68 offen
STE_168:
    s_mov_b64 exec, -1
    v_mfma_f32_32x32x16_bf16 v[32:47], v[180:183], v[88:91], v[32:47]
    s_waitcnt lgkmcnt(11)
    v_add_u32 v6, 1, v6
    ds_write_b32 v5, v6
    ds_read_b64_tr_b16 v[180:181], v10 offset:53248
    ds_read_b64_tr_b16 v[182:183], v10 offset:53760
    buffer_load_dwordx4 v[120:123], v0, s[4:7], s71 offen offset:2048 sc1
    v_mfma_f32_32x32x16_bf16 v[48:63], v[184:187], v[92:95], v[48:63]
    ds_read_b64_tr_b16 v[184:185], v11 offset:55296
    ds_read_b64_tr_b16 v[186:187], v11 offset:55808
    v_mfma_f32_32x32x16_bf16 v[32:47], v[188:191], v[92:95], v[32:47]
    ds_read_b64_tr_b16 v[188:189], v10 offset:55296
    ds_read_b64_tr_b16 v[190:191], v10 offset:55808
    buffer_load_dwordx4 v[124:127], v0, s[4:7], s71 offen offset:3072 sc1
    v_mfma_f32_32x32x16_bf16 v[48:63], v[192:195], v[96:99], v[48:63]
    s_waitcnt lgkmcnt(9)
    v_min_u32 v8, v8, v9
    s_nop 0
    v_readfirstlane_b32 s48, v8
    s_nop 1
    s_sub_i32 s48, s48, s49
    s_cmp_gt_i32 s48, 32
    s_cbranch_scc0 NW_169
NWB_170:
    v_xor_b32 v10, 0x10000, v10
    v_xor_b32 v11, 0x10000, v11
    ds_read_b64_tr_b16 v[192:193], v11 offset:0
    ds_read_b64_tr_b16 v[194:195], v11 offset:512
    v_mfma_f32_32x32x16_bf16 v[32:47], v[196:199], v[96:99], v[32:47]
    ds_read_b64_tr_b16 v[196:197], v10 offset:0
    ds_read_b64_tr_b16 v[198:199], v10 offset:512
    s_add_u32 s71, s71, 4096
    buffer_load_dwordx4 v[64:67], v0, s[4:7], s71 offen offset:0 sc1
    v_mfma_f32_32x32x16_bf16 v[48:63], v[200:203], v[100:103], v[48:63]
    ds_read_b64_tr_b16 v[200:201], v11 offset:2048
    ds_read_b64_tr_b16 v[202:203], v11 offset:2560
    v_mfma_f32_32x32x16_bf16 v[32:47], v[204:207], v[100:103], v[32:47]
    ds_read_b64_tr_b16 v[204:205], v10 offset:2048
    ds_read_b64_tr_b16 v[206:207], v10 offset:2560
    buffer_load_dwordx4 v[68:71], v0, s[4:7], s71 offen offset:1024 sc1
    v_mfma_f32_32x32x16_bf16 v[48:63], v[208:211], v[104:107], v[48:63]
    ds_read_b64 v[8:9], v4 offset:32
    ds_read_b64_tr_b16 v[208:209], v11 offset:4096
    ds_read_b64_tr_b16 v[210:211], v11 offset:4608
    v_mfma_f32_32x32x16_bf16 v[32:47], v[212:215], v[104:107], v[32:47]
    s_waitcnt lgkmcnt(11)
    v_add_u32 v6, 1, v6
    ds_write_b32 v5, v6
    ds_read_b64_tr_b16 v[212:213], v10 offset:4096
    ds_read_b64_tr_b16 v[214:215], v10 offset:4608
    buffer_load_dwordx4 v[72:75], v0, s[4:7], s71 offen offset:2048 sc1
    v_mfma_f32_32x32x16_bf16 v[48:63], v[216:219], v[108:111], v[48:63]
    ds_read_b64_tr_b16 v[216:217], v11 offset:6144
    ds_read_b64_tr_b16 v[218:219], v11 offset:6656
    v_mfma_f32_32x32x16_bf16 v[32:47], v[220:223], v[108:111], v[32:47]
    ds_read_b64_tr_b16 v[220:221], v10 offset:6144
    ds_read_b64_tr_b16 v[222:223], v10 offset:6656
    buffer_load_dwordx4 v[76:79], v0, s[4:7], s71 offen offset:3072 sc1
    s_waitcnt vmcnt(8)
    v_mfma_f32_32x32x16_bf16 v[48:63], v[224:227], v[112:115], v[48:63]
    s_waitcnt lgkmcnt(9)
    v_min_u32 v8, v8, v9
    s_nop 0
    v_readfirstlane_b32 s48, v8
    s_nop 1
    s_sub_i32 s48, s48, s49
    s_cmp_gt_i32 s48, 33
    s_cbranch_scc0 NW_171
NWB_172:
    ds_read_b64_tr_b16 v[224:225], v11 offset:16384
    ds_read_b64_tr_b16 v[226:227], v11 offset:16896
    v_mfma_f32_32x32x16_bf16 v[32:47], v[228:231], v[112:115], v[32:47]
    ds_read_b64_tr_b16 v[228:229], v10 offset:16384
    ds_read_b64_tr_b16 v[230:231], v10 offset:16896
    s_add_u32 s71, s71, 4096
    buffer_load_dwordx4 v[80:83], v0, s[4:7], s71 offen offset:0 sc1
    s_waitcnt vmcnt(8)
    v_mfma_f32_32x32x16_bf16 v[48:63], v[232:235], v[116:119], v[48:63]
    ds_read_b64_tr_b16 v[232:233], v11 offset:18432
    ds_read_b64_tr_b16 v[234:235], v11 offset:18944
    v_mfma_f32_32x32x16_bf16 v[32:47], v[236:239], v[116:119], v[32:47]
    ds_read_b64_tr_b16 v[236:237], v10 offset:18432
    ds_read_b64_tr_b16 v[238:239], v10 offset:18944
    buffer_load_dwordx4 v[84:87], v0, s[4:7], s71 offen offset:1024 sc1
    s_waitcnt vmcnt(7)
    v_mfma_f32_32x32x16_bf16 v[48:63], v[240:243], v[120:123], v[48:63]
    ds_read_b64 v[8:9], v4 offset:32
    ds_read_b64_tr_b16 v[240:241], v11 offset:20480
    ds_read_b64_tr_b16 v[242:243], v11 offset:20992
    v_mfma_f32_32x32x16_bf16 v[32:47], v[244:247], v[120:123], v[32:47]
    ds_read_b64_tr_b16 v[244:245], v10 offset:20480
    ds_read_b64_tr_b16 v[246:247], v10 offset:20992
    buffer_load_dword v13, v12, s[4:7], 0 offen sc1
    buffer_load_dwordx4 v[88:91], v0, s[4:7], s71 offen offset:2048 sc1
    s_waitcnt vmcnt(8)
    v_mfma_f32_32x32x16_bf16 v[48:63], v[248:251], v[124:127], v[48:63]
    ds_read_b64_tr_b16 v[248:249], v11 offset:22528
    ds_read_b64_tr_b16 v[250:251], v11 offset:23040
    v_mfma_f32_32x32x16_bf16 v[32:47], v[252:255], v[124:127], v[32:47]
    ds_read_b64_tr_b16 v[252:253], v10 offset:22528
    ds_read_b64_tr_b16 v[254:255], v10 offset:23040
    buffer_load_dwordx4 v[92:95], v0, s[4:7], s71 offen offset:3072 sc1
    s_waitcnt vmcnt(8)
    v_mfma_f32_32x32x16_bf16 v[48:63], v[128:131], v[64:67], v[48:63]
    s_waitcnt lgkmcnt(8)
    v_min_u32 v8, v8, v9
    s_nop 0
    v_readfirstlane_b32 s48, v8
    s_nop 1
    s_sub_i32 s48, s48, s49
    s_cmp_gt_i32 s48, 34
    s_cbranch_scc0 NW_173
NWB_174:
    ds_read_b64_tr_b16 v[128:129], v11 offset:32768
    ds_read_b64_tr_b16 v[130:131], v11 offset:33280
    v_mfma_f32_32x32x16_bf16 v[32:47], v[132:135], v[64:67], v[32:47]
    ds_read_b64_tr_b16 v[132:133], v10 offset:32768
    ds_read_b64_tr_b16 v[134:135], v10 offset:33280
    s_add_u32 s71, s71, 4096
    buffer_load_dwordx4 v[96:99], v0, s[4:7], s71 offen offset:0 sc1
    s_waitcnt vmcnt(8)
    v_mfma_f32_32x32x16_bf16 v[48:63], v[136:139], v[68:71], v[48:63]
    ds_read_b64_tr_b16 v[136:137], v11 offset:34816
    ds_read_b64_tr_b16 v[138:139], v11 offset:35328
    v_mfma_f32_32x32x16_bf16 v[32:47], v[140:143], v[68:71], v[32:47]
    ds_read_b64_tr_b16 v[140:141], v10 offset:34816
    ds_read_b64_tr_b16 v[142:143], v10 offset:35328
    buffer_load_dwordx4 v[100:103], v0, s[4:7], s71 offen offset:1024 sc1
    s_waitcnt vmcnt(8)
    v_mfma_f32_32x32x16_bf16 v[48:63], v[144:147], v[72:75], v[48:63]
    ds_read_b64 v[8:9], v4 offset:32
    ds_read_b64_tr_b16 v[144:145], v11 offset:36864
    ds_read_b64_tr_b16 v[146:147], v11 offset:37376
    v_mfma_f32_32x32x16_bf16 v[32:47], v[148:151], v[72:75], v[32:47]
    ds_read_b64_tr_b16 v[148:149], v10 offset:36864
    ds_read_b64_tr_b16 v[150:151], v10 offset:37376
    buffer_load_dword v26, v12, s[4:7], 0 offen sc1
    buffer_load_dwordx4 v[104:107], v0, s[4:7], s71 offen offset:2048 sc1
    s_waitcnt vmcnt(9)
    v_mfma_f32_32x32x16_bf16 v[48:63], v[152:155], v[76:79], v[48:63]
    ds_read_b64_tr_b16 v[152:153], v11 offset:38912
    ds_read_b64_tr_b16 v[154:155], v11 offset:39424
    v_mfma_f32_32x32x16_bf16 v[32:47], v[156:159], v[76:79], v[32:47]
    ds_read_b64_tr_b16 v[156:157], v10 offset:38912
    ds_read_b64_tr_b16 v[158:159], v10 offset:39424
    buffer_load_dwordx4 v[108:111], v0, s[4:7], s71 offen offset:3072 sc1
    s_waitcnt vmcnt(9)
    v_mfma_f32_32x32x16_bf16 v[48:63], v[160:163], v[80:83], v[48:63]
    s_waitcnt lgkmcnt(15)
    v_add_u32 v6, 2, v6
    ds_write_b32 v5, v6
    s_waitcnt lgkmcnt(9)
    v_min_u32 v8, v8, v9
    s_nop 0
    v_readfirstlane_b32 s48, v8
    s_nop 1
    s_sub_i32 s48, s48, s49
    s_cmp_gt_i32 s48, 35
    s_cbranch_scc0 NW_175
NWB_176:
    ds_read_b64_tr_b16 v[160:161], v11 offset:49152
    ds_read_b64_tr_b16 v[162:163], v11 offset:49664
    v_mfma_f32_32x32x16_bf16 v[32:47], v[164:167], v[80:83], v[32:47]
    ds_read_b64_tr_b16 v[164:165], v10 offset:49152
    ds_read_b64_tr_b16 v[166:167], v10 offset:49664
    s_waitcnt vmcnt(7)
    v_cmp_le_u32 vcc, s54, v13
    s_nop 1
    s_cmp_eq_u64 vcc, -1
    s_cbranch_scc1 P6G_177
    s_waitcnt vmcnt(2)
    v_cmp_le_u32 vcc, s54, v26
    s_nop 1
    s_cmp_eq_u64 vcc, -1
    s_cbranch_scc1 P6G_177
    s_mov_b32 s55, 0
POLL_178:
    buffer_load_dword v13, v12, s[4:7], 0 offen sc1
POLLC_179:
    s_waitcnt vmcnt(0)
    v_cmp_le_u32 vcc, s54, v13
    s_nop 1
    s_cmp_eq_u64 vcc, -1
    s_cbranch_scc1 POLLD_180
    s_add_u32 s55, s55, 1
    s_cmp_lt_u32 s55, 400000
    s_cbranch_scc1 POLL_178
    s_branch ABORT
POLLD_180:
P6G_177:
    s_add_u32 s71, s71, 32768
    buffer_load_dwordx4 v[112:115], v0, s[4:7], s71 offen offset:0 sc1
    v_mfma_f32_32x32x16_bf16 v[48:63], v[168:171], v[84:87], v[48:63]
    ds_read_b64_tr_b16 v[168:169], v11 offset:51200
    ds_read_b64_tr_b16 v[170:171], v11 offset:51712
    v_mfma_f32_32x32x16_bf16 v[32:47], v[172:175], v[84:87], v[32:47]
    ds_read_b64_tr_b16 v[172:173], v10 offset:51200
    ds_read_b64_tr_b16 v[174:175], v10 offset:51712
    buffer_load_dwordx4 v[116:119], v0, s[4:7], s71 offen offset:1024 sc1
    s_waitcnt vmcnt(8)
    v_mfma_f32_32x32x16_bf16 v[48:63], v[176:179], v[88:91], v[48:63]
    ds_read_b64 v[8:9], v4 offset:32
    ds_read_b64_tr_b16 v[176:177], v11 offset:53248
    ds_read_b64_tr_b16 v[178:179], v11 offset:53760
    v_mfma_f32_32x32x16_bf16 v[32:47], v[180:183], v[88:91], v[32:47]
    s_waitcnt lgkmcnt(12)
    v_add_u32 v6, 1, v6
    ds_write_b32 v5, v6
    ds_read_b64_tr_b16 v[180:181], v10 offset:53248
    ds_read_b64_tr_b16 v[182:183], v10 offset:53760
    buffer_load_dwordx4 v[120:123], v0, s[4:7], s71 offen offset:2048 sc1
    s_waitcnt vmcnt(8)
    v_mfma_f32_32x32x16_bf16 v[48:63], v[184:187], v[92:95], v[48:63]
    ds_read_b64_tr_b16 v[184:185], v11 offset:55296
    ds_read_b64_tr_b16 v[186:187], v11 offset:55808
    v_mfma_f32_32x32x16_bf16 v[32:47], v[188:191], v[92:95], v[32:47]
    ds_read_b64_tr_b16 v[188:189], v10 offset:55296
    ds_read_b64_tr_b16 v[190:191], v10 offset:55808
    buffer_load_dwordx4 v[124:127], v0, s[4:7], s71 offen offset:3072 sc1
    s_waitcnt vmcnt(8)
    v_mfma_f32_32x32x16_bf16 v[48:63], v[192:195], v[96:99], v[48:63]
    s_waitcnt lgkmcnt(9)
    v_min_u32 v8, v8, v9
    s_nop 0
    v_readfirstlane_b32 s48, v8
    s_nop 1
    s_sub_i32 s48, s48, s49
    s_cmp_gt_i32 s48, 36
    s_cbranch_scc0 NW_181
NWB_182:
    v_xor_b32 v10, 0x10000, v10
    v_xor_b32 v11, 0x10000, v11
    ds_read_b64_tr_b16 v[192:193], v11 offset:0
    ds_read_b64_tr_b16 v[194:195], v11 offset:512
    v_mfma_f32_32x32x16_bf16 v[32:47], v[196:199], v[96:99], v[32:47]
    ds_read_b64_tr_b16 v[196:197], v10 offset:0
    ds_read_b64_tr_b16 v[198:199], v10 offset:512
    s_add_u32 s71, s71, 4096
    buffer_load_dwordx4 v[64:67], v0, s[4:7], s71 offen offset:0 sc1
    s_waitcnt vmcnt(8)
    v_mfma_f32_32x32x16_bf16 v[48:63], v[200:203], v[100:103], v[48:63]
    ds_read_b64_tr_b16 v[200:201], v11 offset:2048
    ds_read_b64_tr_b16 v[202:203], v11 offset:2560
    v_mfma_f32_32x32x16_bf16 v[32:47], v[204:207], v[100:103], v[32:47]
    ds_read_b64_tr_b16 v[204:205], v10 offset:2048
    ds_read_b64_tr_b16 v[206:207], v10 offset:2560
    buffer_load_dwordx4 v[68:71], v0, s[4:7], s71 offen offset:1024 sc1
    s_waitcnt vmcnt(7)
    v_mfma_f32_32x32x16_bf16 v[48:63], v[208:211], v[104:107], v[48:63]
    ds_read_b64 v[8:9], v4 offset:32
    ds_read_b64_tr_b16 v[208:209], v11 offset:4096
    ds_read_b64_tr_b16 v[210:211], v11 offset:4608
    v_mfma_f32_32x32x16_bf16 v[32:47], v[212:215], v[104:107], v[32:47]
    s_waitcnt lgkmcnt(11)
    v_add_u32 v6, 1, v6
    ds_write_b32 v5, v6
    ds_read_b64_tr_b16 v[212:213], v10 offset:4096
    ds_read_b64_tr_b16 v[214:215], v10 offset:4608
    buffer_load_dwordx4 v[72:75], v0, s[4:7], s71 offen offset:2048 sc1
    s_waitcnt vmcnt(7)
    v_mfma_f32_32x32x16_bf16 v[48:63], v[216:219], v[108:111], v[48:63]
    ds_read_b64_tr_b16 v[216:217], v11 offset:6144
    ds_read_b64_tr_b16 v[218:219], v11 offset:6656
    v_mfma_f32_32x32x16_bf16 v[32:47], v[220:223], v[108:111], v[32:47]
    ds_read_b64_tr_b16 v[220:221], v10 offset:6144
    ds_read_b64_tr_b16 v[222:223], v10 offset:6656
    buffer_load_dwordx4 v[76:79], v0, s[4:7], s71 offen offset:3072 sc1
    s_waitcnt vmcnt(7)
    v_mfma_f32_32x32x16_bf16 v[48:63], v[224:227], v[112:115], v[48:63]
    s_waitcnt lgkmcnt(9)
    v_min_u32 v8, v8, v9
    s_nop 0
    v_readfirstlane_b32 s48, v8
    s_nop 1
    s_sub_i32 s48, s48, s49
    s_cmp_gt_i32 s48, 37
    s_cbranch_scc0 NW_183
NWB_184:
    ds_read_b64_tr_b16 v[224:225], v11 offset:16384
    ds_read_b64_tr_b16 v[226:227], v11 offset:16896
    v_mfma_f32_32x32x16_bf16 v[32:47], v[228:231], v[112:115], v[32:47]
    ds_read_b64_tr_b16 v[228:229], v10 offset:16384
    ds_read_b64_tr_b16 v[230:231], v10 offset:16896
    s_add_u32 s71, s71, 4096
    buffer_load_dwordx4 v[80:83], v0, s[4:7], s71 offen offset:0 sc1
    s_waitcnt vmcnt(7)
    v_mfma_f32_32x32x16_bf16 v[48:63], v[232:235], v[116:119], v[48:63]
    ds_read_b64_tr_b16 v[232:233], v11 offset:18432
    ds_read_b64_tr_b16 v[234:235], v11 offset:18944
    v_mfma_f32_32x32x16_bf16 v[32:47], v[236:239], v[116:119], v[32:47]
    ds_read_b64_tr_b16 v[236:237], v10 offset:18432
    ds_read_b64_tr_b16 v[238:239], v10 offset:18944
    buffer_load_dwordx4 v[84:87], v0, s[4:7], s71 offen offset:1024 sc1
    s_waitcnt vmcnt(7)
    v_mfma_f32_32x32x16_bf16 v[48:63], v[240:243], v[120:123], v[48:63]
    ds_read_b64 v[8:9], v4 offset:32
    ds_read_b64_tr_b16 v[240:241], v11 offset:20480
    ds_read_b64_tr_b16 v[242:243], v11 offset:20992
    v_mfma_f32_32x32x16_bf16 v[32:47], v[244:247], v[120:123], v[32:47]
    s_waitcnt lgkmcnt(11)
    v_add_u32 v6, 1, v6
    ds_write_b32 v5, v6
    ds_read_b64_tr_b16 v[244:245], v10 offset:20480
    ds_read_b64_tr_b16 v[246:247], v10 offset:20992
    buffer_load_dwordx4 v[88:91], v0, s[4:7], s71 offen offset:2048 sc1
    s_waitcnt vmcnt(7)
    v_mfma_f32_32x32x16_bf16 v[48:63], v[248:251], v[124:127], v[48:63]
    ds_read_b64_tr_b16 v[248:249], v11 offset:22528
    ds_read_b64_tr_b16 v[250:251], v11 offset:23040
    v_mfma_f32_32x32x16_bf16 v[32:47], v[252:255], v[124:127], v[32:47]
    ds_read_b64_tr_b16 v[252:253], v10 offset:22528
    ds_read_b64_tr_b16 v[254:255], v10 offset:23040
    buffer_load_dwordx4 v[92:95], v0, s[4:7], s71 offen offset:3072 sc1
    s_waitcnt vmcnt(7)
    v_mfma_f32_32x32x16_bf16 v[48:63], v[128:131], v[64:67], v[48:63]
    s_waitcnt lgkmcnt(9)
    v_min_u32 v8, v8, v9
    s_nop 0
    v_readfirstlane_b32 s48, v8
    s_nop 1
    s_sub_i32 s48, s48, s49
    s_cmp_gt_i32 s48, 38
    s_cbranch_scc0 NW_185
NWB_186:
    ds_read_b64_tr_b16 v[128:129], v11 offset:32768
    ds_read_b64_tr_b16 v[130:131], v11 offset:33280
    v_mfma_f32_32x32x16_bf16 v[32:47], v[132:135], v[64:67], v[32:47]
    ds_read_b64_tr_b16 v[132:133], v10 offset:32768
    ds_read_b64_tr_b16 v[134:135], v10 offset:33280
    s_add_u32 s71, s71, 4096
    buffer_load_dwordx4 v[96:99], v0, s[4:7], s71 offen offset:0 sc1
    s_waitcnt vmcnt(7)
    v_mfma_f32_32x32x16_bf16 v[48:63], v[136:139], v[68:71], v[48:63]
    ds_read_b64_tr_b16 v[136:137], v11 offset:34816
    ds_read_b64_tr_b16 v[138:139], v11 offset:35328
    v_mfma_f32_32x32x16_bf16 v[32:47], v[140:143], v[68:71], v[32:47]
    ds_read_b64_tr_b16 v[140:141], v10 offset:34816
    ds_read_b64_tr_b16 v[142:143], v10 offset:35328
    buffer_load_dwordx4 v[100:103], v0, s[4:7], s71 offen offset:1024 sc1
    s_waitcnt vmcnt(7)
    v_mfma_f32_32x32x16_bf16 v[48:63], v[144:147], v[72:75], v[48:63]
    ds_read_b64 v[8:9], v4 offset:32
    ds_read_b64_tr_b16 v[144:145], v11 offset:36864
    ds_read_b64_tr_b16 v[146:147], v11 offset:37376
    v_mfma_f32_32x32x16_bf16 v[32:47], v[148:151], v[72:75], v[32:47]
    s_waitcnt lgkmcnt(11)
    v_add_u32 v6, 1, v6
    ds_write_b32 v5, v6
    ds_read_b64_tr_b16 v[148:149], v10 offset:36864
    ds_read_b64_tr_b16 v[150:151], v10 offset:37376
    buffer_load_dwordx4 v[104:107], v0, s[4:7], s71 offen offset:2048 sc1
    s_waitcnt vmcnt(7)
    v_mfma_f32_32x32x16_bf16 v[48:63], v[152:155], v[76:79], v[48:63]
    ds_read_b64_tr_b16 v[152:153], v11 offset:38912
    ds_read_b64_tr_b16 v[154:155], v11 offset:39424
    v_mfma_f32_32x32x16_bf16 v[32:47], v[156:159], v[76:79], v[32:47]
    ds_read_b64_tr_b16 v[156:157], v10 offset:38912
    ds_read_b64_tr_b16 v[158:159], v10 offset:39424
    buffer_load_dwordx4 v[108:111], v0, s[4:7], s71 offen offset:3072 sc1
    s_waitcnt vmcnt(7)
    v_mfma_f32_32x32x16_bf16 v[48:63], v[160:163], v[80:83], v[48:63]
    s_waitcnt lgkmcnt(9)
    v_min_u32 v8, v8, v9
    s_nop 0
    v_readfirstlane_b32 s48, v8
    s_nop 1
    s_sub_i32 s48, s48, s49
    s_cmp_gt_i32 s48, 39
    s_cbranch_scc0 NW_187
NWB_188:
    ds_read_b64_tr_b16 v[160:161], v11 offset:49152
    ds_read_b64_tr_b16 v[162:163], v11 offset:49664
    v_mfma_f32_32x32x16_bf16 v[32:47], v[164:167], v[80:83], v[32:47]
    ds_read_b64_tr_b16 v[164:165], v10 offset:49152
    ds_read_b64_tr_b16 v[166:167], v10 offset:49664
    s_add_u32 s71, s71, 4096
    buffer_load_dwordx4 v[112:115], v0, s[4:7], s71 offen offset:0 sc1
    s_waitcnt vmcnt(7)
    v_mfma_f32_32x32x16_bf16 v[48:63], v[168:171], v[84:87], v[48:63]
    ds_read_b64_tr_b16 v[168:169], v11 offset:51200
    ds_read_b64_tr_b16 v[170:171], v11 offset:51712
    v_mfma_f32_32x32x16_bf16 v[32:47], v[172:175], v[84:87], v[32:47]
    ds_read_b64_tr_b16 v[172:173], v10 offset:51200
    ds_read_b64_tr_b16 v[174:175], v10 offset:51712
    buffer_load_dwordx4 v[116:119], v0, s[4:7], s71 offen offset:1024 sc1
    s_waitcnt vmcnt(7)
    v_mfma_f32_32x32x16_bf16 v[48:63], v[176:179], v[88:91], v[48:63]
    ds_read_b64_tr_b16 v[176:177], v11 offset:53248
    ds_read_b64_tr_b16 v[178:179], v11 offset:53760
    v_mfma_f32_32x32x16_bf16 v[32:47], v[180:183], v[88:91], v[32:47]
    ds_read_b64_tr_b16 v[180:181], v10 offset:53248
    ds_read_b64_tr_b16 v[182:183], v10 offset:53760
    buffer_load_dwordx4 v[120:123], v0, s[4:7], s71 offen offset:2048 sc1
    s_waitcnt vmcnt(7)
    v_mfma_f32_32x32x16_bf16 v[48:63], v[184:187], v[92:95], v[48:63]
    ds_read_b64_tr_b16 v[184:185], v11 offset:55296
    ds_read_b64_tr_b16 v[186:187], v11 offset:55808
    v_mfma_f32_32x32x16_bf16 v[32:47], v[188:191], v[92:95], v[32:47]
    ds_read_b64_tr_b16 v[188:189], v10 offset:55296
    ds_read_b64_tr_b16 v[190:191], v10 offset:55808
    buffer_load_dwordx4 v[124:127], v0, s[4:7], s71 offen offset:3072 sc1
    s_waitcnt vmcnt(7)
    v_mfma_f32_32x32x16_bf16 v[48:63], v[192:195], v[96:99], v[48:63]
    v_mfma_f32_32x32x16_bf16 v[32:47], v[196:199], v[96:99], v[32:47]
    s_add_u32 s71, s71, 4096
    buffer_load_dwordx4 v[64:67], v0, s[4:7], s71 offen offset:0 sc1
    s_waitcnt vmcnt(7)
    v_mfma_f32_32x32x16_bf16 v[48:63], v[200:203], v[100:103], v[48:63]
    v_mfma_f32_32x32x16_bf16 v[32:47], v[204:207], v[100:103], v[32:47]
    buffer_load_dwordx4 v[68:71], v0, s[4:7], s71 offen offset:1024 sc1
    s_waitcnt vmcnt(7)
    v_mfma_f32_32x32x16_bf16 v[48:63], v[208:211], v[104:107], v[48:63]
    v_xor_b32 v29, 8, v5
    ds_read_b32 v28, v29 offset:64
    v_mfma_f32_32x32x16_bf16 v[32:47], v[212:215], v[104:107], v[32:47]
    buffer_load_dwordx4 v[72:75], v0, s[4:7], s71 offen offset:2048 sc1
    s_waitcnt vmcnt(7)
    v_mfma_f32_32x32x16_bf16 v[48:63], v[216:219], v[108:111], v[48:63]
    v_mfma_f32_32x32x16_bf16 v[32:47], v[220:223], v[108:111], v[32:47]
    buffer_load_dwordx4 v[76:79], v0, s[4:7], s71 offen offset:3072 sc1
    s_waitcnt vmcnt(7)
    v_mfma_f32_32x32x16_bf16 v[48:63], v[224:227], v[112:115], v[48:63]
    v_mfma_f32_32x32x16_bf16 v[32:47], v[228:231], v[112:115], v[32:47]
    s_add_u32 s71, s71, 4096
    buffer_load_dwordx4 v[80:83], v0, s[4:7], s71 offen offset:0 sc1
    s_waitcnt vmcnt(7)
    v_mfma_f32_32x32x16_bf16 v[48:63], v[232:235], v[116:119], v[48:63]
    s_waitcnt lgkmcnt(0)
    v_readfirstlane_b32 s52, v28
    s_nop 1
    s_cmp_ge_u32 s52, s84
    s_cbranch_scc1 CK_189
    s_mov_b32 s55, 0
LW_190:
    ds_read_b32 v28, v29 offset:64
    s_waitcnt lgkmcnt(0)
    v_readfirstlane_b32 s52, v28
    s_nop 1
    s_cmp_ge_u32 s52, s84
    s_cbranch_scc1 LWD_191
    s_add_u32 s55, s55, 1
    s_cmp_lt_u32 s55, 4000000
    s_cbranch_scc1 LW_190
    s_branch ABORT
LWD_191:
CK_189:
    v_mfma_f32_32x32x16_bf16 v[32:47], v[236:239], v[116:119], v[32:47]
    buffer_load_dwordx4 v[84:87], v0, s[4:7], s71 offen offset:1024 sc1
    s_waitcnt vmcnt(7)
    v_mfma_f32_32x32x16_bf16 v[48:63], v[240:243], v[120:123], v[48:63]
    v_mfma_f32_32x32x16_bf16 v[32:47], v[244:247], v[120:123], v[32:47]
    buffer_load_dwordx4 v[88:91], v0, s[4:7], s71 offen offset:2048 sc1
    s_waitcnt vmcnt(7)
    v_mfma_f32_32x32x16_bf16 v[48:63], v[248:251], v[124:127], v[48:63]
    v_mfma_f32_32x32x16_bf16 v[32:47], v[252:255], v[124:127], v[32:47]
    buffer_load_dwordx4 v[92:95], v0, s[4:7], s71 offen offset:3072 sc1
    s_waitcnt vmcnt(7)
    v_mfma_f32_32x32x16_bf16 v[48:63], v[128:131], v[64:67], v[48:63]
    v_mfma_f32_32x32x16_bf16 v[32:47], v[132:135], v[64:67], v[32:47]
    s_waitcnt vmcnt(6)
    v_mfma_f32_32x32x16_bf16 v[48:63], v[136:139], v[68:71], v[48:63]
    s_lshl_b32 s51, s42, 12
    v_mfma_f32_32x32x16_bf16 v[32:47], v[140:143], v[68:71], v[32:47]
    s_add_u32 s51, s51, 131072
    s_waitcnt vmcnt(5)
    v_mfma_f32_32x32x16_bf16 v[48:63], v[144:147], v[72:75], v[48:63]
    v_add_u32 v112, s51, v0
    v_mov_b32 v120, 0
    v_mfma_f32_32x32x16_bf16 v[32:47], v[148:151], v[72:75], v[32:47]
    v_xor_b32 v113, 0x2000, v112
    v_mov_b32 v121, 0
    s_waitcnt vmcnt(4)
    v_mfma_f32_32x32x16_bf16 v[48:63], v[152:155], v[76:79], v[48:63]
    v_xor_b32 v114, 8, v5
    v_and_b32 v122, 0x1f0, v0
    v_mfma_f32_32x32x16_bf16 v[32:47], v[156:159], v[76:79], v[32:47]
    s_add_u32 s70, s70, 1
    v_lshrrev_b32 v123, 9, v0
    s_waitcnt vmcnt(3)
    v_mfma_f32_32x32x16_bf16 v[48:63], v[160:163], v[80:83], v[48:63]
    v_mov_b32 v115, s70
    v_lshl_or_b32 v122, v123, 2, v122
    v_mfma_f32_32x32x16_bf16 v[32:47], v[164:167], v[80:83], v[32:47]
    s_add_u32 s72, s74, 32768
    s_waitcnt vmcnt(2)
    v_mfma_f32_32x32x16_bf16 v[48:63], v[168:171], v[84:87], v[48:63]
    v_mfma_f32_32x32x16_bf16 v[32:47], v[172:175], v[84:87], v[32:47]
    s_waitcnt vmcnt(1)
    v_mfma_f32_32x32x16_bf16 v[48:63], v[176:179], v[88:91], v[48:63]
    v_mfma_f32_32x32x16_bf16 v[32:47], v[180:183], v[88:91], v[32:47]
    s_waitcnt vmcnt(0)
    v_mfma_f32_32x32x16_bf16 v[48:63], v[184:187], v[92:95], v[48:63]
    v_mfma_f32_32x32x16_bf16 v[32:47], v[188:191], v[92:95], v[32:47]
    s_nop 10
    ds_write_b128 v112, v[48:51] offset:0
    ds_write_b128 v112, v[52:55] offset:1024
    ds_write_b128 v112, v[56:59] offset:2048
    ds_write_b128 v112, v[60:63] offset:3072
    ds_write_b32 v5, v115 offset:32
    s_mov_b32 s55, 0
XC_192:
    ds_read_b32 v116, v114 offset:32
    ds_read_b128 v[96:99], v113 offset:0
    ds_read_b128 v[100:103], v113 offset:1024
    ds_read_b128 v[104:107], v113 offset:2048
    ds_read_b128 v[108:111], v113 offset:3072
    s_waitcnt lgkmcnt(4)
    v_readfirstlane_b32 s52, v116
    s_nop 1
    s_cmp_ge_u32 s52, s70
    s_cbranch_scc1 XCD_193
    s_add_u32 s55, s55, 1
    s_cmp_lt_u32 s55, 4000000
    s_cbranch_scc1 XC_192
    s_branch ABORT
XCD_193:
    s_waitcnt lgkmcnt(3)
    v_pk_add_f32 v[32:33], v[32:33], v[96:97]
    v_pk_add_f32 v[34:35], v[34:35], v[98:99]
    s_waitcnt lgkmcnt(2)
    v_pk_add_f32 v[36:37], v[36:37], v[100:101]
    v_pk_add_f32 v[38:39], v[38:39], v[102:103]
    s_waitcnt lgkmcnt(1)
    v_pk_add_f32 v[40:41], v[40:41], v[104:105]
    v_pk_add_f32 v[42:43], v[42:43], v[106:107]
    s_waitcnt lgkmcnt(0)
    v_pk_add_f32 v[44:45], v[44:45], v[108:109]
    v_pk_add_f32 v[46:47], v[46:47], v[110:111]
    ds_write_b32 v5, v115 offset:64
    s_mov_b32 s84, s70
    v_cvt_pk_bf16_f32 v16, v32, v33
    v_cvt_pk_bf16_f32 v17, v34, v35
    v_cvt_pk_bf16_f32 v18, v36, v37
    v_cvt_pk_bf16_f32 v19, v38, v39
    v_cvt_pk_bf16_f32 v20, v40, v41
    v_cvt_pk_bf16_f32 v21, v42, v43
    v_cvt_pk_bf16_f32 v22, v44, v45
    v_cvt_pk_bf16_f32 v23, v46, v47
    s_cmp_eq_u32 s46, 1
    s_cbranch_scc1 FINAL
    s_cmp_eq_u32 s47, 3
    s_cbranch_scc0 STF_194
    buffer_store_dwordx4 v[16:19], v0, s[4:7], s73 offen
    buffer_store_dwordx4 v[20:23], v0, s[4:7], s73 offen offset:1024
STE_195:
    v_dot2c_f32_bf16 v120, s75, v16
    v_dot2c_f32_bf16 v121, v16, v16
    v_dot2c_f32_bf16 v120, s75, v17
    v_dot2c_f32_bf16 v121, v17, v17
    v_dot2c_f32_bf16 v120, s75, v18
    v_dot2c_f32_bf16 v121, v18, v18
    v_dot2c_f32_bf16 v120, s75, v19
    v_dot2c_f32_bf16 v121, v19, v19
    v_dot2c_f32_bf16 v120, s75, v20
    v_dot2c_f32_bf16 v121, v20, v20
    v_dot2c_f32_bf16 v120, s75, v21
    v_dot2c_f32_bf16 v121, v21, v21
    v_dot2c_f32_bf16 v120, s75, v22
    v_dot2c_f32_bf16 v121, v22, v22
    v_dot2c_f32_bf16 v120, s75, v23
    v_dot2c_f32_bf16 v121, v23, v23
    s_nop 2
    v_permlane32_swap_b32 v120, v121
    v_add_f32 v120, v120, v121
    s_cmp_eq_u32 s47, 3
    s_cbranch_scc0 STF_196
    buffer_store_dword v120, v122, s[4:7], s72 offen
STE_197:
    s_lshl_b32 s51, s77, 7
    s_lshl_b32 s52, s76, 2
    s_add_u32 s51, s51, s52
    s_add_u32 s51, s51, s69
    v_and_b32 v112, 0x70, v0
    v_bfe_u32 v113, v0, 7, 1
    v_lshl_or_b32 v112, v113, 3, v112
    v_add_u32 v112, s51, v112
    s_lshl_b32 s71, s42, 15
    s_add_u32 s71, s71, s63
    s_mov_b32 s64, s63
    s_add_u32 s63, s63, 196608
    s_mov_b32 s54, 7
    s_mov_b32 s49, 40
    s_sub_i32 s48, s48, 40
    s_add_u32 s65, s65, 196608
    s_add_u32 s82, s82, 524288
    s_add_u32 s83, s83, 65536
    v_xor_b32 v10, 64, v3
    ds_read_b64 v[8:9], v4 offset:32
    s_waitcnt lgkmcnt(0)
    v_min_u32 v8, v8, v9
    s_nop 0
    v_readfirstlane_b32 s48, v8
    s_nop 1
    s_sub_i32 s48, s48, s49
    s_add_u32 s51, s50, 7
    v_mov_b32 v8, s51
    v_mov_b32 v9, 0
    s_mov_b64 exec, 1
    s_cmp_eq_u32 s47, 3
    s_waitcnt vmcnt(0)
    s_cbranch_scc0 STF_198
    buffer_store_dword v8, v9, s[4:7], s68 offen
STE_199:
    s_mov_b64 exec, -1
    s_mov_b32 s46, 1
    s_mov_b32 s50, 8
    s_branch P1_L1
FINAL:
    v_bfe_u32 v64, v0, 4, 5
    v_lshlrev_b32 v64, 10, v64
    v_lshrrev_b32 v65, 9, v0
    v_lshl_or_b32 v64, v65, 4, v64
    buffer_store_dwordx4 v[16:19], v64, s[8:11], s88 offen offset:0
    buffer_store_dwordx4 v[20:23], v64, s[8:11], s88 offen offset:32
ABORT:
DONE:
    s_endpgm
W_WAIT:
    s_mov_b32 s55, 0
W_WAIT_L:
    ds_read_b64 v[8:9], v4 offset:32
    s_waitcnt lgkmcnt(0)
    v_min_u32 v8, v8, v9
    s_nop 0
    v_readfirstlane_b32 s48, v8
    s_nop 1
    s_sub_i32 s48, s48, s49
    s_cmp_gt_i32 s48, s96
    s_cbranch_scc1 W_WAIT_D
    s_sleep 1
    s_add_u32 s55, s55, 1
    s_cmp_lt_u32 s55, 4000000
    s_cbranch_scc1 W_WAIT_L
    s_endpgm
W_WAIT_D:
    s_setpc_b64 s[56:57]
NW_1:
    s_mov_b32 s96, 0
    s_call_b64 s[56:57], W_WAIT
    s_branch NWB_2
NW_3:
    s_mov_b32 s96, 1
    s_call_b64 s[56:57], W_WAIT
    s_branch NWB_4
NW_5:
    s_mov_b32 s96, 2
    s_call_b64 s[56:57], W_WAIT
    s_branch NWB_6
NW_7:
    s_mov_b32 s96, 3
    s_call_b64 s[56:57], W_WAIT
    s_branch NWB_8
NW_17:
    s_mov_b32 s96, 0
    s_call_b64 s[56:57], W_WAIT
    s_branch NWB_18
NW_19:
    s_mov_b32 s96, 1
    s_call_b64 s[56:57], W_WAIT
    s_branch NWB_20
NW_21:
    s_mov_b32 s96, 2
    s_call_b64 s[56:57], W_WAIT
    s_branch NWB_22
NW_23:
    s_mov_b32 s96, 3
    s_call_b64 s[56:57], W_WAIT
    s_branch NWB_24
NW_30:
    s_mov_b32 s96, 4
    s_call_b64 s[56:57], W_WAIT
    s_branch NWB_31
NW_32:
    s_mov_b32 s96, 5
    s_call_b64 s[56:57], W_WAIT
    s_branch NWB_33
NW_37:
    s_mov_b32 s96, 6
    s_call_b64 s[56:57], W_WAIT
    s_branch NWB_38
NW_39:
    s_mov_b32 s96, 7
    s_call_b64 s[56:57], W_WAIT
    s_branch NWB_40
NW_47:
    s_mov_b32 s96, 8
    s_call_b64 s[56:57], W_WAIT
    s_branch NWB_48
NW_49:
    s_mov_b32 s96, 9
    s_call_b64 s[56:57], W_WAIT
    s_branch NWB_50
NW_62:
    s_mov_b32 s96, 10
    s_call_b64 s[56:57], W_WAIT
    s_branch NWB_63
NW_64:
    s_mov_b32 s96, 11
    s_call_b64 s[56:57], W_WAIT
    s_branch NWB_65
NW_71:
    s_mov_b32 s96, 12
    s_call_b64 s[56:57], W_WAIT
    s_branch NWB_72
NW_73:
    s_mov_b32 s96, 13
    s_call_b64 s[56:57], W_WAIT
    s_branch NWB_74
NW_87:
    s_mov_b32 s96, 17
    s_call_b64 s[56:57], W_WAIT
    s_branch NWB_88
NW_89:
    s_mov_b32 s96, 17
    s_call_b64 s[56:57], W_WAIT
    s_branch NWB_90
NW_96:
    s_mov_b32 s96, 17
    s_call_b64 s[56:57], W_WAIT
    s_branch NWB_97
NW_98:
    s_mov_b32 s96, 17
    s_call_b64 s[56:57], W_WAIT
    s_branch NWB_99
NW_115:
    s_mov_b32 s96, 18
    s_call_b64 s[56:57], W_WAIT
    s_branch NWB_116
NW_117:
    s_mov_b32 s96, 19
    s_call_b64 s[56:57], W_WAIT
    s_branch NWB_118
NW_119:
    s_mov_b32 s96, 20
    s_call_b64 s[56:57], W_WAIT
    s_branch NWB_120
NW_121:
    s_mov_b32 s96, 21
    s_call_b64 s[56:57], W_WAIT
    s_branch NWB_122
NW_126:
    s_mov_b32 s96, 22
    s_call_b64 s[56:57], W_WAIT
    s_branch NWB_127
NW_128:
    s_mov_b32 s96, 23
    s_call_b64 s[56:57], W_WAIT
    s_branch NWB_129
NW_132:
    s_mov_b32 s96, 24
    s_call_b64 s[56:57], W_WAIT
    s_branch NWB_133
NW_134:
    s_mov_b32 s96, 25
    s_call_b64 s[56:57], W_WAIT
    s_branch NWB_135
NW_142:
    s_mov_b32 s96, 26
    s_call_b64 s[56:57], W_WAIT
    s_branch NWB_143
NW_144:
    s_mov_b32 s96, 27
    s_call_b64 s[56:57], W_WAIT
    s_branch NWB_145
NW_146:
    s_mov_b32 s96, 28
    s_call_b64 s[56:57], W_WAIT
    s_branch NWB_147
NW_148:
    s_mov_b32 s96, 29
    s_call_b64 s[56:57], W_WAIT
    s_branch NWB_149
NW_152:
    s_mov_b32 s96, 26
    s_call_b64 s[56:57], W_WAIT
    s_branch NWB_153
NW_154:
    s_mov_b32 s96, 27
    s_call_b64 s[56:57], W_WAIT
    s_branch NWB_155
NW_156:
    s_mov_b32 s96, 28
    s_call_b64 s[56:57], W_WAIT
    s_branch NWB_157
NW_158:
    s_mov_b32 s96, 29
    s_call_b64 s[56:57], W_WAIT
    s_branch NWB_159
NW_163:
    s_mov_b32 s96, 30
    s_call_b64 s[56:57], W_WAIT
    s_branch NWB_164
NW_165:
    s_mov_b32 s96, 31
    s_call_b64 s[56:57], W_WAIT
    s_branch NWB_166
NW_169:
    s_mov_b32 s96, 32
    s_call_b64 s[56:57], W_WAIT
    s_branch NWB_170
NW_171:
    s_mov_b32 s96, 33
    s_call_b64 s[56:57], W_WAIT
    s_branch NWB_172
NW_173:
    s_mov_b32 s96, 34
    s_call_b64 s[56:57], W_WAIT
    s_branch NWB_174
NW_175:
    s_mov_b32 s96, 35
    s_call_b64 s[56:57], W_WAIT
    s_branch NWB_176
NW_181:
    s_mov_b32 s96, 36
    s_call_b64 s[56:57], W_WAIT
    s_branch NWB_182
NW_183:
    s_mov_b32 s96, 37
    s_call_b64 s[56:57], W_WAIT
    s_branch NWB_184
NW_185:
    s_mov_b32 s96, 38
    s_call_b64 s[56:57], W_WAIT
    s_branch NWB_186
NW_187:
    s_mov_b32 s96, 39
    s_call_b64 s[56:57], W_WAIT
    s_branch NWB_188
GRETRY:
    s_add_u32 s54, s54, 1
    s_cmp_lt_u32 s54, 400000
    s_cbranch_scc0 ABORT
    s_cmp_le_u32 s54, 3
    s_cbranch_scc1 GATHER
    buffer_load_dwordx4 v[48:51], v0, s[4:7], s83 offen sc1
    s_waitcnt vmcnt(0)
    v_cmp_eq_u32 vcc, -1, v48
    s_nop 1
    s_cmp_eq_u64 vcc, 0
    s_cbranch_scc0 GRETRY
    s_branch GATHER
P4_PR:
    buffer_load_dwordx4 v[24:27], v28, s[4:7], s53 offen sc1
    s_waitcnt vmcnt(0)
    s_add_u32 s55, s55, 1
    s_cmp_lt_u32 s55, 400000
    s_cbranch_scc1 P4_PC
    s_branch ABORT
STF_45:
    buffer_store_dwordx4 v[80:83], v0, s[4:7], s71 offen sc1
    buffer_store_dwordx4 v[84:87], v0, s[4:7], s71 offen offset:1024 sc1
    s_branch STE_46
STF_51:
    buffer_store_dword v8, v9, s[4:7], s68 offen sc1
    s_branch STE_52
STF_58:
    buffer_store_dwordx4 v[16:19], v0, s[4:7], s73 offen sc1
    buffer_store_dwordx4 v[20:23], v0, s[4:7], s73 offen offset:1024 sc1
    s_branch STE_59
STF_60:
    buffer_store_dword v104, v106, s[4:7], s72 offen sc1
    s_branch STE_61
STF_66:
    buffer_store_dword v8, v9, s[4:7], s68 offen sc1
    s_branch STE_67
STF_85:
    buffer_store_dwordx4 v[32:35], v88, s[4:7], s73 offen sc1
    buffer_store_dwordx4 v[40:43], v88, s[4:7], s73 offen offset:1024 sc1
    s_branch STE_86
STF_91:
    buffer_store_dword v8, v9, s[4:7], s68 offen sc1
    s_branch STE_92
STF_106:
    buffer_store_dwordx4 v[24:27], v0, s[4:7], s73 offen sc1
    buffer_store_dwordx4 v[28:31], v0, s[4:7], s73 offen offset:1024 sc1
    s_branch STE_107
STF_108:
    buffer_store_dword v104, v106, s[4:7], s72 offen sc1
    s_branch STE_109
STF_110:
    buffer_store_dword v8, v9, s[4:7], s68 offen sc1
    s_branch STE_111
STF_130:
    buffer_store_dword v58, v59, s[4:7], s68 offen sc1
    s_branch STE_131
STF_150:
    buffer_store_dword v8, v9, s[4:7], s68 offen sc1
    s_branch STE_151
STF_167:
    buffer_store_dword v24, v25, s[4:7], s68 offen sc1
    s_branch STE_168
STF_194:
    buffer_store_dwordx4 v[16:19], v0, s[4:7], s73 offen sc1
    buffer_store_dwordx4 v[20:23], v0, s[4:7], s73 offen offset:1024 sc1
    s_branch STE_195
STF_196:
    buffer_store_dword v120, v122, s[4:7], s72 offen sc1
    s_branch STE_197
STF_198:
    buffer_store_dword v8, v9, s[4:7], s68 offen sc1
    s_branch STE_199
HELPERS:
    s_and_b32 s95, s42, 1
    s_bfe_u32 s76, s42, 0x10001
    v_bfe_u32 v22, v8, 1, 2
    v_and_b32 v23, 2, v16
    v_xor_b32 v22, v22, v23
    v_lshrrev_b32 v23, 1, v22
    v_and_b32 v22, 1, v22
    v_lshlrev_b32 v22, 5, v22
    v_and_b32 v24, 1, v8
    v_lshl_or_b32 v22, v24, 4, v22
    v_mul_u32_u24 v25, 3072, v16
    v_add_u32 v25, v25, v22
    v_lshl_add_u32 v20, v23, 10, v25
    v_xor_b32 v21, 32, v20
    v_mul_u32_u24 v26, 393216, v23
    v_add_u32 v26, v26, v25
    v_xor_b32 v27, 32, v26
    s_mul_i32 s51, s95, 196608
    s_lshl_b32 s72, s41, 6
    s_add_u32 s72, s72, s51
    s_mul_i32 s51, s76, 393216
    s_add_u32 s72, s72, s51
    s_add_u32 s72, s72, s51
    s_mul_i32 s71, s42, 98304
    s_lshl_b32 s51, s41, 6
    s_add_u32 s71, s71, s51
    s_add_u32 s71, s71, 4294575104
    s_mov_b32 s14, 1572864
    s_mov_b32 s15, 0x20000
    s_waitcnt lgkmcnt(0)
    s_mov_b32 s12, s18
    s_and_b32 s13, s19, 0xffff
    s_barrier
    s_lshl_b32 s52, s2, 2
    s_add_u32 s52, s52, s42
    s_mul_i32 s52, s52, 1536
    s_sub_u32 s52, s52, 6144
    v_lshlrev_b32 v28, 7, v8
    s_mov_b64 exec, 0xfff
    buffer_load_dword v6, v28, s[12:15], s52 offen
    s_mov_b64 exec, -1
    s_cmp_eq_u32 s42, 7
    s_cbranch_scc0 NOPHI
    s_mov_b32 s8, s20
    s_and_b32 s9, s21, 0xffff
    s_mov_b32 s10, 16384
    s_mov_b32 s11, 0x20000
    s_lshl_b32 s51, s41, 10
    s_mov_b32 m0, 155648
    s_nop 0
    buffer_load_dwordx4 v0, s[8:11], s51 offen lds
    s_mov_b32 s4, s38
    s_and_b32 s5, s39, 0xffff
    s_mov_b32 s6, 25165824
    s_mov_b32 s7, 0x20000
    v_mov_b32 v150, 20267008
    buffer_load_dwordx2 v[152:153], v150, s[4:7], 0 offen sc1
NOPHI:
    s_mov_b32 s73, m0
    s_lshl_b32 s74, s42, 12
    s_add_u32 m0, s74, 4294950912
    s_nop 0
    buffer_load_dwordx4 v20, s[12:15], s71 offen lds
    s_add_u32 s71, s71, 24576
    s_add_u32 m0, s74, 4294951936
    s_nop 0
    buffer_load_dwordx4 v21, s[12:15], s71 offen lds
    s_add_u32 s71, s71, 24576
    s_add_u32 m0, s74, 4294952960
    s_nop 0
    buffer_load_dwordx4 v20, s[12:15], s71 offen lds
    s_add_u32 s71, s71, 24576
    s_add_u32 m0, s74, 4294953984
    s_nop 0
    buffer_load_dwordx4 v21, s[12:15], s71 offen lds
    s_add_u32 s71, s71, 319488
    s_mov_b32 m0, s73
    s_mov_b32 s73, m0
    s_lshl_b32 s74, s42, 12
    s_add_u32 m0, s74, 0
    s_nop 0
    buffer_load_dwordx4 v20, s[12:15], s71 offen lds
    s_add_u32 s71, s71, 24576
    s_add_u32 m0, s74, 1024
    s_nop 0
    buffer_load_dwordx4 v21, s[12:15], s71 offen lds
    s_add_u32 s71, s71, 24576
    s_add_u32 m0, s74, 2048
    s_nop 0
    buffer_load_dwordx4 v20, s[12:15], s71 offen lds
    s_add_u32 s71, s71, 24576
    s_add_u32 m0, s74, 3072
    s_nop 0
    buffer_load_dwordx4 v21, s[12:15], s71 offen lds
    s_add_u32 s71, s71, 319488
    s_mov_b32 m0, s73
    s_lshr_b32 s43, s41, 3
    s_and_b32 s44, s41, 7
    s_mov_b32 s46, 0
    s_mov_b32 s75, 0x3f803f80
    v_mov_b32 v4, 160512
    v_lshrrev_b32 v9, 4, v8
    v_bfe_u32 v10, v8, 2, 2
    v_and_b32 v11, 3, v8
    v_lshl_add_u32 v12, v9, 3, v10
    v_lshlrev_b32 v12, 7, v12
    v_and_b32 v13, 2, v10
    v_and_b32 v14, 1, v9
    v_or_b32 v15, v13, v14
    v_lshl_or_b32 v12, v15, 5, v12
    v_lshl_or_b32 v1, v11, 3, v12
    v_lshrrev_b32 v28, 5, v8
    v_lshl_add_u32 v12, v28, 3, v10
    v_lshlrev_b32 v12, 7, v12
    v_or_b32 v15, v13, v28
    v_lshrrev_b32 v29, 1, v11
    v_and_b32 v30, 1, v11
    v_lshl_or_b32 v12, v29, 3, v12
    v_xor_b32 v31, v14, v15
    v_lshl_or_b32 v2, v31, 5, v12
    v_lshl_or_b32 v2, v30, 4, v2
    v_xor_b32 v31, v30, v15
    v_lshl_or_b32 v3, v31, 5, v12
    v_lshl_or_b32 v3, v14, 4, v3
    s_mov_b32 s4, s38
    s_and_b32 s5, s39, 0xffff
    s_mov_b32 s6, 25165824
    s_mov_b32 s7, 0x20000
    v_mov_b32 v17, v22
    v_mov_b32 v18, v23
    v_lshlrev_b32 v19, 2, v8
    v_add_u32 v19, 160640, v19
    s_lshl_b32 s51, s42, 2
    s_add_u32 s52, s51, 160592
    v_mov_b32 v1, s52
    s_add_u32 s52, s51, 160496
    v_mov_b32 v5, s52
    s_lshl_b32 s51, s95, 5
    v_xor_b32 v15, s51, v22
    v_lshlrev_b32 v7, 7, v8
    s_mov_b32 s86, 6
    s_mov_b32 s49, 0
    s_mov_b32 s77, 0
    s_setprio 3
    s_cmp_eq_u32 s42, 7
    s_cbranch_scc1 INITW
    s_cmp_eq_u32 s42, 6
    s_cbranch_scc1 TASK6
    s_lshl_b32 s51, s95, 10
    s_mov_b32 m0, s51
    s_branch LD_FIRST
LD_LAYER:
    s_waitcnt vmcnt(8)
    s_sub_i32 s51, s84, 1
    s_max_i32 s85, s85, s51
    s_call_b64 s[80:81], PUB
    s_waitcnt vmcnt(0)
    s_sub_i32 s51, s84, 0
    s_max_i32 s85, s85, s51
    s_call_b64 s[80:81], PUB
LD_FIRST:
    s_call_b64 s[78:79], RK
    s_add_u32 s82, s49, 6
    s_mov_b32 s83, 18
    s_call_b64 s[78:79], RQ
    s_setprio 0
    s_mov_b32 s84, s85
    s_add_u32 m0, m0, 98304
    s_mov_b32 s12, s22
    s_and_b32 s13, s23, 0xffff
    s_mov_b32 s14, 524288
    s_mov_b32 s91, 1024
    s_mov_b32 s92, 64
    s_mov_b32 s90, 4
    s_mov_b32 s87, 16384
    s_mov_b32 s88, 212992
    s_mov_b32 s93, 4294721536
    s_lshl_b32 s94, s44, 7
    s_call_b64 s[56:57], LD_RUN
    s_mov_b32 s12, s26
    s_and_b32 s13, s27, 0xffff
    s_mov_b32 s14, 524288
    s_mov_b32 s91, 1024
    s_mov_b32 s92, 64
    s_mov_b32 s90, 4
    s_mov_b32 s87, 16384
    s_mov_b32 s88, 212992
    s_mov_b32 s93, 4294721536
    s_lshl_b32 s94, s44, 7
    s_call_b64 s[56:57], LD_RUN
    s_mov_b32 s12, s28
    s_and_b32 s13, s29, 0xffff
    s_mov_b32 s14, 524288
    s_mov_b32 s91, 1024
    s_mov_b32 s92, 64
    s_mov_b32 s90, 4
    s_mov_b32 s87, 16384
    s_mov_b32 s88, 212992
    s_mov_b32 s93, 4294721536
    s_lshl_b32 s94, s44, 7
    s_call_b64 s[56:57], LD_RUN
    s_waitcnt vmcnt(8)
    s_sub_i32 s51, s84, 1
    s_max_i32 s85, s85, s51
    s_call_b64 s[80:81], PUB
    s_waitcnt vmcnt(0)
    s_sub_i32 s51, s84, 0
    s_max_i32 s85, s85, s51
    s_call_b64 s[80:81], PUB
    s_add_u32 s82, s49, 26
    s_mov_b32 s83, 1048576
    s_call_b64 s[78:79], R3
    s_mov_b32 s84, s85
    s_mov_b32 s12, s32
    s_and_b32 s13, s33, 0xffff
    s_mov_b32 s14, 1835008
    s_mov_b32 s91, 1024
    s_mov_b32 s92, 64
    s_mov_b32 s90, 7
    s_mov_b32 s87, 16384
    s_mov_b32 s88, 868352
    s_mov_b32 s93, 4294131712
    s_lshl_b32 s94, s44, 7
    s_call_b64 s[56:57], LD_RUN
    s_mov_b32 s12, s32
    s_and_b32 s13, s33, 0xffff
    s_mov_b32 s14, 1835008
    s_mov_b32 s91, 1024
    s_mov_b32 s92, 64
    s_mov_b32 s90, 7
    s_mov_b32 s87, 16384
    s_mov_b32 s88, 868352
    s_mov_b32 s93, 4294131712
    s_lshl_b32 s94, s44, 7
    s_add_u32 s94, s94, 65536
    s_call_b64 s[56:57], LD_RUN
    s_add_u32 s46, s46, 1
    s_add_u32 s49, s49, 40
    s_cmp_lt_u32 s46, 2
    s_cbranch_scc1 LD_LAYER
    s_waitcnt vmcnt(8)
    s_sub_i32 s51, s84, 1
    s_max_i32 s85, s85, s51
    s_call_b64 s[80:81], PUB
    s_waitcnt vmcnt(0)
    s_sub_i32 s51, s84, 0
    s_max_i32 s85, s85, s51
    s_call_b64 s[80:81], PUB
    s_waitcnt lgkmcnt(0)
    s_endpgm
PUB:
    v_mov_b32 v8, s85
    ds_write_b32 v5, v8
    v_xor_b32 v29, 8, v5
    v_and_b32 v30, -9, v5
    s_cmp_le_u32 s85, s77
    s_cbranch_scc1 PUB_F
    ds_read_b32 v28, v29
    s_waitcnt lgkmcnt(0)
    v_readfirstlane_b32 s77, v28
    v_min_u32 v8, v8, v28
PUB_F:
    s_mov_b64 exec, 1
    ds_max_u32 v30, v8 offset:32
    s_mov_b64 exec, -1
    s_setpc_b64 s[80:81]
RK:
    s_cmp_eq_u32 s46, 0
    s_cbranch_scc1 RK0
    s_add_u32 s84, s49, 0
    s_cmp_gt_u32 s86, s84
    s_cbranch_scc1 RQ_F0
    s_call_b64 s[56:57], LD_FREE
RQ_F0:
    s_lshl_b32 s89, s42, 12
    s_sub_u32 s89, s89, 16384
    v_add_u32 v10, s89, v0
    ds_write_b128 v10, v[32:35] offset:0
    ds_write_b128 v10, v[36:39] offset:1024
    ds_write_b128 v10, v[40:43] offset:2048
    ds_write_b128 v10, v[44:47] offset:3072
    s_add_u32 s85, s84, 1
    s_call_b64 s[80:81], PUB
    s_add_u32 s84, s49, 1
    s_cmp_gt_u32 s86, s84
    s_cbranch_scc1 RQ_F1
    s_call_b64 s[56:57], LD_FREE
RQ_F1:
    s_lshl_b32 s89, s42, 12
    s_sub_u32 s89, s89, 16384
    v_add_u32 v10, s89, v0
    ds_write_b128 v10, v[48:51] offset:16384
    ds_write_b128 v10, v[52:55] offset:17408
    ds_write_b128 v10, v[56:59] offset:18432
    ds_write_b128 v10, v[60:63] offset:19456
    s_add_u32 s85, s84, 1
    s_call_b64 s[80:81], PUB
    s_add_u32 s84, s49, 2
    s_cmp_gt_u32 s86, s84
    s_cbranch_scc1 RQ_F2
    s_call_b64 s[56:57], LD_FREE
RQ_F2:
    s_lshl_b32 s89, s42, 12
    s_sub_u32 s89, s89, 16384
    v_add_u32 v10, s89, v0
    ds_write_b128 v10, v[64:67] offset:32768
    ds_write_b128 v10, v[68:71] offset:33792
    ds_write_b128 v10, v[72:75] offset:34816
    ds_write_b128 v10, v[76:79] offset:35840
    s_add_u32 s85, s84, 1
    s_call_b64 s[80:81], PUB
    s_add_u32 s84, s49, 3
    s_cmp_gt_u32 s86, s84
    s_cbranch_scc1 RQ_F3
    s_call_b64 s[56:57], LD_FREE
RQ_F3:
    s_lshl_b32 s89, s42, 12
    s_sub_u32 s89, s89, 16384
    v_add_u32 v10, s89, v0
    ds_write_b128 v10, v[80:83] offset:49152
    ds_write_b128 v10, v[84:87] offset:50176
    ds_write_b128 v10, v[88:91] offset:51200
    ds_write_b128 v10, v[92:95] offset:52224
    s_add_u32 s85, s84, 1
    s_add_u32 s85, s85, s76
    s_call_b64 s[80:81], PUB
    s_setpc_b64 s[78:79]
RK0:
    s_waitcnt vmcnt(4)
    s_mov_b32 s85, 1
    s_call_b64 s[80:81], PUB
    s_mov_b32 s73, m0
    s_lshl_b32 s74, s42, 12
    s_add_u32 m0, s74, 16384
    s_nop 0
    buffer_load_dwordx4 v20, s[12:15], s71 offen lds
    s_add_u32 s71, s71, 24576
    s_add_u32 m0, s74, 17408
    s_nop 0
    buffer_load_dwordx4 v21, s[12:15], s71 offen lds
    s_add_u32 s71, s71, 24576
    s_add_u32 m0, s74, 18432
    s_nop 0
    buffer_load_dwordx4 v20, s[12:15], s71 offen lds
    s_add_u32 s71, s71, 24576
    s_add_u32 m0, s74, 19456
    s_nop 0
    buffer_load_dwordx4 v21, s[12:15], s71 offen lds
    s_add_u32 s71, s71, 319488
    s_mov_b32 m0, s73
    s_mov_b32 s73, m0
    s_lshl_b32 s74, s42, 12
    s_add_u32 m0, s74, 32768
    s_nop 0
    buffer_load_dwordx4 v20, s[12:15], s71 offen lds
    s_add_u32 s71, s71, 24576
    s_add_u32 m0, s74, 33792
    s_nop 0
    buffer_load_dwordx4 v21, s[12:15], s71 offen lds
    s_add_u32 s71, s71, 24576
    s_add_u32 m0, s74, 34816
    s_nop 0
    buffer_load_dwordx4 v20, s[12:15], s71 offen lds
    s_add_u32 s71, s71, 24576
    s_add_u32 m0, s74, 35840
    s_nop 0
    buffer_load_dwordx4 v21, s[12:15], s71 offen lds
    s_add_u32 s71, s71, 319488
    s_mov_b32 m0, s73
    s_cmp_eq_u32 s42, 7
    s_cbranch_scc0 NOHOOK
    v_mov_b32 v24, 1
    ds_write_b32 v4, v24 offset:120
    s_cmp_eq_u32 s2, 0
    s_cbranch_scc0 NOHOOK
    s_mov_b32 s8, s36
    s_and_b32 s9, s37, 0xffff
    s_mov_b32 s10, 256
    s_mov_b32 s11, 0x20000
    v_mov_b32 v151, 0
    v_mov_b32 v150, 20267008
    v_and_b32 v152, -16, v152
    v_add_co_u32 v152, vcc, 16, v152
    s_nop 1
    v_addc_co_u32 v153, vcc, 0, v153, vcc
    v_not_b32 v154, v152
    v_not_b32 v155, v153
    s_mov_b64 exec, 1
    buffer_store_dwordx4 v[152:155], v151, s[8:11], 0 offen sc1
    buffer_store_dwordx2 v[152:153], v150, s[4:7], 0 offen sc1
    s_mov_b64 exec, -1
NOHOOK:
    s_waitcnt vmcnt(8)
    s_mov_b32 s85, 2
    s_call_b64 s[80:81], PUB
    s_lshl_b32 s89, s42, 12
    s_sub_u32 s89, s89, 16384
    v_add_u32 v11, s89, v3
    v_xor_b32 v12, 64, v11
    ds_read_b64_tr_b16 v[32:33], v11 offset:0
    ds_read_b64_tr_b16 v[34:35], v11 offset:512
    ds_read_b64_tr_b16 v[36:37], v12 offset:0
    ds_read_b64_tr_b16 v[38:39], v12 offset:512
    ds_read_b64_tr_b16 v[40:41], v11 offset:2048
    ds_read_b64_tr_b16 v[42:43], v11 offset:2560
    ds_read_b64_tr_b16 v[44:45], v12 offset:2048
    ds_read_b64_tr_b16 v[46:47], v12 offset:2560
    ds_read_b64_tr_b16 v[48:49], v11 offset:16384
    ds_read_b64_tr_b16 v[50:51], v11 offset:16896
    ds_read_b64_tr_b16 v[52:53], v12 offset:16384
    ds_read_b64_tr_b16 v[54:55], v12 offset:16896
    ds_read_b64_tr_b16 v[56:57], v11 offset:18432
    ds_read_b64_tr_b16 v[58:59], v11 offset:18944
    ds_read_b64_tr_b16 v[60:61], v12 offset:18432
    ds_read_b64_tr_b16 v[62:63], v12 offset:18944
    v_bfe_u32 v8, v0, 6, 2
    v_bfe_u32 v9, v0, 8, 1
    v_cmp_eq_u32 vcc, v8, v9
    v_mov_b32 v8, s75
    v_add_u32 v10, s89, v0
    v_cndmask_b32 v28, 0, v8, vcc
    v_cndmask_b32 v29, 0, v8, vcc
    v_cndmask_b32 v30, 0, v8, vcc
    v_cndmask_b32 v31, 0, v8, vcc
    s_waitcnt lgkmcnt(14)
    s_nop 0
    v_mfma_f32_16x16x32_bf16 v[20:23], v[28:31], v[32:35], 0
    s_waitcnt lgkmcnt(12)
    v_mfma_f32_16x16x32_bf16 v[24:27], v[28:31], v[36:39], 0
    s_waitcnt lgkmcnt(10)
    v_mfma_f32_16x16x32_bf16 v[20:23], v[28:31], v[40:43], v[20:23]
    s_waitcnt lgkmcnt(8)
    v_mfma_f32_16x16x32_bf16 v[24:27], v[28:31], v[44:47], v[24:27]
    s_waitcnt lgkmcnt(6)
    v_mfma_f32_16x16x32_bf16 v[20:23], v[28:31], v[48:51], v[20:23]
    s_waitcnt lgkmcnt(4)
    v_mfma_f32_16x16x32_bf16 v[24:27], v[28:31], v[52:55], v[24:27]
    s_waitcnt lgkmcnt(2)
    v_mfma_f32_16x16x32_bf16 v[20:23], v[28:31], v[56:59], v[20:23]
    s_waitcnt lgkmcnt(0)
    v_mfma_f32_16x16x32_bf16 v[24:27], v[28:31], v[60:63], v[24:27]
    s_add_u32 s51, s76, 2
    v_mov_b32 v8, s51
    s_nop 5
    v_mov_b32 v9, v24
    ds_read_b128 v[32:35], v10 offset:0
    ds_read_b128 v[36:39], v10 offset:1024
    ds_read_b128 v[40:43], v10 offset:2048
    ds_read_b128 v[44:47], v10 offset:3072
    ds_read_b128 v[48:51], v10 offset:16384
    ds_read_b128 v[52:55], v10 offset:17408
    ds_read_b128 v[56:59], v10 offset:18432
    ds_read_b128 v[60:63], v10 offset:19456
    s_waitcnt lgkmcnt(0)
    s_waitcnt vmcnt(4)
    s_mov_b32 s85, 3
    s_call_b64 s[80:81], PUB
    s_waitcnt vmcnt(0)
    s_add_u32 s85, s76, 4
    s_call_b64 s[80:81], PUB
    s_lshl_b32 s89, s42, 12
    s_sub_u32 s89, s89, 16384
    v_add_u32 v11, s89, v3
    v_xor_b32 v12, 64, v11
    ds_read_b64_tr_b16 v[64:65], v11 offset:32768
    ds_read_b64_tr_b16 v[66:67], v11 offset:33280
    ds_read_b64_tr_b16 v[68:69], v12 offset:32768
    ds_read_b64_tr_b16 v[70:71], v12 offset:33280
    ds_read_b64_tr_b16 v[72:73], v11 offset:34816
    ds_read_b64_tr_b16 v[74:75], v11 offset:35328
    ds_read_b64_tr_b16 v[76:77], v12 offset:34816
    ds_read_b64_tr_b16 v[78:79], v12 offset:35328
    ds_read_b64_tr_b16 v[80:81], v11 offset:49152
    ds_read_b64_tr_b16 v[82:83], v11 offset:49664
    ds_read_b64_tr_b16 v[84:85], v12 offset:49152
    ds_read_b64_tr_b16 v[86:87], v12 offset:49664
    ds_read_b64_tr_b16 v[88:89], v11 offset:51200
    ds_read_b64_tr_b16 v[90:91], v11 offset:51712
    ds_read_b64_tr_b16 v[92:93], v12 offset:51200
    ds_read_b64_tr_b16 v[94:95], v12 offset:51712
    v_bfe_u32 v8, v0, 6, 2
    v_bfe_u32 v9, v0, 8, 1
    v_cmp_eq_u32 vcc, v8, v9
    v_mov_b32 v8, s75
    v_add_u32 v10, s89, v0
    v_cndmask_b32 v28, 0, v8, vcc
    v_cndmask_b32 v29, 0, v8, vcc
    v_cndmask_b32 v30, 0, v8, vcc
    v_cndmask_b32 v31, 0, v8, vcc
    s_waitcnt lgkmcnt(14)
    s_nop 0
    v_mfma_f32_16x16x32_bf16 v[20:23], v[28:31], v[64:67], v[20:23]
    s_waitcnt lgkmcnt(12)
    v_mfma_f32_16x16x32_bf16 v[24:27], v[28:31], v[68:71], v[24:27]
    s_waitcnt lgkmcnt(10)
    v_mfma_f32_16x16x32_bf16 v[20:23], v[28:31], v[72:75], v[20:23]
    s_waitcnt lgkmcnt(8)
    v_mfma_f32_16x16x32_bf16 v[24:27], v[28:31], v[76:79], v[24:27]
    s_waitcnt lgkmcnt(6)
    v_mfma_f32_16x16x32_bf16 v[20:23], v[28:31], v[80:83], v[20:23]
    s_waitcnt lgkmcnt(4)
    v_mfma_f32_16x16x32_bf16 v[24:27], v[28:31], v[84:87], v[24:27]
    s_waitcnt lgkmcnt(2)
    v_mfma_f32_16x16x32_bf16 v[20:23], v[28:31], v[88:91], v[20:23]
    s_waitcnt lgkmcnt(0)
    v_mfma_f32_16x16x32_bf16 v[24:27], v[28:31], v[92:95], v[24:27]
    s_add_u32 s51, s76, 6
    v_mov_b32 v8, s51
    s_nop 5
    v_mov_b32 v9, v24
    s_mul_i32 s52, s95, 256
    s_lshl_b32 s53, s76, 7
    s_add_u32 s52, s52, s53
    v_add_u32 v13, s52, v19
    v_mov_b32 v9, 1
    s_mov_b32 exec_hi, 0
    ds_write_b32 v13, v20 offset:0
    ds_write_b32 v13, v24 offset:512
    s_mov_b64 exec, 1
    ds_add_u32 v4, v9 offset:68
    s_mov_b64 exec, -1
    ds_read_b128 v[64:67], v10 offset:32768
    ds_read_b128 v[68:71], v10 offset:33792
    ds_read_b128 v[72:75], v10 offset:34816
    ds_read_b128 v[76:79], v10 offset:35840
    ds_read_b128 v[80:83], v10 offset:49152
    ds_read_b128 v[84:87], v10 offset:50176
    ds_read_b128 v[88:91], v10 offset:51200
    ds_read_b128 v[92:95], v10 offset:52224
    s_waitcnt lgkmcnt(0)
    ds_write_b32 v1, v8
    s_mov_b32 s12, s18
    s_and_b32 s13, s19, 0xffff
    s_mov_b32 s14, 1572864
    s_mov_b32 s15, 0x20000
    v_mul_u32_u24 v25, 3072, v16
    v_add_u32 v25, v25, v17
    v_mul_u32_u24 v26, 393216, v18
    v_add_u32 v26, v26, v25
    v_xor_b32 v27, 32, v26
    s_lshl_b32 s89, s76, 1
    s_add_u32 s89, s89, s95
    s_lshl_b32 s89, s89, 13
    s_add_u32 s89, s89, 65536
    s_mov_b32 s73, m0
    s_add_u32 m0, s89, 0
    s_nop 0
    buffer_load_dwordx4 v26, s[12:15], s72 offen lds
    s_add_u32 s72, s72, 24576
    s_add_u32 m0, s89, 1024
    s_nop 0
    buffer_load_dwordx4 v27, s[12:15], s72 offen lds
    s_add_u32 s72, s72, 24576
    s_add_u32 m0, s89, 2048
    s_nop 0
    buffer_load_dwordx4 v26, s[12:15], s72 offen lds
    s_add_u32 s72, s72, 24576
    s_add_u32 m0, s89, 3072
    s_nop 0
    buffer_load_dwordx4 v27, s[12:15], s72 offen lds
    s_add_u32 s72, s72, 24576
    s_add_u32 m0, s89, 4096
    s_nop 0
    buffer_load_dwordx4 v26, s[12:15], s72 offen lds
    s_add_u32 s72, s72, 24576
    s_add_u32 m0, s89, 5120
    s_nop 0
    buffer_load_dwordx4 v27, s[12:15], s72 offen lds
    s_add_u32 s72, s72, 24576
    s_add_u32 m0, s89, 6144
    s_nop 0
    buffer_load_dwordx4 v26, s[12:15], s72 offen lds
    s_add_u32 s72, s72, 24576
    s_add_u32 m0, s89, 7168
    s_nop 0
    buffer_load_dwordx4 v27, s[12:15], s72 offen lds
    s_add_u32 s72, s72, 24576
    s_mov_b32 m0, s73
    s_setprio 0
    s_setpc_b64 s[78:79]
RQ:
    s_add_u32 s84, s49, s76
    s_add_u32 s84, s84, 4
    s_cmp_gt_u32 s86, s84
    s_cbranch_scc1 RF_200
    s_call_b64 s[56:57], LD_FREE
RF_200:
    s_lshl_b32 s89, s76, 1
    s_add_u32 s89, s89, s95
    s_lshl_b32 s89, s89, 13
    s_add_u32 s89, s89, 65536
    v_add_u32 v10, s89, v0
    s_waitcnt vmcnt(0)
    s_cmp_eq_u32 s46, 0
    s_cbranch_scc1 RQ_NQ
    ds_write_b128 v10, v[96:99] offset:0
    ds_write_b128 v10, v[100:103] offset:1024
    ds_write_b128 v10, v[104:107] offset:2048
    ds_write_b128 v10, v[108:111] offset:3072
    ds_write_b128 v10, v[112:115] offset:4096
    ds_write_b128 v10, v[116:119] offset:5120
    ds_write_b128 v10, v[120:123] offset:6144
    ds_write_b128 v10, v[124:127] offset:7168
RQ_NQ:
    s_mov_b32 s85, s82
    s_call_b64 s[80:81], PUB
    s_cmp_eq_u32 s46, 0
    s_cbranch_scc0 L0O_201
    s_lshl_b32 s89, s76, 1
    s_add_u32 s89, s89, s95
    s_lshl_b32 s89, s89, 13
    s_add_u32 s89, s89, 65536
    v_add_u32 v11, s89, v3
    v_xor_b32 v12, 64, v11
    ds_read_b64_tr_b16 v[96:97], v11 offset:0
    ds_read_b64_tr_b16 v[98:99], v11 offset:512
    ds_read_b64_tr_b16 v[100:101], v12 offset:0
    ds_read_b64_tr_b16 v[102:103], v12 offset:512
    ds_read_b64_tr_b16 v[104:105], v11 offset:2048
    ds_read_b64_tr_b16 v[106:107], v11 offset:2560
    ds_read_b64_tr_b16 v[108:109], v12 offset:2048
    ds_read_b64_tr_b16 v[110:111], v12 offset:2560
    ds_read_b64_tr_b16 v[112:113], v11 offset:4096
    ds_read_b64_tr_b16 v[114:115], v11 offset:4608
    ds_read_b64_tr_b16 v[116:117], v12 offset:4096
    ds_read_b64_tr_b16 v[118:119], v12 offset:4608
    ds_read_b64_tr_b16 v[120:121], v11 offset:6144
    ds_read_b64_tr_b16 v[122:123], v11 offset:6656
    ds_read_b64_tr_b16 v[124:125], v12 offset:6144
    ds_read_b64_tr_b16 v[126:127], v12 offset:6656
    v_bfe_u32 v8, v0, 6, 2
    v_bfe_u32 v9, v0, 8, 1
    v_cmp_eq_u32 vcc, v8, v9
    v_mov_b32 v8, s75
    v_add_u32 v10, s89, v0
    v_cndmask_b32 v28, 0, v8, vcc
    v_cndmask_b32 v29, 0, v8, vcc
    v_cndmask_b32 v30, 0, v8, vcc
    v_cndmask_b32 v31, 0, v8, vcc
    s_waitcnt lgkmcnt(14)
    s_nop 0
    v_mfma_f32_16x16x32_bf16 v[20:23], v[28:31], v[96:99], 0
    s_waitcnt lgkmcnt(12)
    v_mfma_f32_16x16x32_bf16 v[20:23], v[28:31], v[100:103], v[20:23]
    s_waitcnt lgkmcnt(10)
    v_mfma_f32_16x16x32_bf16 v[20:23], v[28:31], v[104:107], v[20:23]
    s_waitcnt lgkmcnt(8)
    v_mfma_f32_16x16x32_bf16 v[20:23], v[28:31], v[108:111], v[20:23]
    s_waitcnt lgkmcnt(6)
    v_mfma_f32_16x16x32_bf16 v[20:23], v[28:31], v[112:115], v[20:23]
    s_waitcnt lgkmcnt(4)
    v_mfma_f32_16x16x32_bf16 v[20:23], v[28:31], v[116:119], v[20:23]
    s_waitcnt lgkmcnt(2)
    v_mfma_f32_16x16x32_bf16 v[20:23], v[28:31], v[120:123], v[20:23]
    s_waitcnt lgkmcnt(0)
    v_mfma_f32_16x16x32_bf16 v[20:23], v[28:31], v[124:127], v[20:23]
    s_add_u32 s51, s83, 2
    v_mov_b32 v8, s51
    s_nop 5
    v_mov_b32 v9, v20
    s_mul_i32 s52, s95, 256
    s_lshl_b32 s53, s76, 7
    s_add_u32 s52, s52, s53
    v_add_u32 v13, s52, v19
    v_mov_b32 v9, 1
    s_mov_b32 exec_hi, 0
    ds_write_b32 v13, v20 offset:1024
    s_mov_b64 exec, 1
    ds_add_u32 v4, v9 offset:40
    s_mov_b64 exec, -1
    ds_read_b128 v[96:99], v10 offset:0
    ds_read_b128 v[100:103], v10 offset:1024
    ds_read_b128 v[104:107], v10 offset:2048
    ds_read_b128 v[108:111], v10 offset:3072
    ds_read_b128 v[112:115], v10 offset:4096
    ds_read_b128 v[116:119], v10 offset:5120
    ds_read_b128 v[120:123], v10 offset:6144
    ds_read_b128 v[124:127], v10 offset:7168
    s_waitcnt lgkmcnt(0)
    ds_write_b32 v1, v8
L0O_201:
    s_setpc_b64 s[78:79]
R3:
    s_cmp_ge_u32 s41, 14
    s_cbranch_scc0 R3_GO
    v_mov_b32 v8, 0x100000
    ds_write_b32 v1, v8
    s_mov_b32 s85, s82
    s_call_b64 s[80:81], PUB
    s_setpc_b64 s[78:79]
R3_GO:
    s_lshl_b32 s84, s76, 2
    s_add_u32 s84, s84, s49
    s_add_u32 s84, s84, 18
    s_cmp_gt_u32 s86, s84
    s_cbranch_scc1 R3_F0
    s_call_b64 s[56:57], LD_FREE
R3_F0:
    s_cmp_eq_u32 s46, 0
    s_cbranch_scc0 L0O_202
    s_mov_b32 s12, s30
    s_and_b32 s13, s31, 0xffff
    s_mov_b32 s14, 1835008
    s_mov_b32 s15, 0x20000
    v_mul_u32_u24 v12, 3584, v16
    v_lshl_add_u32 v12, v18, 6, v12
    v_add_u32 v12, v12, v17
    v_xor_b32 v13, 32, v12
    s_lshl_b32 s71, s41, 8
    s_lshl_b32 s52, s76, 7
    s_add_u32 s71, s71, s52
    s_mul_i32 s52, s95, 229376
    s_add_u32 s71, s71, s52
    s_add_u32 s71, s71, 0
    buffer_load_dwordx4 v[128:131], v12, s[12:15], s71 offen
    s_add_u32 s71, s71, 28672
    buffer_load_dwordx4 v[132:135], v13, s[12:15], s71 offen
    s_add_u32 s71, s71, 28672
    buffer_load_dwordx4 v[136:139], v12, s[12:15], s71 offen
    s_add_u32 s71, s71, 28672
    buffer_load_dwordx4 v[140:143], v13, s[12:15], s71 offen
    s_add_u32 s71, s71, 28672
    buffer_load_dwordx4 v[144:147], v12, s[12:15], s71 offen
    s_add_u32 s71, s71, 28672
    buffer_load_dwordx4 v[148:151], v13, s[12:15], s71 offen
    s_add_u32 s71, s71, 28672
    buffer_load_dwordx4 v[152:155], v12, s[12:15], s71 offen
    s_add_u32 s71, s71, 28672
    buffer_load_dwordx4 v[156:159], v13, s[12:15], s71 offen
    s_add_u32 s71, s71, 258048
    buffer_load_dwordx4 v[160:163], v12, s[12:15], s71 offen
    s_add_u32 s71, s71, 28672
    buffer_load_dwordx4 v[164:167], v13, s[12:15], s71 offen
    s_add_u32 s71, s71, 28672
    buffer_load_dwordx4 v[168:171], v12, s[12:15], s71 offen
    s_add_u32 s71, s71, 28672
    buffer_load_dwordx4 v[172:175], v13, s[12:15], s71 offen
    s_add_u32 s71, s71, 28672
    buffer_load_dwordx4 v[176:179], v12, s[12:15], s71 offen
    s_add_u32 s71, s71, 28672
    buffer_load_dwordx4 v[180:183], v13, s[12:15], s71 offen
    s_add_u32 s71, s71, 28672
    buffer_load_dwordx4 v[184:187], v12, s[12:15], s71 offen
    s_add_u32 s71, s71, 28672
    buffer_load_dwordx4 v[188:191], v13, s[12:15], s71 offen
    s_add_u32 s71, s71, 258048
    buffer_load_dwordx4 v[192:195], v12, s[12:15], s71 offen
    s_add_u32 s71, s71, 28672
    buffer_load_dwordx4 v[196:199], v13, s[12:15], s71 offen
    s_add_u32 s71, s71, 28672
    buffer_load_dwordx4 v[200:203], v12, s[12:15], s71 offen
    s_add_u32 s71, s71, 28672
    buffer_load_dwordx4 v[204:207], v13, s[12:15], s71 offen
    s_add_u32 s71, s71, 28672
    buffer_load_dwordx4 v[208:211], v12, s[12:15], s71 offen
    s_add_u32 s71, s71, 28672
    buffer_load_dwordx4 v[212:215], v13, s[12:15], s71 offen
    s_add_u32 s71, s71, 28672
    buffer_load_dwordx4 v[216:219], v12, s[12:15], s71 offen
    s_add_u32 s71, s71, 28672
    buffer_load_dwordx4 v[220:223], v13, s[12:15], s71 offen
    s_add_u32 s71, s71, 258048
    buffer_load_dwordx4 v[224:227], v12, s[12:15], s71 offen
    s_add_u32 s71, s71, 28672
    buffer_load_dwordx4 v[228:231], v13, s[12:15], s71 offen
    s_add_u32 s71, s71, 28672
    buffer_load_dwordx4 v[232:235], v12, s[12:15], s71 offen
    s_add_u32 s71, s71, 28672
    buffer_load_dwordx4 v[236:239], v13, s[12:15], s71 offen
    s_add_u32 s71, s71, 28672
    buffer_load_dwordx4 v[240:243], v12, s[12:15], s71 offen
    s_add_u32 s71, s71, 28672
    buffer_load_dwordx4 v[244:247], v13, s[12:15], s71 offen
    s_add_u32 s71, s71, 28672
    buffer_load_dwordx4 v[248:251], v12, s[12:15], s71 offen
    s_add_u32 s71, s71, 28672
    buffer_load_dwordx4 v[252:255], v13, s[12:15], s71 offen
    s_add_u32 s71, s71, 258048
L0O_202:
    s_lshl_b32 s89, s76, 2
    s_add_u32 s89, s89, 18
    s_and_b32 s89, s89, 7
    s_lshl_b32 s89, s89, 1
    s_add_u32 s89, s89, s95
    s_lshl_b32 s89, s89, 13
    v_add_u32 v10, s89, v0
    s_waitcnt vmcnt(24)
    ds_write_b128 v10, v[128:131] offset:0
    ds_write_b128 v10, v[132:135] offset:1024
    ds_write_b128 v10, v[136:139] offset:2048
    ds_write_b128 v10, v[140:143] offset:3072
    ds_write_b128 v10, v[144:147] offset:4096
    ds_write_b128 v10, v[148:151] offset:5120
    ds_write_b128 v10, v[152:155] offset:6144
    ds_write_b128 v10, v[156:159] offset:7168
    s_add_u32 s85, s84, 1
    s_call_b64 s[80:81], PUB
    s_lshl_b32 s84, s76, 2
    s_add_u32 s84, s84, s49
    s_add_u32 s84, s84, 19
    s_cmp_gt_u32 s86, s84
    s_cbranch_scc1 R3_F1
    s_call_b64 s[56:57], LD_FREE
R3_F1:
    s_lshl_b32 s89, s76, 2
    s_add_u32 s89, s89, 19
    s_and_b32 s89, s89, 7
    s_lshl_b32 s89, s89, 1
    s_add_u32 s89, s89, s95
    s_lshl_b32 s89, s89, 13
    v_add_u32 v10, s89, v0
    s_waitcnt vmcnt(16)
    ds_write_b128 v10, v[160:163] offset:0
    ds_write_b128 v10, v[164:167] offset:1024
    ds_write_b128 v10, v[168:171] offset:2048
    ds_write_b128 v10, v[172:175] offset:3072
    ds_write_b128 v10, v[176:179] offset:4096
    ds_write_b128 v10, v[180:183] offset:5120
    ds_write_b128 v10, v[184:187] offset:6144
    ds_write_b128 v10, v[188:191] offset:7168
    s_add_u32 s85, s84, 1
    s_call_b64 s[80:81], PUB
    s_lshl_b32 s84, s76, 2
    s_add_u32 s84, s84, s49
    s_add_u32 s84, s84, 20
    s_cmp_gt_u32 s86, s84
    s_cbranch_scc1 R3_F2
    s_call_b64 s[56:57], LD_FREE
R3_F2:
    s_lshl_b32 s89, s76, 2
    s_add_u32 s89, s89, 20
    s_and_b32 s89, s89, 7
    s_lshl_b32 s89, s89, 1
    s_add_u32 s89, s89, s95
    s_lshl_b32 s89, s89, 13
    v_add_u32 v10, s89, v0
    s_waitcnt vmcnt(8)
    ds_write_b128 v10, v[192:195] offset:0
    ds_write_b128 v10, v[196:199] offset:1024
    ds_write_b128 v10, v[200:203] offset:2048
    ds_write_b128 v10, v[204:207] offset:3072
    ds_write_b128 v10, v[208:211] offset:4096
    ds_write_b128 v10, v[212:215] offset:5120
    ds_write_b128 v10, v[216:219] offset:6144
    ds_write_b128 v10, v[220:223] offset:7168
    s_add_u32 s85, s84, 1
    s_call_b64 s[80:81], PUB
    s_lshl_b32 s84, s76, 2
    s_add_u32 s84, s84, s49
    s_add_u32 s84, s84, 21
    s_cmp_gt_u32 s86, s84
    s_cbranch_scc1 R3_F3
    s_call_b64 s[56:57], LD_FREE
R3_F3:
    s_lshl_b32 s89, s76, 2
    s_add_u32 s89, s89, 21
    s_and_b32 s89, s89, 7
    s_lshl_b32 s89, s89, 1
    s_add_u32 s89, s89, s95
    s_lshl_b32 s89, s89, 13
    v_add_u32 v10, s89, v0
    s_waitcnt vmcnt(0)
    ds_write_b128 v10, v[224:227] offset:0
    ds_write_b128 v10, v[228:231] offset:1024
    ds_write_b128 v10, v[232:235] offset:2048
    ds_write_b128 v10, v[236:239] offset:3072
    ds_write_b128 v10, v[240:243] offset:4096
    ds_write_b128 v10, v[244:247] offset:5120
    ds_write_b128 v10, v[248:251] offset:6144
    ds_write_b128 v10, v[252:255] offset:7168
    s_mov_b32 s85, s82
    s_call_b64 s[80:81], PUB
    s_cmp_eq_u32 s46, 0
    s_cbranch_scc0 L0O_203
    s_lshl_b32 s89, s76, 2
    s_add_u32 s89, s89, 18
    s_and_b32 s89, s89, 7
    s_lshl_b32 s89, s89, 1
    s_add_u32 s89, s89, s95
    s_lshl_b32 s89, s89, 13
    v_add_u32 v11, s89, v2
    v_xor_b32 v12, 64, v11
    ds_read_b64_tr_b16 v[128:129], v11 offset:0
    ds_read_b64_tr_b16 v[130:131], v11 offset:512
    ds_read_b64_tr_b16 v[132:133], v12 offset:0
    ds_read_b64_tr_b16 v[134:135], v12 offset:512
    ds_read_b64_tr_b16 v[136:137], v11 offset:2048
    ds_read_b64_tr_b16 v[138:139], v11 offset:2560
    ds_read_b64_tr_b16 v[140:141], v12 offset:2048
    ds_read_b64_tr_b16 v[142:143], v12 offset:2560
    ds_read_b64_tr_b16 v[144:145], v11 offset:4096
    ds_read_b64_tr_b16 v[146:147], v11 offset:4608
    ds_read_b64_tr_b16 v[148:149], v12 offset:4096
    ds_read_b64_tr_b16 v[150:151], v12 offset:4608
    ds_read_b64_tr_b16 v[152:153], v11 offset:6144
    ds_read_b64_tr_b16 v[154:155], v11 offset:6656
    ds_read_b64_tr_b16 v[156:157], v12 offset:6144
    ds_read_b64_tr_b16 v[158:159], v12 offset:6656
    v_bfe_u32 v8, v0, 6, 2
    v_bfe_u32 v9, v0, 8, 1
    v_cmp_eq_u32 vcc, v8, v9
    v_mov_b32 v8, s75
    v_add_u32 v10, s89, v0
    v_cndmask_b32 v28, 0, v8, vcc
    v_cndmask_b32 v29, 0, v8, vcc
    v_cndmask_b32 v30, 0, v8, vcc
    v_cndmask_b32 v31, 0, v8, vcc
    s_waitcnt lgkmcnt(14)
    s_nop 0
    v_mfma_f32_16x16x32_bf16 v[20:23], v[28:31], v[128:131], 0
    s_waitcnt lgkmcnt(12)
    v_mfma_f32_16x16x32_bf16 v[24:27], v[28:31], v[132:135], 0
    s_waitcnt lgkmcnt(10)
    v_mfma_f32_16x16x32_bf16 v[20:23], v[28:31], v[136:139], v[20:23]
    s_waitcnt lgkmcnt(8)
    v_mfma_f32_16x16x32_bf16 v[24:27], v[28:31], v[140:143], v[24:27]
    s_waitcnt lgkmcnt(6)
    v_mfma_f32_16x16x32_bf16 v[20:23], v[28:31], v[144:147], v[20:23]
    s_waitcnt lgkmcnt(4)
    v_mfma_f32_16x16x32_bf16 v[24:27], v[28:31], v[148:151], v[24:27]
    s_waitcnt lgkmcnt(2)
    v_mfma_f32_16x16x32_bf16 v[20:23], v[28:31], v[152:155], v[20:23]
    s_waitcnt lgkmcnt(0)
    v_mfma_f32_16x16x32_bf16 v[24:27], v[28:31], v[156:159], v[24:27]
    s_add_u32 s51, s76, 4
    v_mov_b32 v8, s51
    s_nop 5
    v_mov_b32 v9, v24
    ds_read_b128 v[128:131], v10 offset:0
    ds_read_b128 v[132:135], v10 offset:1024
    ds_read_b128 v[136:139], v10 offset:2048
    ds_read_b128 v[140:143], v10 offset:3072
    ds_read_b128 v[144:147], v10 offset:4096
    ds_read_b128 v[148:151], v10 offset:5120
    ds_read_b128 v[152:155], v10 offset:6144
    ds_read_b128 v[156:159], v10 offset:7168
    s_waitcnt lgkmcnt(0)
    s_lshl_b32 s89, s76, 2
    s_add_u32 s89, s89, 19
    s_and_b32 s89, s89, 7
    s_lshl_b32 s89, s89, 1
    s_add_u32 s89, s89, s95
    s_lshl_b32 s89, s89, 13
    v_add_u32 v11, s89, v2
    v_xor_b32 v12, 64, v11
    ds_read_b64_tr_b16 v[160:161], v11 offset:0
    ds_read_b64_tr_b16 v[162:163], v11 offset:512
    ds_read_b64_tr_b16 v[164:165], v12 offset:0
    ds_read_b64_tr_b16 v[166:167], v12 offset:512
    ds_read_b64_tr_b16 v[168:169], v11 offset:2048
    ds_read_b64_tr_b16 v[170:171], v11 offset:2560
    ds_read_b64_tr_b16 v[172:173], v12 offset:2048
    ds_read_b64_tr_b16 v[174:175], v12 offset:2560
    ds_read_b64_tr_b16 v[176:177], v11 offset:4096
    ds_read_b64_tr_b16 v[178:179], v11 offset:4608
    ds_read_b64_tr_b16 v[180:181], v12 offset:4096
    ds_read_b64_tr_b16 v[182:183], v12 offset:4608
    ds_read_b64_tr_b16 v[184:185], v11 offset:6144
    ds_read_b64_tr_b16 v[186:187], v11 offset:6656
    ds_read_b64_tr_b16 v[188:189], v12 offset:6144
    ds_read_b64_tr_b16 v[190:191], v12 offset:6656
    v_bfe_u32 v8, v0, 6, 2
    v_bfe_u32 v9, v0, 8, 1
    v_cmp_eq_u32 vcc, v8, v9
    v_mov_b32 v8, s75
    v_add_u32 v10, s89, v0
    v_cndmask_b32 v28, 0, v8, vcc
    v_cndmask_b32 v29, 0, v8, vcc
    v_cndmask_b32 v30, 0, v8, vcc
    v_cndmask_b32 v31, 0, v8, vcc
    s_waitcnt lgkmcnt(14)
    s_nop 0
    v_mfma_f32_16x16x32_bf16 v[20:23], v[28:31], v[160:163], v[20:23]
    s_waitcnt lgkmcnt(12)
    v_mfma_f32_16x16x32_bf16 v[24:27], v[28:31], v[164:167], v[24:27]
    s_waitcnt lgkmcnt(10)
    v_mfma_f32_16x16x32_bf16 v[20:23], v[28:31], v[168:171], v[20:23]
    s_waitcnt lgkmcnt(8)
    v_mfma_f32_16x16x32_bf16 v[24:27], v[28:31], v[172:175], v[24:27]
    s_waitcnt lgkmcnt(6)
    v_mfma_f32_16x16x32_bf16 v[20:23], v[28:31], v[176:179], v[20:23]
    s_waitcnt lgkmcnt(4)
    v_mfma_f32_16x16x32_bf16 v[24:27], v[28:31], v[180:183], v[24:27]
    s_waitcnt lgkmcnt(2)
    v_mfma_f32_16x16x32_bf16 v[20:23], v[28:31], v[184:187], v[20:23]
    s_waitcnt lgkmcnt(0)
    v_mfma_f32_16x16x32_bf16 v[24:27], v[28:31], v[188:191], v[24:27]
    s_add_u32 s51, s76, 4
    v_mov_b32 v8, s51
    s_nop 5
    v_mov_b32 v9, v24
    ds_read_b128 v[160:163], v10 offset:0
    ds_read_b128 v[164:167], v10 offset:1024
    ds_read_b128 v[168:171], v10 offset:2048
    ds_read_b128 v[172:175], v10 offset:3072
    ds_read_b128 v[176:179], v10 offset:4096
    ds_read_b128 v[180:183], v10 offset:5120
    ds_read_b128 v[184:187], v10 offset:6144
    ds_read_b128 v[188:191], v10 offset:7168
    s_waitcnt lgkmcnt(0)
    s_lshl_b32 s89, s76, 2
    s_add_u32 s89, s89, 20
    s_and_b32 s89, s89, 7
    s_lshl_b32 s89, s89, 1
    s_add_u32 s89, s89, s95
    s_lshl_b32 s89, s89, 13
    v_add_u32 v11, s89, v2
    v_xor_b32 v12, 64, v11
    ds_read_b64_tr_b16 v[192:193], v11 offset:0
    ds_read_b64_tr_b16 v[194:195], v11 offset:512
    ds_read_b64_tr_b16 v[196:197], v12 offset:0
    ds_read_b64_tr_b16 v[198:199], v12 offset:512
    ds_read_b64_tr_b16 v[200:201], v11 offset:2048
    ds_read_b64_tr_b16 v[202:203], v11 offset:2560
    ds_read_b64_tr_b16 v[204:205], v12 offset:2048
    ds_read_b64_tr_b16 v[206:207], v12 offset:2560
    ds_read_b64_tr_b16 v[208:209], v11 offset:4096
    ds_read_b64_tr_b16 v[210:211], v11 offset:4608
    ds_read_b64_tr_b16 v[212:213], v12 offset:4096
    ds_read_b64_tr_b16 v[214:215], v12 offset:4608
    ds_read_b64_tr_b16 v[216:217], v11 offset:6144
    ds_read_b64_tr_b16 v[218:219], v11 offset:6656
    ds_read_b64_tr_b16 v[220:221], v12 offset:6144
    ds_read_b64_tr_b16 v[222:223], v12 offset:6656
    v_bfe_u32 v8, v0, 6, 2
    v_bfe_u32 v9, v0, 8, 1
    v_cmp_eq_u32 vcc, v8, v9
    v_mov_b32 v8, s75
    v_add_u32 v10, s89, v0
    v_cndmask_b32 v28, 0, v8, vcc
    v_cndmask_b32 v29, 0, v8, vcc
    v_cndmask_b32 v30, 0, v8, vcc
    v_cndmask_b32 v31, 0, v8, vcc
    s_waitcnt lgkmcnt(14)
    s_nop 0
    v_mfma_f32_16x16x32_bf16 v[20:23], v[28:31], v[192:195], v[20:23]
    s_waitcnt lgkmcnt(12)
    v_mfma_f32_16x16x32_bf16 v[24:27], v[28:31], v[196:199], v[24:27]
    s_waitcnt lgkmcnt(10)
    v_mfma_f32_16x16x32_bf16 v[20:23], v[28:31], v[200:203], v[20:23]
    s_waitcnt lgkmcnt(8)
    v_mfma_f32_16x16x32_bf16 v[24:27], v[28:31], v[204:207], v[24:27]
    s_waitcnt lgkmcnt(6)
    v_mfma_f32_16x16x32_bf16 v[20:23], v[28:31], v[208:211], v[20:23]
    s_waitcnt lgkmcnt(4)
    v_mfma_f32_16x16x32_bf16 v[24:27], v[28:31], v[212:215], v[24:27]
    s_waitcnt lgkmcnt(2)
    v_mfma_f32_16x16x32_bf16 v[20:23], v[28:31], v[216:219], v[20:23]
    s_waitcnt lgkmcnt(0)
    v_mfma_f32_16x16x32_bf16 v[24:27], v[28:31], v[220:223], v[24:27]
    s_add_u32 s51, s76, 4
    v_mov_b32 v8, s51
    s_nop 5
    v_mov_b32 v9, v24
    ds_read_b128 v[192:195], v10 offset:0
    ds_read_b128 v[196:199], v10 offset:1024
    ds_read_b128 v[200:203], v10 offset:2048
    ds_read_b128 v[204:207], v10 offset:3072
    ds_read_b128 v[208:211], v10 offset:4096
    ds_read_b128 v[212:215], v10 offset:5120
    ds_read_b128 v[216:219], v10 offset:6144
    ds_read_b128 v[220:223], v10 offset:7168
    s_waitcnt lgkmcnt(0)
    s_lshl_b32 s89, s76, 2
    s_add_u32 s89, s89, 21
    s_and_b32 s89, s89, 7
    s_lshl_b32 s89, s89, 1
    s_add_u32 s89, s89, s95
    s_lshl_b32 s89, s89, 13
    v_add_u32 v11, s89, v2
    v_xor_b32 v12, 64, v11
    ds_read_b64_tr_b16 v[224:225], v11 offset:0
    ds_read_b64_tr_b16 v[226:227], v11 offset:512
    ds_read_b64_tr_b16 v[228:229], v12 offset:0
    ds_read_b64_tr_b16 v[230:231], v12 offset:512
    ds_read_b64_tr_b16 v[232:233], v11 offset:2048
    ds_read_b64_tr_b16 v[234:235], v11 offset:2560
    ds_read_b64_tr_b16 v[236:237], v12 offset:2048
    ds_read_b64_tr_b16 v[238:239], v12 offset:2560
    ds_read_b64_tr_b16 v[240:241], v11 offset:4096
    ds_read_b64_tr_b16 v[242:243], v11 offset:4608
    ds_read_b64_tr_b16 v[244:245], v12 offset:4096
    ds_read_b64_tr_b16 v[246:247], v12 offset:4608
    ds_read_b64_tr_b16 v[248:249], v11 offset:6144
    ds_read_b64_tr_b16 v[250:251], v11 offset:6656
    ds_read_b64_tr_b16 v[252:253], v12 offset:6144
    ds_read_b64_tr_b16 v[254:255], v12 offset:6656
    v_bfe_u32 v8, v0, 6, 2
    v_bfe_u32 v9, v0, 8, 1
    v_cmp_eq_u32 vcc, v8, v9
    v_mov_b32 v8, s75
    v_add_u32 v10, s89, v0
    v_cndmask_b32 v28, 0, v8, vcc
    v_cndmask_b32 v29, 0, v8, vcc
    v_cndmask_b32 v30, 0, v8, vcc
    v_cndmask_b32 v31, 0, v8, vcc
    s_waitcnt lgkmcnt(14)
    s_nop 0
    v_mfma_f32_16x16x32_bf16 v[20:23], v[28:31], v[224:227], v[20:23]
    s_waitcnt lgkmcnt(12)
    v_mfma_f32_16x16x32_bf16 v[24:27], v[28:31], v[228:231], v[24:27]
    s_waitcnt lgkmcnt(10)
    v_mfma_f32_16x16x32_bf16 v[20:23], v[28:31], v[232:235], v[20:23]
    s_waitcnt lgkmcnt(8)
    v_mfma_f32_16x16x32_bf16 v[24:27], v[28:31], v[236:239], v[24:27]
    s_waitcnt lgkmcnt(6)
    v_mfma_f32_16x16x32_bf16 v[20:23], v[28:31], v[240:243], v[20:23]
    s_waitcnt lgkmcnt(4)
    v_mfma_f32_16x16x32_bf16 v[24:27], v[28:31], v[244:247], v[24:27]
    s_waitcnt lgkmcnt(2)
    v_mfma_f32_16x16x32_bf16 v[20:23], v[28:31], v[248:251], v[20:23]
    s_waitcnt lgkmcnt(0)
    v_mfma_f32_16x16x32_bf16 v[24:27], v[28:31], v[252:255], v[24:27]
    s_add_u32 s51, s83, 2
    v_mov_b32 v8, s51
    s_nop 5
    v_mov_b32 v9, v24
    s_lshl_b32 s52, s76, 9
    s_lshl_b32 s53, s95, 7
    s_add_u32 s52, s52, s53
    v_add_u32 v13, s52, v19
    s_lshl_b32 s52, s76, 2
    v_add_u32 v14, s52, v4
    v_mov_b32 v9, 1
    s_mov_b32 exec_hi, 0
    ds_write_b32 v13, v20 offset:1536
    ds_write_b32 v13, v24 offset:1792
    s_mov_b64 exec, 1
    ds_add_u32 v14, v9 offset:112
    s_mov_b64 exec, -1
    ds_read_b128 v[224:227], v10 offset:0
    ds_read_b128 v[228:231], v10 offset:1024
    ds_read_b128 v[232:235], v10 offset:2048
    ds_read_b128 v[236:239], v10 offset:3072
    ds_read_b128 v[240:243], v10 offset:4096
    ds_read_b128 v[244:247], v10 offset:5120
    ds_read_b128 v[248:251], v10 offset:6144
    ds_read_b128 v[252:255], v10 offset:7168
    s_waitcnt lgkmcnt(0)
    ds_write_b32 v1, v8
L0O_203:
    s_setpc_b64 s[78:79]
L3:
    s_cmp_ge_u32 s41, 14
    s_cbranch_scc1 L3_X
    s_cmp_eq_u32 s46, 0
    s_cbranch_scc0 L3_X
    s_mov_b32 s12, s30
    s_and_b32 s13, s31, 0xffff
    s_mov_b32 s14, 1835008
    s_mov_b32 s15, 0x20000
    v_mul_u32_u24 v12, 3584, v16
    v_lshl_add_u32 v12, v18, 6, v12
    v_add_u32 v12, v12, v17
    v_xor_b32 v13, 32, v12
    s_lshl_b32 s71, s41, 8
    s_lshl_b32 s52, s76, 7
    s_add_u32 s71, s71, s52
    s_mul_i32 s52, s95, 229376
    s_add_u32 s71, s71, s52
    s_add_u32 s71, s71, 0
    buffer_load_dwordx4 v[128:131], v12, s[12:15], s71 offen
    s_add_u32 s71, s71, 28672
    buffer_load_dwordx4 v[132:135], v13, s[12:15], s71 offen
    s_add_u32 s71, s71, 28672
    buffer_load_dwordx4 v[136:139], v12, s[12:15], s71 offen
    s_add_u32 s71, s71, 28672
    buffer_load_dwordx4 v[140:143], v13, s[12:15], s71 offen
    s_add_u32 s71, s71, 28672
    buffer_load_dwordx4 v[144:147], v12, s[12:15], s71 offen
    s_add_u32 s71, s71, 28672
    buffer_load_dwordx4 v[148:151], v13, s[12:15], s71 offen
    s_add_u32 s71, s71, 28672
    buffer_load_dwordx4 v[152:155], v12, s[12:15], s71 offen
    s_add_u32 s71, s71, 28672
    buffer_load_dwordx4 v[156:159], v13, s[12:15], s71 offen
    s_add_u32 s71, s71, 258048
    buffer_load_dwordx4 v[160:163], v12, s[12:15], s71 offen
    s_add_u32 s71, s71, 28672
    buffer_load_dwordx4 v[164:167], v13, s[12:15], s71 offen
    s_add_u32 s71, s71, 28672
    buffer_load_dwordx4 v[168:171], v12, s[12:15], s71 offen
    s_add_u32 s71, s71, 28672
    buffer_load_dwordx4 v[172:175], v13, s[12:15], s71 offen
    s_add_u32 s71, s71, 28672
    buffer_load_dwordx4 v[176:179], v12, s[12:15], s71 offen
    s_add_u32 s71, s71, 28672
    buffer_load_dwordx4 v[180:183], v13, s[12:15], s71 offen
    s_add_u32 s71, s71, 28672
    buffer_load_dwordx4 v[184:187], v12, s[12:15], s71 offen
    s_add_u32 s71, s71, 28672
    buffer_load_dwordx4 v[188:191], v13, s[12:15], s71 offen
    s_add_u32 s71, s71, 258048
    buffer_load_dwordx4 v[192:195], v12, s[12:15], s71 offen
    s_add_u32 s71, s71, 28672
    buffer_load_dwordx4 v[196:199], v13, s[12:15], s71 offen
    s_add_u32 s71, s71, 28672
    buffer_load_dwordx4 v[200:203], v12, s[12:15], s71 offen
    s_add_u32 s71, s71, 28672
    buffer_load_dwordx4 v[204:207], v13, s[12:15], s71 offen
    s_add_u32 s71, s71, 28672
    buffer_load_dwordx4 v[208:211], v12, s[12:15], s71 offen
    s_add_u32 s71, s71, 28672
    buffer_load_dwordx4 v[212:215], v13, s[12:15], s71 offen
    s_add_u32 s71, s71, 28672
    buffer_load_dwordx4 v[216:219], v12, s[12:15], s71 offen
    s_add_u32 s71, s71, 28672
    buffer_load_dwordx4 v[220:223], v13, s[12:15], s71 offen
    s_add_u32 s71, s71, 258048
    buffer_load_dwordx4 v[224:227], v12, s[12:15], s71 offen
    s_add_u32 s71, s71, 28672
    buffer_load_dwordx4 v[228:231], v13, s[12:15], s71 offen
    s_add_u32 s71, s71, 28672
    buffer_load_dwordx4 v[232:235], v12, s[12:15], s71 offen
    s_add_u32 s71, s71, 28672
    buffer_load_dwordx4 v[236:239], v13, s[12:15], s71 offen
    s_add_u32 s71, s71, 28672
    buffer_load_dwordx4 v[240:243], v12, s[12:15], s71 offen
    s_add_u32 s71, s71, 28672
    buffer_load_dwordx4 v[244:247], v13, s[12:15], s71 offen
    s_add_u32 s71, s71, 28672
    buffer_load_dwordx4 v[248:251], v12, s[12:15], s71 offen
    s_add_u32 s71, s71, 28672
    buffer_load_dwordx4 v[252:255], v13, s[12:15], s71 offen
    s_add_u32 s71, s71, 258048
L3_X:
    s_setpc_b64 s[78:79]
LD_FREE:
    s_mov_b32 s55, 0
LD_FREE_L:
    s_cmp_gt_u32 s86, s84
    s_cbranch_scc1 LD_FREE_D
    ds_read_b128 v[28:31], v4 offset:16
    ds_read_b128 v[10:13], v4 offset:96
    s_waitcnt lgkmcnt(0)
    v_min3_u32 v28, v28, v29, v30
    v_min3_u32 v28, v28, v31, v10
    v_min3_u32 v28, v28, v11, v12
    v_min_u32 v28, v28, v13
    s_nop 0
    v_readfirstlane_b32 s86, v28
    s_nop 1
    s_add_u32 s86, s86, 6
    s_sleep 2
    s_add_u32 s55, s55, 1
    s_cmp_lt_u32 s55, 4000000
    s_cbranch_scc1 LD_FREE_L
    s_endpgm
LD_FREE_D:
    s_setpc_b64 s[56:57]
LD_RUN:
    v_mul_u32_u24 v25, s91, v16
    v_mul_u32_u24 v24, s92, v18
    v_add3_u32 v25, v25, v24, v15
    s_lshl_b32 s51, s91, 3
    s_mul_i32 s51, s51, s95
    s_add_u32 s89, s94, s51
LD_CHUNK:
    s_cmp_gt_u32 s86, s84
    s_cbranch_scc1 LD_GO
    s_mov_b32 s55, 0
LD_SPIN:
    ds_read_b128 v[28:31], v4 offset:16
    ds_read_b128 v[10:13], v4 offset:96
    s_waitcnt lgkmcnt(0)
    v_min3_u32 v28, v28, v29, v30
    v_min3_u32 v28, v28, v31, v10
    v_min3_u32 v28, v28, v11, v12
    v_min_u32 v28, v28, v13
    s_nop 0
    v_readfirstlane_b32 s86, v28
    s_nop 1
    s_add_u32 s86, s86, 6
    s_cmp_gt_u32 s86, s84
    s_cbranch_scc1 LD_GO
    s_sub_u32 s51, s84, s85
    s_cmp_eq_u32 s51, 2
    s_cbranch_scc1 LD_PW2
    s_cmp_eq_u32 s51, 1
    s_cbranch_scc1 LD_PW1
    s_sleep 2
    s_add_u32 s55, s55, 1
    s_cmp_lt_u32 s55, 4000000
    s_cbranch_scc1 LD_SPIN
    s_endpgm
LD_PW2:
    s_waitcnt vmcnt(8)
    s_branch LD_PWX
LD_PW1:
    s_waitcnt vmcnt(0)
LD_PWX:
    s_add_u32 s85, s85, 1
    s_call_b64 s[80:81], PUB
    s_branch LD_SPIN
LD_GO:
    buffer_load_dwordx4 v25, s[12:15], s89 offen lds
    s_add_u32 m0, m0, 2048
    s_add_u32 s89, s89, s87
    buffer_load_dwordx4 v25, s[12:15], s89 offen lds
    s_add_u32 m0, m0, 2048
    s_add_u32 s89, s89, s87
    buffer_load_dwordx4 v25, s[12:15], s89 offen lds
    s_add_u32 m0, m0, 2048
    s_add_u32 s89, s89, s87
    buffer_load_dwordx4 v25, s[12:15], s89 offen lds
    s_add_u32 m0, m0, 2048
    s_add_u32 s89, s89, s88
    buffer_load_dwordx4 v25, s[12:15], s89 offen lds
    s_add_u32 m0, m0, 2048
    s_add_u32 s89, s89, s87
    buffer_load_dwordx4 v25, s[12:15], s89 offen lds
    s_add_u32 m0, m0, 2048
    s_add_u32 s89, s89, s87
    buffer_load_dwordx4 v25, s[12:15], s89 offen lds
    s_add_u32 m0, m0, 2048
    s_add_u32 s89, s89, s87
    buffer_load_dwordx4 v25, s[12:15], s89 offen lds
    s_add_u32 m0, m0, 2048
    s_add_u32 s89, s89, s93
LD_ISSUED:
    s_and_b32 m0, m0, 0x1ffff
    s_add_u32 s84, s84, 1
    s_sub_u32 s51, s84, s85
    s_cmp_le_u32 s51, 2
    s_cbranch_scc1 LD_NOPUB
    s_waitcnt vmcnt(16)
    s_add_u32 s85, s85, 1
    s_call_b64 s[80:81], PUB
LD_NOPUB:
    s_sub_u32 s90, s90, 1
    s_cmp_lg_u32 s90, 0
    s_cbranch_scc1 LD_CHUNK
    s_setpc_b64 s[56:57]
INITW:
    s_lshr_b32 s90, s2, 3
    s_call_b64 s[78:79], RK
    s_mov_b32 s8, s22
    s_and_b32 s9, s23, 0xffff
    s_mov_b32 s10, 524288
    s_mov_b32 s11, 0x20000
    s_mul_i32 s51, s2, 2048
    s_mov_b32 exec_lo, 0xffff
    s_mov_b32 exec_hi, 0x0
    buffer_load_dword v6, v7, s[8:11], s51 offen sc1
    s_mov_b64 exec, -1
    s_mov_b32 s8, s26
    s_and_b32 s9, s27, 0xffff
    s_mov_b32 s10, 524288
    s_mov_b32 s11, 0x20000
    s_mul_i32 s51, s2, 2048
    s_mov_b32 exec_lo, 0xffff
    s_mov_b32 exec_hi, 0x0
    buffer_load_dword v6, v7, s[8:11], s51 offen sc1
    s_mov_b64 exec, -1
    s_mul_i32 s51, s40, 917504
    s_mul_i32 s52, s41, 8192
    s_add_u32 s51, s51, s52
    s_add_u32 s51, s51, 32768
    buffer_load_dword v6, v7, s[4:7], s51 offen sc1
    s_mul_i32 s51, s40, 917504
    s_mul_i32 s52, s41, 3072
    s_add_u32 s51, s51, s52
    s_add_u32 s51, s51, 851968
    s_mov_b64 exec, 0xffffff
    buffer_load_dword v6, v7, s[4:7], s51 offen sc1
    s_mov_b64 exec, -1
    s_add_u32 s82, s49, 22
    s_mov_b32 s83, 22
    s_call_b64 s[78:79], RQ
    s_setprio 0
    s_mov_b32 s55, 0
TW_204:
    ds_read_b32 v25, v4 offset:72
    s_waitcnt lgkmcnt(0)
    v_readfirstlane_b32 s52, v25
    s_nop 1
    s_cmp_ge_u32 s52, 1
    s_cbranch_scc1 TWD_205
    s_sleep 2
    s_add_u32 s55, s55, 1
    s_cmp_lt_u32 s55, 4000000
    s_cbranch_scc1 TW_204
    s_endpgm
TWD_205:
    s_mul_i32 s51, s40, 917504
    s_mul_i32 s52, s41, 8192
    s_add_u32 s51, s51, s52
    s_add_u32 s51, s51, 229376
    buffer_load_dword v6, v7, s[4:7], s51 offen sc1
    s_mul_i32 s51, s2, 7168
    s_add_u32 s98, s30, s51
    s_addc_u32 s99, s31, 0
    s_mov_b32 s53, 14
SP_206:
    s_load_dword s60, s[98:99], 0
    s_load_dword s61, s[98:99], 64
    s_load_dword s62, s[98:99], 128
    s_load_dword s63, s[98:99], 192
    s_load_dword s64, s[98:99], 256
    s_load_dword s65, s[98:99], 320
    s_load_dword s66, s[98:99], 384
    s_load_dword s67, s[98:99], 448
    s_add_u32 s98, s98, 512
    s_addc_u32 s99, s99, 0
    s_sub_u32 s53, s53, 1
    s_cmp_lg_u32 s53, 0
    s_cbranch_scc1 SP_206
    s_add_u32 s82, s49, 40
    s_mov_b32 s83, 1048576
    s_call_b64 s[78:79], R3
    s_add_u32 s46, s46, 1
    s_add_u32 s49, s49, 40
    s_call_b64 s[78:79], RK
    s_add_u32 s82, s49, 22
    s_mov_b32 s83, 22
    s_call_b64 s[78:79], RQ
    s_setprio 0
    s_mul_i32 s51, s40, 917504
    s_mul_i32 s52, s41, 8192
    s_add_u32 s51, s51, s52
    s_add_u32 s51, s51, 229376
    s_add_u32 s98, s38, s51
    s_addc_u32 s99, s39, 0
    s_mov_b32 s53, 16
SP_207:
    s_load_dword s60, s[98:99], 0
    s_load_dword s61, s[98:99], 64
    s_load_dword s62, s[98:99], 128
    s_load_dword s63, s[98:99], 192
    s_load_dword s64, s[98:99], 256
    s_load_dword s65, s[98:99], 320
    s_load_dword s66, s[98:99], 384
    s_load_dword s67, s[98:99], 448
    s_add_u32 s98, s98, 512
    s_addc_u32 s99, s99, 0
    s_sub_u32 s53, s53, 1
    s_cmp_lg_u32 s53, 0
    s_cbranch_scc1 SP_207
    s_add_u32 s82, s49, 40
    s_mov_b32 s83, 1048576
    s_call_b64 s[78:79], R3
    s_add_u32 s46, s46, 1
    s_add_u32 s49, s49, 40
    s_waitcnt vmcnt(0) lgkmcnt(0)
    s_endpgm
TASK6:
    s_lshr_b32 s90, s2, 3
    s_call_b64 s[78:79], RK
    s_mov_b32 s55, 0
TW_208:
    ds_read_b32 v25, v4 offset:44
    s_waitcnt lgkmcnt(0)
    v_readfirstlane_b32 s52, v25
    s_nop 1
    s_cmp_ge_u32 s52, 4
    s_cbranch_scc1 TWD_209
    s_sleep 2
    s_add_u32 s55, s55, 1
    s_cmp_lt_u32 s55, 4000000
    s_cbranch_scc1 TW_208
    s_endpgm
TWD_209:
    s_mov_b32 s12, s36
    s_and_b32 s13, s37, 0xffff
    s_mov_b32 s14, 256
    s_mov_b32 s15, 0x20000
    s_getreg_b32 s88, hwreg(HW_REG_XCC_ID)
    s_and_b32 s88, s88, 15
    v_mov_b32 v25, 0
    s_mov_b32 s55, 0
NC_L:
    buffer_load_dwordx4 v[28:31], v25, s[12:15], 0 offen sc1
    s_waitcnt vmcnt(0)
    v_xor_b32 v30, v28, v30
    v_xor_b32 v31, v29, v31
    v_and_b32 v30, v30, v31
    s_nop 0
    v_readfirstlane_b32 s51, v30
    s_nop 1
    s_cmp_eq_u32 s51, -1
    s_cbranch_scc1 NC_D
    s_sleep 8
    s_add_u32 s55, s55, 1
    s_cmp_lt_u32 s55, 400000
    s_cbranch_scc1 NC_L
    s_endpgm
NC_D:
    v_readfirstlane_b32 s92, v28
    v_readfirstlane_b32 s93, v29
    v_or_b32 v28, s88, v28
    s_lshl_b32 s51, s41, 7
    s_lshl_b32 s52, s40, 3
    s_add_u32 s51, s51, s52
    s_add_u32 s51, s51, 20250624
    s_lshl_b32 s52, s40, 7
    s_lshl_b32 s53, s41, 3
    s_add_u32 s52, s52, s53
    s_add_u32 s52, s52, 20254720
    s_mov_b64 exec, 1
    buffer_store_dwordx2 v[28:29], v25, s[4:7], s51 offen sc1
    buffer_store_dwordx2 v[28:29], v25, s[4:7], s52 offen sc1
    s_mov_b64 exec, -1
    s_add_u32 s82, s49, 22
    s_mov_b32 s83, 22
    s_call_b64 s[78:79], RQ
    s_setprio 0
    s_lshl_b32 s51, s41, 7
    s_add_u32 s51, s51, 20250624
    s_lshl_b32 s52, s40, 7
    s_add_u32 s52, s52, 20254720
    v_bfe_u32 v24, v0, 4, 4
    v_lshlrev_b32 v24, 3, v24
    v_add_u32 v25, s51, v24
    s_mov_b64 exec, 0xffff0000
    v_add_u32 v25, s52, v24
    s_mov_b64 exec, -1
    s_mov_b32 s55, 0
HS_L:
    buffer_load_dwordx2 v[28:29], v25, s[4:7], 0 offen sc1
    s_waitcnt vmcnt(0)
    v_and_b32 v30, -16, v28
    v_xor_b32 v30, s92, v30
    v_xor_b32 v31, s93, v29
    v_or_b32 v30, v30, v31
    v_cmp_eq_u32 vcc, 0, v30
    s_nop 1
    s_cmp_eq_u64 vcc, -1
    s_cbranch_scc1 HS_D
    s_sleep 4
    s_add_u32 s55, s55, 1
    s_cmp_lt_u32 s55, 400000
    s_cbranch_scc1 HS_L
    s_endpgm
HS_D:
    v_and_b32 v28, 15, v28
    v_cmp_eq_u32 vcc, s88, v28
    s_nop 1
    s_lshr_b32 s51, vcc_lo, 16
    s_cmp_eq_u32 s51, 0xffff
    s_cselect_b32 s51, 3, 2
    v_mov_b32 v24, s51
    ds_write_b32 v4, v24 offset:64
    s_mul_i32 s51, s2, 2048
    s_add_u32 s98, s28, s51
    s_addc_u32 s99, s29, 0
    s_mov_b32 s53, 4
SP_210:
    s_load_dword s60, s[98:99], 0
    s_load_dword s61, s[98:99], 64
    s_load_dword s62, s[98:99], 128
    s_load_dword s63, s[98:99], 192
    s_load_dword s64, s[98:99], 256
    s_load_dword s65, s[98:99], 320
    s_load_dword s66, s[98:99], 384
    s_load_dword s67, s[98:99], 448
    s_add_u32 s98, s98, 512
    s_addc_u32 s99, s99, 0
    s_sub_u32 s53, s53, 1
    s_cmp_lg_u32 s53, 0
    s_cbranch_scc1 SP_210
    s_mul_i32 s51, s2, 7168
    s_add_u32 s98, s32, s51
    s_addc_u32 s99, s33, 0
    s_mov_b32 s53, 14
SP_211:
    s_load_dword s60, s[98:99], 0
    s_load_dword s61, s[98:99], 64
    s_load_dword s62, s[98:99], 128
    s_load_dword s63, s[98:99], 192
    s_load_dword s64, s[98:99], 256
    s_load_dword s65, s[98:99], 320
    s_load_dword s66, s[98:99], 384
    s_load_dword s67, s[98:99], 448
    s_add_u32 s98, s98, 512
    s_addc_u32 s99, s99, 0
    s_sub_u32 s53, s53, 1
    s_cmp_lg_u32 s53, 0
    s_cbranch_scc1 SP_211
    s_add_u32 s82, s49, 40
    s_mov_b32 s83, 1048576
    s_call_b64 s[78:79], R3
    s_add_u32 s46, s46, 1
    s_add_u32 s49, s49, 40
    s_call_b64 s[78:79], RK
    s_add_u32 s82, s49, 22
    s_mov_b32 s83, 22
    s_call_b64 s[78:79], RQ
    s_setprio 0
    s_mul_i32 s51, s40, 917504
    s_mul_i32 s52, s41, 3072
    s_add_u32 s51, s51, s52
    s_add_u32 s51, s51, 851968
    s_add_u32 s98, s38, s51
    s_addc_u32 s99, s39, 0
    s_mov_b32 s53, 6
SP_212:
    s_load_dword s60, s[98:99], 0
    s_load_dword s61, s[98:99], 64
    s_load_dword s62, s[98:99], 128
    s_load_dword s63, s[98:99], 192
    s_load_dword s64, s[98:99], 256
    s_load_dword s65, s[98:99], 320
    s_load_dword s66, s[98:99], 384
    s_load_dword s67, s[98:99], 448
    s_add_u32 s98, s98, 512
    s_addc_u32 s99, s99, 0
    s_sub_u32 s53, s53, 1
    s_cmp_lg_u32 s53, 0
    s_cbranch_scc1 SP_212
    s_mul_i32 s51, s40, 917504
    s_mul_i32 s52, s41, 8192
    s_add_u32 s51, s51, s52
    s_add_u32 s51, s51, 32768
    s_add_u32 s98, s38, s51
    s_addc_u32 s99, s39, 0
    s_mov_b32 s53, 16
SP_213:
    s_load_dword s60, s[98:99], 0
    s_load_dword s61, s[98:99], 64
    s_load_dword s62, s[98:99], 128
    s_load_dword s63, s[98:99], 192
    s_load_dword s64, s[98:99], 256
    s_load_dword s65, s[98:99], 320
    s_load_dword s66, s[98:99], 384
    s_load_dword s67, s[98:99], 448
    s_add_u32 s98, s98, 512
    s_addc_u32 s99, s99, 0
    s_sub_u32 s53, s53, 1
    s_cmp_lg_u32 s53, 0
    s_cbranch_scc1 SP_213
    s_add_u32 s82, s49, 40
    s_mov_b32 s83, 1048576
    s_call_b64 s[78:79], R3
    s_add_u32 s46, s46, 1
    s_add_u32 s49, s49, 40
    s_waitcnt vmcnt(0) lgkmcnt(0)
    s_endpgm
CODE_END:
.section .rodata,"a"
.p2align 6
.amdhsa_kernel interleave_layers__linear_kernel_hedgehog__mixer_s_mlp__prompt_kernel
  .amdhsa_next_free_vgpr 256
  .amdhsa_next_free_sgpr 102
  .amdhsa_accum_offset 256
  .amdhsa_group_segment_fixed_size 0
  .amdhsa_kernarg_size 96
  .amdhsa_user_sgpr_count 2
  .amdhsa_user_sgpr_kernarg_segment_ptr 1
  .amdhsa_system_sgpr_workgroup_id_x 1
.end_amdhsa_kernel
```
